```python
import torch

def _softmax(x, axis=-1):
    return torch.softmax(x, dim=axis)
def _gelu(x):
    return torch.nn.functional.gelu(x, approximate="tanh")
def _silu(x):
    return torch.nn.functional.silu(x)
def _sigmoid(x):
    return torch.sigmoid(x)
def _layernorm(x, axis=-1, eps=1e-5):
    m = x.mean(dim=axis, keepdim=True)
    v = x.var(dim=axis, keepdim=True, unbiased=False)
    return (x - m) / torch.sqrt(v + eps)
def _scatter_add(tgt, idx, src, axis=0):
    return tgt.clone().index_add_(axis, idx, src)
def _segment_sum(src, seg, n):
    out = torch.zeros((n,) + src.shape[1:], dtype=src.dtype)
    return out.index_add_(0, seg, src)
def _pad(x, pw):
    flat = tuple(v for pair in reversed(pw) for v in pair)
    return torch.nn.functional.pad(x, flat)

kernel_name = 'sequential_preLN__grouped_kv_mqa__glu_gated_glu__prompt'

def setup_inputs():

    _w = (lambda a: (lambda t: t.to(torch.bfloat16) if t.is_floating_point() else t)(torch.as_tensor(a)))
    def _A_setup():
        B, S, D, H = 1, 2048, 512, 32
        Dh = D // H
        return {
            "x": _w((lambda *s: torch.randn(*s, dtype=torch.bfloat16) * 0.05)(B, S, D)),
            "wq": _w((lambda *s: torch.randn(*s, dtype=torch.bfloat16) * 0.05)(D, H * Dh)),
            "wk": _w((lambda *s: torch.randn(*s, dtype=torch.bfloat16) * 0.05)(D, Dh)),
            "wv": _w((lambda *s: torch.randn(*s, dtype=torch.bfloat16) * 0.05)(D, Dh)),
            "wo": _w((lambda *s: torch.randn(*s, dtype=torch.bfloat16) * 0.05)(H * Dh, D)),
        }
    _A_in = _A_setup()

    def _B_setup():
        B, S, D, F = 1, 2048, 512, 1792
        return {
            "x": _w((lambda *s: torch.randn(*s, dtype=torch.bfloat16) * 0.05)(B, S, D)),
            "w_gate": _w((lambda *s: torch.randn(*s, dtype=torch.bfloat16) * 0.05)(D, F)),
            "w_up": _w((lambda *s: torch.randn(*s, dtype=torch.bfloat16) * 0.05)(D, F)),
            "w_down": _w((lambda *s: torch.randn(*s, dtype=torch.bfloat16) * 0.05)(F, D)),
        }
    _B_in = _B_setup()

    return {
        "A_x": _A_in["x"],
        "A_wq": _A_in["wq"],
        "A_wk": _A_in["wk"],
        "A_wv": _A_in["wv"],
        "A_wo": _A_in["wo"],
        "B_x": _B_in["x"],
        "B_w_gate": _B_in["w_gate"],
        "B_w_up": _B_in["w_up"],
        "B_w_down": _B_in["w_down"],
    }

def reference(A_x, A_wq, A_wk, A_wv, A_wo, B_x, B_w_gate, B_w_up, B_w_down):
    def _A_ref(x, wq, wk, wv, wo):
        B, S, D = x.shape
        H = 32
        Dh = D // H
        q = (lambda x, *d: x.permute(*d))((x @ wq).reshape(B, S, H, Dh), 0, 2, 1, 3)
        k = x @ wk
        v = x @ wv
        scores = torch.einsum("bhqd,bkd->bhqk", q, k) * (Dh ** -0.5)
        p = _softmax(scores, axis=-1)
        o = torch.einsum("bhqk,bkd->bhqd", p, v)
        return (lambda x, *d: x.permute(*d))(o, 0, 2, 1, 3).reshape(B, S, H * Dh) @ wo

    def _B_ref(x, w_gate, w_up, w_down):
        g = torch.einsum("bsd,df->bsf", x, w_gate)
        u = torch.einsum("bsd,df->bsf", x, w_up)
        h = _sigmoid(g) * u
        return torch.einsum("bsf,fd->bsd", h, w_down)

    x = A_x
    h = x + _A_ref(_layernorm(x, axis=-1), A_wq, A_wk, A_wv, A_wo)
    h2 = h + _B_ref(_layernorm(h, axis=-1), B_w_gate, B_w_up, B_w_down)
    return h2
```

```asm
; @launch grid=(256,1,1) block=(512,1,1) lds=163840
.amdgcn_target "amdgcn-amd-amdhsa--gfx950"
.text
.globl sequential_preLN__grouped_kv_mqa__glu_gated_glu__prompt_kernel
.p2align 8
.type sequential_preLN__grouped_kv_mqa__glu_gated_glu__prompt_kernel,@function
sequential_preLN__grouped_kv_mqa__glu_gated_glu__prompt_kernel:
    s_load_dwordx2 s[4:5], s[0:1], 0
    s_lshr_b32 s52, s2, 1
    s_and_b32 s52, s52, 8
    s_add_u32 s52, s52, 16
    s_load_dwordx2 s[12:13], s[0:1], s52
    s_load_dwordx2 s[40:41], s[0:1], 88
    s_cmpk_ge_u32 s2, 256
    s_cbranch_scc1 L_end
    s_getpc_b64 s[64:65]
L_pc:
    v_readfirstlane_b32 s50, v0
    s_lshr_b32 s45, s2, 3
    s_lshl_b32 s51, s45, 11
    s_mov_b32 s66, L_codeend-L_pc
    s_mov_b32 s67, 0x20000
    v_lshrrev_b32 v1, 5, v0
    v_lshlrev_b32 v1, 7, v1
    buffer_load_dword v255, v1, s[64:67], s51 offen
    s_and_b32 s44, s2, 7
    s_lshr_b32 s51, s45, 2
    s_lshl_b32 s46, s44, 3
    s_add_u32 s46, s46, s51
    s_and_b32 s47, s45, 3
    s_bfe_u32 s48, s50, 0x20006
    v_and_b32 v0, 63, v0
    s_cmpk_lt_u32 s50, 256
    s_cbranch_scc1 L_main
    s_setprio 2
    v_lshrrev_b32 v2, 4, v0
    v_and_b32 v3, 15, v0
    v_lshlrev_b32 v4, 10, v2
    v_lshl_add_u32 v4, v3, 4, v4
    s_and_b32 s52, s47, 1
    s_lshl_b32 s57, s52, 2
    s_add_u32 s57, s57, s48
    s_lshl_b32 s50, s46, 3
    s_add_u32 s55, s50, s57
    s_lshl_b32 s55, s55, 12
    s_xor_b32 s56, s55, 0x4000
    s_mov_b32 s6, 2097152
    s_mov_b32 s7, 0x20000
    s_mov_b32 s14, 16384
    s_mov_b32 s15, 0x20000
    v_lshlrev_b32 v1, 4, v0
    s_lshl_b32 s58, s48, 12
    s_add_u32 m0, s58, 16640
    v_mov_b32 v124, v4
    s_waitcnt lgkmcnt(0)
    buffer_load_dwordx4 v[48:51], v124, s[4:7], s55 offen offset:0
    buffer_load_dwordx4 v[52:55], v124, s[4:7], s55 offen offset:256
    buffer_load_dwordx4 v[56:59], v124, s[4:7], s55 offen offset:512
    buffer_load_dwordx4 v[60:63], v124, s[4:7], s55 offen offset:768
    s_barrier
    buffer_load_dwordx4 v1, s[12:15], s58 offen offset:0 lds
    buffer_load_dwordx4 v1, s[12:15], s58 offen offset:1024 lds
    buffer_load_dwordx4 v1, s[12:15], s58 offen offset:2048 lds
    buffer_load_dwordx4 v1, s[12:15], s58 offen offset:3072 lds
    s_and_b32 s50, s48, 1
    s_lshl_b32 s50, s50, 3
    s_add_u32 s50, s50, 48
    s_load_dwordx2 s[20:21], s[0:1], s50
    s_load_dwordx2 s[16:17], s[0:1], 32
    s_load_dwordx2 s[28:29], s[0:1], 64
    s_load_dwordx2 s[32:33], s[0:1], 72
    s_mov_b32 s18, 524288
    s_mov_b32 s19, 0x20000
    s_mov_b32 s22, 1835008
    s_mov_b32 s23, 0x20000
    s_mov_b32 s30, 1835008
    s_mov_b32 s31, 0x20000
    s_mov_b32 s34, 2097152
    s_mov_b32 s35, 0x20000
    s_mov_b32 s42, 12582912
    s_mov_b32 s43, 0x20000
    s_mov_b32 s60, 0x3f803f80
    s_mov_b32 s61, 0x3f80
    s_mov_b32 s62, 0x3f800000
    s_getreg_b32 s49, hwreg(HW_REG_XCC_ID, 0, 4)
    v_bfe_u32 v5, v0, 1, 3
    v_mul_u32_u24 v5, 2080, v5
    v_and_b32 v6, 1, v0
    v_lshl_add_u32 v7, v6, 4, v5
    v_cmp_eq_u32 vcc, 0, v6
    v_mov_b32 v8, s60
    s_nop 0
    v_cndmask_b32 v8, 0, v8, vcc
    v_mov_b32 v9, v8
    v_mov_b32 v10, v8
    v_mov_b32 v11, v8
    ds_write_b128 v7, v[8:11] offset:2048
    v_mul_u32_u24 v5, 528, v3
    v_lshl_add_u32 v5, v2, 4, v5
    s_lshl_b32 s50, s57, 6
    s_xor_b32 s51, s50, 256
    s_add_u32 s52, s50, 33280
    s_add_u32 s53, s51, 33280
    v_add_u32 v120, s52, v5
    v_add_u32 v121, s53, v5
    s_lshr_b32 s50, s50, 2
    s_lshr_b32 s51, s51, 2
    s_add_u32 s50, s50, 163600
    s_add_u32 s51, s51, 163600
    v_lshl_add_u32 v122, v2, 2, s50
    v_lshl_add_u32 v123, v2, 2, s51
    s_waitcnt lgkmcnt(0)
    s_load_dword s36, s[40:41], 295936
    v_and_b32 v2, 7, v0
    s_lshl_b32 s50, s48, 3
    v_add_u32 v2, s50, v2
    v_lshlrev_b32 v2, 7, v2
    v_lshrrev_b32 v3, 3, v0
    v_lshl_add_u32 v2, v3, 12, v2
    v_lshrrev_b32 v14, 2, v0
    v_lshlrev_b32 v14, 10, v14
    v_and_b32 v15, 3, v0
    v_lshlrev_b32 v15, 4, v15
    s_lshl_b32 s50, s47, 8
    s_lshl_b32 s51, s48, 6
    s_add_u32 s50, s50, s51
    v_add3_u32 v4, v14, v15, s50
    s_mul_i32 s59, s48, 14336
    s_add_u32 s59, s59, 105728
    v_lshrrev_b32 v14, 5, v0
    v_lshlrev_b32 v14, 8, v14
    v_bfe_u32 v15, v0, 2, 2
    v_lshl_add_u32 v14, v15, 6, v14
    v_bfe_u32 v15, v0, 4, 1
    v_lshl_add_u32 v14, v15, 5, v14
    v_and_b32 v15, 3, v0
    v_lshl_add_u32 v14, v15, 3, v14
    v_add_u32 v5, s59, v14
    v_lshrrev_b32 v14, 3, v0
    v_and_b32 v15, 6, v14
    v_and_b32 v6, 7, v0
    v_xor_b32 v6, v6, v15
    v_lshlrev_b32 v6, 4, v6
    v_lshl_add_u32 v6, v14, 10, v6
    v_lshrrev_b32 v14, 2, v0
    v_lshlrev_b32 v14, 7, v14
    v_bfe_u32 v15, v0, 3, 2
    s_and_b32 s50, s48, 1
    s_lshl_b32 s50, s50, 1
    v_xor_b32 v15, s50, v15
    v_lshl_add_u32 v14, v15, 5, v14
    v_and_b32 v15, 3, v0
    v_lshlrev_b32 v15, 3, v15
    v_add3_u32 v24, v14, v15, s59
    v_xor_b32 v25, 32, v24
    v_xor_b32 v13, 64, v24
    v_xor_b32 v27, 96, v24
    s_and_b32 s50, s45, 15
    s_mul_i32 s50, s50, 224
    s_lshl_b32 s52, s47, 1
    v_add_u32 v14, 0, v0
    v_mul_u32_u24 v15, 10923, v14
    v_lshrrev_b32 v15, 16, v15
    v_mul_u32_u24 v16, 6, v15
    v_sub_u32 v14, v14, v16
    v_cmp_gt_u32 vcc, s52, v14
    v_mul_u32_u24 v15, 3584, v15
    v_add_u32 v16, 8, v14
    v_cndmask_b32 v14, v16, v14, vcc
    v_lshlrev_b32 v14, 4, v14
    v_add3_u32 v16, v14, v15, s50
    v_add_u32 v14, 64, v0
    v_mul_u32_u24 v15, 10923, v14
    v_lshrrev_b32 v15, 16, v15
    v_mul_u32_u24 v17, 6, v15
    v_sub_u32 v14, v14, v17
    v_cmp_gt_u32 vcc, s52, v14
    v_mul_u32_u24 v15, 3584, v15
    v_add_u32 v17, 8, v14
    v_cndmask_b32 v14, v17, v14, vcc
    v_lshlrev_b32 v14, 4, v14
    v_add3_u32 v17, v14, v15, s50
    v_add_u32 v14, 128, v0
    v_mul_u32_u24 v15, 10923, v14
    v_lshrrev_b32 v15, 16, v15
    v_mul_u32_u24 v18, 6, v15
    v_sub_u32 v14, v14, v18
    v_cmp_gt_u32 vcc, s52, v14
    v_mul_u32_u24 v15, 3584, v15
    v_add_u32 v18, 8, v14
    v_cndmask_b32 v14, v18, v14, vcc
    v_lshlrev_b32 v14, 4, v14
    v_add3_u32 v18, v14, v15, s50
    s_and_b32 s50, s45, 15
    s_mul_i32 s50, s50, 224
    s_lshl_b32 s51, s47, 5
    s_add_u32 s50, s50, s51
    v_lshrrev_b32 v15, 3, v0
    v_and_b32 v14, 6, v15
    v_and_b32 v43, 7, v0
    v_xor_b32 v14, v14, v43
    v_lshlrev_b32 v14, 4, v14
    v_mul_u32_u24 v15, 3584, v15
    v_add3_u32 v43, v14, v15, s50
    s_lshr_b32 s50, s48, 1
    s_mul_i32 s73, s50, 57344
    s_lshr_b32 s51, s45, 4
    s_lshl_b32 s51, s51, 1
    s_or_b32 s51, s51, s50
    s_and_b32 s52, s45, 1
    s_lshl_b32 s52, s52, 2
    s_or_b32 s72, s51, s52
    s_lshl_b32 s50, s50, 11
    s_and_b32 s51, s48, 1
    s_lshl_b32 s51, s51, 12
    s_add_u32 s74, s50, s51
    v_lshrrev_b32 v14, 4, v0
    v_mul_u32_u24 v14, 3584, v14
    v_bfe_u32 v15, v0, 2, 2
    v_mul_u32_u24 v15, 896, v15
    v_and_b32 v20, 3, v0
    v_lshlrev_b32 v20, 8, v20
    v_add3_u32 v20, v20, v14, v15
    s_mul_i32 s50, s48, 458752
    s_and_b32 s51, s45, 7
    s_lshl_b32 s51, s51, 7
    s_add_u32 s75, s50, s51
    v_mov_b32 v26, 163584
    v_lshlrev_b32 v23, 7, v0
    v_lshlrev_b32 v47, 2, v0
    s_lshl_b32 s50, s46, 4
    s_lshl_b32 s51, s47, 2
    s_add_u32 s50, s50, s51
    s_add_u32 s50, s50, s48
    s_lshl_b32 s51, s50, 11
    s_lshl_b32 s50, s50, 8
    s_bfm_b64 exec, 16, 0
    s_add_u32 s52, s51, 1048576
    v_add_u32 v21, s52, v23
    s_bfm_b64 exec, 2, 16
    s_add_u32 s52, s50, 391168
    v_add_u32 v21, s52, v23
    s_bfm_b64 exec, 2, 18
    s_add_u32 s52, s50, 784128
    v_add_u32 v21, s52, v23
    s_lshl_b32 s50, s46, 7
    s_add_u32 s50, s50, 344064
    s_lshl_b32 s51, s46, 6
    s_add_u32 s51, s51, 327680
    s_bitcmp1_b32 s48, 0
    s_cselect_b32 s51, s50, s51
    s_bfm_b64 exec, 44, 20
    v_mov_b32 v21, s51
    s_mov_b64 exec, -1
    v_lshlrev_b32 v22, 10, v0
    v_lshrrev_b32 v19, 3, v0
    v_lshlrev_b32 v19, 10, v19
    v_and_b32 v14, 7, v0
    v_lshl_add_u32 v19, v14, 4, v19
    v_and_b32 v14, 31, v0
    v_lshlrev_b32 v14, 10, v14
    v_lshrrev_b32 v15, 5, v0
    v_lshl_add_u32 v40, v15, 4, v14
    v_lshrrev_b32 v14, 4, v0
    v_lshlrev_b32 v14, 7, v14
    v_bfe_u32 v15, v0, 1, 1
    v_lshl_add_u32 v14, v15, 6, v14
    v_bfe_u32 v15, v0, 2, 2
    v_lshl_add_u32 v14, v15, 3, v14
    v_and_b32 v15, 1, v0
    v_lshl_add_u32 v14, v15, 2, v14
    v_add_u32 v42, 163072, v14
    s_lshl_b32 s50, s48, 2
    s_add_u32 s50, s50, 163776
    v_mov_b32 v230, s50
    v_and_b32 v41, 31, v0
    v_lshlrev_b32 v41, 2, v41
    v_add_u32 v41, 163600, v41
    v_lshrrev_b32 v14, 5, v0
    v_lshl_add_u32 v14, v14, 9, v1
    s_lshl_b32 s50, s2, 11
    s_cmp_eq_u32 s48, 1
    s_cselect_b32 s50, s50, 0x100000
    buffer_load_dwordx4 v[64:67], v124, s[4:7], s56 offen offset:0
    buffer_load_dwordx4 v[68:71], v124, s[4:7], s56 offen offset:256
    buffer_load_dwordx4 v[72:75], v124, s[4:7], s56 offen offset:512
    buffer_load_dwordx4 v[76:79], v124, s[4:7], s56 offen offset:768
    s_barrier
    buffer_load_dwordx4 v[232:235], v14, s[16:19], s50 offen offset:0
    buffer_load_dwordx4 v[236:239], v14, s[16:19], s50 offen offset:512
    s_waitcnt vmcnt(13)
    v_dot2_f32_bf16 v112, v48, s60, 0
    v_dot2_f32_bf16 v113, v49, s60, 0
    v_dot2_f32_bf16 v112, v50, s60, v112
    v_dot2_f32_bf16 v113, v51, s60, v113
    s_waitcnt vmcnt(12)
    v_dot2_f32_bf16 v112, v52, s60, v112
    v_dot2_f32_bf16 v113, v53, s60, v113
    v_dot2_f32_bf16 v112, v54, s60, v112
    v_dot2_f32_bf16 v113, v55, s60, v113
    s_waitcnt vmcnt(11)
    v_dot2_f32_bf16 v112, v56, s60, v112
    v_dot2_f32_bf16 v113, v57, s60, v113
    v_dot2_f32_bf16 v112, v58, s60, v112
    v_dot2_f32_bf16 v113, v59, s60, v113
    s_waitcnt vmcnt(10)
    v_dot2_f32_bf16 v112, v60, s60, v112
    v_dot2_f32_bf16 v113, v61, s60, v113
    v_dot2_f32_bf16 v112, v62, s60, v112
    v_dot2_f32_bf16 v113, v63, s60, v113
    s_nop 2
    v_add_f32 v112, v112, v113
    s_nop 1
    v_add_f32_dpp v112, v112, v112 quad_perm:[1,0,3,2] row_mask:0xf bank_mask:0xf
    s_nop 1
    v_add_f32_dpp v112, v112, v112 quad_perm:[2,3,0,1] row_mask:0xf bank_mask:0xf
    s_nop 1
    v_add_f32_dpp v112, v112, v112 row_half_mirror row_mask:0xf bank_mask:0xf
    s_nop 1
    v_add_f32_dpp v112, v112, v112 row_mirror row_mask:0xf bank_mask:0xf
    v_mul_f32 v112, 0xbb000000, v112
    ds_write_b32 v122, v112
    v_dot2_f32_bf16 v80, v48, s61, v112
    v_dot2_f32_bf16 v81, v48, s62, v112
    v_dot2_f32_bf16 v82, v49, s61, v112
    v_dot2_f32_bf16 v83, v49, s62, v112
    v_dot2_f32_bf16 v84, v50, s61, v112
    v_dot2_f32_bf16 v85, v50, s62, v112
    v_dot2_f32_bf16 v86, v51, s61, v112
    v_dot2_f32_bf16 v87, v51, s62, v112
    v_dot2_f32_bf16 v88, v52, s61, v112
    v_dot2_f32_bf16 v89, v52, s62, v112
    v_dot2_f32_bf16 v90, v53, s61, v112
    v_dot2_f32_bf16 v91, v53, s62, v112
    v_dot2_f32_bf16 v92, v54, s61, v112
    v_dot2_f32_bf16 v93, v54, s62, v112
    v_dot2_f32_bf16 v94, v55, s61, v112
    v_dot2_f32_bf16 v95, v55, s62, v112
    v_dot2_f32_bf16 v96, v56, s61, v112
    v_dot2_f32_bf16 v97, v56, s62, v112
    v_dot2_f32_bf16 v98, v57, s61, v112
    v_dot2_f32_bf16 v99, v57, s62, v112
    v_dot2_f32_bf16 v100, v58, s61, v112
    v_dot2_f32_bf16 v101, v58, s62, v112
    v_dot2_f32_bf16 v102, v59, s61, v112
    v_dot2_f32_bf16 v103, v59, s62, v112
    v_dot2_f32_bf16 v104, v60, s61, v112
    v_dot2_f32_bf16 v105, v60, s62, v112
    v_dot2_f32_bf16 v106, v61, s61, v112
    v_dot2_f32_bf16 v107, v61, s62, v112
    v_dot2_f32_bf16 v108, v62, s61, v112
    v_dot2_f32_bf16 v109, v62, s62, v112
    v_dot2_f32_bf16 v110, v63, s61, v112
    v_dot2_f32_bf16 v111, v63, s62, v112
    v_pk_mul_f32 v[114:115], v[80:81], v[80:81]
    v_pk_mul_f32 v[116:117], v[82:83], v[82:83]
    v_pk_fma_f32 v[114:115], v[84:85], v[84:85], v[114:115]
    v_pk_fma_f32 v[116:117], v[86:87], v[86:87], v[116:117]
    v_pk_fma_f32 v[114:115], v[88:89], v[88:89], v[114:115]
    v_pk_fma_f32 v[116:117], v[90:91], v[90:91], v[116:117]
    v_pk_fma_f32 v[114:115], v[92:93], v[92:93], v[114:115]
    v_pk_fma_f32 v[116:117], v[94:95], v[94:95], v[116:117]
    v_pk_fma_f32 v[114:115], v[96:97], v[96:97], v[114:115]
    v_pk_fma_f32 v[116:117], v[98:99], v[98:99], v[116:117]
    v_pk_fma_f32 v[114:115], v[100:101], v[100:101], v[114:115]
    v_pk_fma_f32 v[116:117], v[102:103], v[102:103], v[116:117]
    v_pk_fma_f32 v[114:115], v[104:105], v[104:105], v[114:115]
    v_pk_fma_f32 v[116:117], v[106:107], v[106:107], v[116:117]
    v_pk_fma_f32 v[114:115], v[108:109], v[108:109], v[114:115]
    v_pk_fma_f32 v[116:117], v[110:111], v[110:111], v[116:117]
    v_pk_add_f32 v[114:115], v[114:115], v[116:117]
    v_add_f32 v114, v114, v115
    s_nop 1
    v_add_f32_dpp v114, v114, v114 quad_perm:[1,0,3,2] row_mask:0xf bank_mask:0xf
    s_nop 1
    v_add_f32_dpp v114, v114, v114 quad_perm:[2,3,0,1] row_mask:0xf bank_mask:0xf
    s_nop 1
    v_add_f32_dpp v114, v114, v114 row_half_mirror row_mask:0xf bank_mask:0xf
    s_nop 1
    v_add_f32_dpp v114, v114, v114 row_mirror row_mask:0xf bank_mask:0xf
    v_mov_b32 v231, 1
    s_waitcnt vmcnt(6)
    ds_write_b32 v230, v231
    v_mov_b32 v115, 0x3727c5ac
    v_fmac_f32 v115, 0x3b000000, v114
    v_rsq_f32 v114, v115
    v_mov_b32 v231, 2
    v_pk_mul_f32 v[80:81], v[80:81], v[114:115] op_sel_hi:[1,0]
    v_pk_mul_f32 v[82:83], v[82:83], v[114:115] op_sel_hi:[1,0]
    v_pk_mul_f32 v[84:85], v[84:85], v[114:115] op_sel_hi:[1,0]
    v_pk_mul_f32 v[86:87], v[86:87], v[114:115] op_sel_hi:[1,0]
    v_cvt_pk_bf16_f32 v48, v80, v81
    v_cvt_pk_bf16_f32 v49, v82, v83
    v_cvt_pk_bf16_f32 v50, v84, v85
    v_cvt_pk_bf16_f32 v51, v86, v87
    ds_write_b128 v120, v[48:51] offset:0
    v_pk_mul_f32 v[88:89], v[88:89], v[114:115] op_sel_hi:[1,0]
    v_pk_mul_f32 v[90:91], v[90:91], v[114:115] op_sel_hi:[1,0]
    v_pk_mul_f32 v[92:93], v[92:93], v[114:115] op_sel_hi:[1,0]
    v_pk_mul_f32 v[94:95], v[94:95], v[114:115] op_sel_hi:[1,0]
    v_cvt_pk_bf16_f32 v52, v88, v89
    v_cvt_pk_bf16_f32 v53, v90, v91
    v_cvt_pk_bf16_f32 v54, v92, v93
    v_cvt_pk_bf16_f32 v55, v94, v95
    ds_write_b128 v120, v[52:55] offset:8448
    v_pk_mul_f32 v[96:97], v[96:97], v[114:115] op_sel_hi:[1,0]
    v_pk_mul_f32 v[98:99], v[98:99], v[114:115] op_sel_hi:[1,0]
    v_pk_mul_f32 v[100:101], v[100:101], v[114:115] op_sel_hi:[1,0]
    v_pk_mul_f32 v[102:103], v[102:103], v[114:115] op_sel_hi:[1,0]
    v_cvt_pk_bf16_f32 v56, v96, v97
    v_cvt_pk_bf16_f32 v57, v98, v99
    v_cvt_pk_bf16_f32 v58, v100, v101
    v_cvt_pk_bf16_f32 v59, v102, v103
    ds_write_b128 v120, v[56:59] offset:16896
    v_pk_mul_f32 v[104:105], v[104:105], v[114:115] op_sel_hi:[1,0]
    v_pk_mul_f32 v[106:107], v[106:107], v[114:115] op_sel_hi:[1,0]
    v_pk_mul_f32 v[108:109], v[108:109], v[114:115] op_sel_hi:[1,0]
    v_pk_mul_f32 v[110:111], v[110:111], v[114:115] op_sel_hi:[1,0]
    v_cvt_pk_bf16_f32 v60, v104, v105
    v_cvt_pk_bf16_f32 v61, v106, v107
    v_cvt_pk_bf16_f32 v62, v108, v109
    v_cvt_pk_bf16_f32 v63, v110, v111
    ds_write_b128 v120, v[60:63] offset:25344
    s_waitcnt lgkmcnt(0)
    ds_write_b32 v230, v231
    s_and_b32 s36, s36, 0xfffffff0
    s_add_u32 s36, s36, 0x9e3779b0
    s_add_u32 s37, s36, 1
    s_add_u32 s49, s49, s36
    v_mov_b32 v31, s36
    s_waitcnt vmcnt(2)
    v_dot2_f32_bf16 v112, v64, s60, 0
    v_dot2_f32_bf16 v113, v65, s60, 0
    v_dot2_f32_bf16 v112, v66, s60, v112
    v_dot2_f32_bf16 v113, v67, s60, v113
    v_dot2_f32_bf16 v112, v68, s60, v112
    v_dot2_f32_bf16 v113, v69, s60, v113
    v_dot2_f32_bf16 v112, v70, s60, v112
    v_dot2_f32_bf16 v113, v71, s60, v113
    v_dot2_f32_bf16 v112, v72, s60, v112
    v_dot2_f32_bf16 v113, v73, s60, v113
    v_dot2_f32_bf16 v112, v74, s60, v112
    v_dot2_f32_bf16 v113, v75, s60, v113
    v_dot2_f32_bf16 v112, v76, s60, v112
    v_dot2_f32_bf16 v113, v77, s60, v113
    v_dot2_f32_bf16 v112, v78, s60, v112
    v_dot2_f32_bf16 v113, v79, s60, v113
    s_nop 2
    v_add_f32 v112, v112, v113
    s_nop 1
    v_add_f32_dpp v112, v112, v112 quad_perm:[1,0,3,2] row_mask:0xf bank_mask:0xf
    s_nop 1
    v_add_f32_dpp v112, v112, v112 quad_perm:[2,3,0,1] row_mask:0xf bank_mask:0xf
    s_nop 1
    v_add_f32_dpp v112, v112, v112 row_half_mirror row_mask:0xf bank_mask:0xf
    s_nop 1
    v_add_f32_dpp v112, v112, v112 row_mirror row_mask:0xf bank_mask:0xf
    v_mul_f32 v112, 0xbb000000, v112
    ds_write_b32 v123, v112
    v_dot2_f32_bf16 v80, v64, s61, v112
    v_dot2_f32_bf16 v81, v64, s62, v112
    v_dot2_f32_bf16 v82, v65, s61, v112
    v_dot2_f32_bf16 v83, v65, s62, v112
    v_dot2_f32_bf16 v84, v66, s61, v112
    v_dot2_f32_bf16 v85, v66, s62, v112
    v_dot2_f32_bf16 v86, v67, s61, v112
    v_dot2_f32_bf16 v87, v67, s62, v112
    v_dot2_f32_bf16 v88, v68, s61, v112
    v_dot2_f32_bf16 v89, v68, s62, v112
    v_dot2_f32_bf16 v90, v69, s61, v112
    v_dot2_f32_bf16 v91, v69, s62, v112
    v_dot2_f32_bf16 v92, v70, s61, v112
    v_dot2_f32_bf16 v93, v70, s62, v112
    v_dot2_f32_bf16 v94, v71, s61, v112
    v_dot2_f32_bf16 v95, v71, s62, v112
    v_dot2_f32_bf16 v96, v72, s61, v112
    v_dot2_f32_bf16 v97, v72, s62, v112
    v_dot2_f32_bf16 v98, v73, s61, v112
    v_dot2_f32_bf16 v99, v73, s62, v112
    v_dot2_f32_bf16 v100, v74, s61, v112
    v_dot2_f32_bf16 v101, v74, s62, v112
    v_dot2_f32_bf16 v102, v75, s61, v112
    v_dot2_f32_bf16 v103, v75, s62, v112
    v_dot2_f32_bf16 v104, v76, s61, v112
    v_dot2_f32_bf16 v105, v76, s62, v112
    v_dot2_f32_bf16 v106, v77, s61, v112
    v_dot2_f32_bf16 v107, v77, s62, v112
    v_dot2_f32_bf16 v108, v78, s61, v112
    v_dot2_f32_bf16 v109, v78, s62, v112
    v_dot2_f32_bf16 v110, v79, s61, v112
    v_dot2_f32_bf16 v111, v79, s62, v112
    v_pk_mul_f32 v[114:115], v[80:81], v[80:81]
    v_pk_mul_f32 v[116:117], v[82:83], v[82:83]
    v_pk_fma_f32 v[114:115], v[84:85], v[84:85], v[114:115]
    v_pk_fma_f32 v[116:117], v[86:87], v[86:87], v[116:117]
    v_pk_fma_f32 v[114:115], v[88:89], v[88:89], v[114:115]
    v_pk_fma_f32 v[116:117], v[90:91], v[90:91], v[116:117]
    v_pk_fma_f32 v[114:115], v[92:93], v[92:93], v[114:115]
    v_pk_fma_f32 v[116:117], v[94:95], v[94:95], v[116:117]
    v_pk_fma_f32 v[114:115], v[96:97], v[96:97], v[114:115]
    v_pk_fma_f32 v[116:117], v[98:99], v[98:99], v[116:117]
    v_pk_fma_f32 v[114:115], v[100:101], v[100:101], v[114:115]
    v_pk_fma_f32 v[116:117], v[102:103], v[102:103], v[116:117]
    v_pk_fma_f32 v[114:115], v[104:105], v[104:105], v[114:115]
    v_pk_fma_f32 v[116:117], v[106:107], v[106:107], v[116:117]
    v_pk_fma_f32 v[114:115], v[108:109], v[108:109], v[114:115]
    v_pk_fma_f32 v[116:117], v[110:111], v[110:111], v[116:117]
    v_pk_add_f32 v[114:115], v[114:115], v[116:117]
    v_add_f32 v114, v114, v115
    s_nop 1
    v_add_f32_dpp v114, v114, v114 quad_perm:[1,0,3,2] row_mask:0xf bank_mask:0xf
    s_nop 1
    v_add_f32_dpp v114, v114, v114 quad_perm:[2,3,0,1] row_mask:0xf bank_mask:0xf
    s_nop 1
    v_add_f32_dpp v114, v114, v114 row_half_mirror row_mask:0xf bank_mask:0xf
    s_nop 1
    v_add_f32_dpp v114, v114, v114 row_mirror row_mask:0xf bank_mask:0xf
    v_mov_b32 v115, 0x3727c5ac
    v_fmac_f32 v115, 0x3b000000, v114
    v_rsq_f32 v114, v115
    v_mov_b32 v231, 3
    v_pk_mul_f32 v[80:81], v[80:81], v[114:115] op_sel_hi:[1,0]
    v_pk_mul_f32 v[82:83], v[82:83], v[114:115] op_sel_hi:[1,0]
    v_pk_mul_f32 v[84:85], v[84:85], v[114:115] op_sel_hi:[1,0]
    v_pk_mul_f32 v[86:87], v[86:87], v[114:115] op_sel_hi:[1,0]
    v_cvt_pk_bf16_f32 v64, v80, v81
    v_cvt_pk_bf16_f32 v65, v82, v83
    v_cvt_pk_bf16_f32 v66, v84, v85
    v_cvt_pk_bf16_f32 v67, v86, v87
    ds_write_b128 v121, v[64:67] offset:0
    v_pk_mul_f32 v[88:89], v[88:89], v[114:115] op_sel_hi:[1,0]
    v_pk_mul_f32 v[90:91], v[90:91], v[114:115] op_sel_hi:[1,0]
    v_pk_mul_f32 v[92:93], v[92:93], v[114:115] op_sel_hi:[1,0]
    v_pk_mul_f32 v[94:95], v[94:95], v[114:115] op_sel_hi:[1,0]
    v_cvt_pk_bf16_f32 v68, v88, v89
    v_cvt_pk_bf16_f32 v69, v90, v91
    v_cvt_pk_bf16_f32 v70, v92, v93
    v_cvt_pk_bf16_f32 v71, v94, v95
    ds_write_b128 v121, v[68:71] offset:8448
    v_pk_mul_f32 v[96:97], v[96:97], v[114:115] op_sel_hi:[1,0]
    v_pk_mul_f32 v[98:99], v[98:99], v[114:115] op_sel_hi:[1,0]
    v_pk_mul_f32 v[100:101], v[100:101], v[114:115] op_sel_hi:[1,0]
    v_pk_mul_f32 v[102:103], v[102:103], v[114:115] op_sel_hi:[1,0]
    v_cvt_pk_bf16_f32 v72, v96, v97
    v_cvt_pk_bf16_f32 v73, v98, v99
    v_cvt_pk_bf16_f32 v74, v100, v101
    v_cvt_pk_bf16_f32 v75, v102, v103
    ds_write_b128 v121, v[72:75] offset:16896
    v_pk_mul_f32 v[104:105], v[104:105], v[114:115] op_sel_hi:[1,0]
    v_pk_mul_f32 v[106:107], v[106:107], v[114:115] op_sel_hi:[1,0]
    v_pk_mul_f32 v[108:109], v[108:109], v[114:115] op_sel_hi:[1,0]
    v_pk_mul_f32 v[110:111], v[110:111], v[114:115] op_sel_hi:[1,0]
    v_cvt_pk_bf16_f32 v76, v104, v105
    v_cvt_pk_bf16_f32 v77, v106, v107
    v_cvt_pk_bf16_f32 v78, v108, v109
    v_cvt_pk_bf16_f32 v79, v110, v111
    ds_write_b128 v121, v[76:79] offset:25344
    s_waitcnt lgkmcnt(0)
    ds_write_b32 v230, v231
    s_cmp_lg_u32 s48, 1
    s_cbranch_scc1 L_nowb1
    s_waitcnt vmcnt(0)
    v_dot2_f32_bf16 v240, v232, s60, 0
    v_dot2_f32_bf16 v240, v233, s60, v240
    v_dot2_f32_bf16 v240, v234, s60, v240
    v_dot2_f32_bf16 v240, v235, s60, v240
    v_dot2_f32_bf16 v240, v236, s60, v240
    v_dot2_f32_bf16 v240, v237, s60, v240
    v_dot2_f32_bf16 v240, v238, s60, v240
    v_dot2_f32_bf16 v240, v239, s60, v240
    s_nop 0
    s_nop 1
    v_add_f32_dpp v240, v240, v240 quad_perm:[1,0,3,2] row_mask:0xf bank_mask:0xf
    s_nop 1
    v_add_f32_dpp v240, v240, v240 quad_perm:[2,3,0,1] row_mask:0xf bank_mask:0xf
    s_nop 1
    v_add_f32_dpp v240, v240, v240 row_half_mirror row_mask:0xf bank_mask:0xf
    s_nop 1
    v_add_f32_dpp v240, v240, v240 row_mirror row_mask:0xf bank_mask:0xf
    v_mov_b32 v241, v240
    s_nop 1
    v_permlane16_swap_b32 v240, v241
    v_add_f32 v240, v240, v241
    v_mul_f32 v240, 0x3b000000, v240
    v_mov_b32 v241, v240
    s_nop 1
    v_permlane32_swap_b32 v240, v241
    v_cvt_pk_bf16_f32 v244, v240, v241
    v_lshlrev_b32 v242, 16, v244
    v_and_b32 v243, 0xffff0000, v244
    v_sub_f32 v240, v240, v242
    v_sub_f32 v241, v241, v243
    v_cvt_pk_bf16_f32 v245, v240, v241
    v_mov_b32 v246, s37
    s_lshl_b32 s50, s2, 7
    s_add_u32 s63, s50, 360448
L_nowb1:
    s_lshl_b32 s51, s44, 12
    s_add_u32 s56, s51, 262144
    s_mul_i32 s57, s48, 4160
    s_lshl_b32 s58, s48, 12
    s_add_u32 s58, s58, 0
    s_cmp_lt_u32 s48, 2
    s_cbranch_scc1 L_x1skip
    s_and_b32 s52, s48, 1
    s_lshl_b32 s50, s52, 4
    v_and_b32 v12, 15, v0
    v_add_u32 v12, s50, v12
    v_lshlrev_b32 v14, 7, v12
    v_lshlrev_b32 v12, 2, v12
    s_lshl_b32 s51, s44, 7
    s_add_u32 s51, s51, 294912
    s_lshl_b32 s59, s44, 14
    s_lshl_b32 s50, s52, 13
    s_add_u32 s59, s59, s50
    s_add_u32 s59, s59, 131072
    s_mul_i32 s50, s52, 8320
    s_add_u32 m0, s50, 0
    s_lshl_b32 s50, s52, 2
    s_add_u32 s50, s50, 163584
    v_mov_b32 v15, s50
    v_mov_b32 v125, 1
    s_mov_b32 s54, 96
    s_bfm_b64 exec, 16, 0
L_x1l:
    buffer_load_dword v3, v12, s[40:43], s51 offen sc1
    s_waitcnt vmcnt(0)
    v_cmp_ne_u32 vcc, s49, v3
    s_cbranch_vccz L_x1a_ok
    s_sub_u32 s54, s54, 1
    s_cbranch_scc0 L_x1l
    s_mov_b64 exec, -1
    s_sub_u32 s59, s59, 131072
    v_mov_b32 v125, 0
    s_mov_b32 s54, 131072
    s_bfm_b64 exec, 16, 0
L_x1a:
    buffer_load_dword v3, v14, s[40:43], s56 offen sc1
    s_waitcnt vmcnt(0)
    v_cmp_ne_u32 vcc, s37, v3
    s_cbranch_vccz L_x1a_ok
    s_sub_u32 s54, s54, 1
    s_cbranch_scc0 L_x1a
L_x1a_ok:
    s_mov_b64 exec, -1
    buffer_load_dwordx4 v1, s[40:43], s59 offen offset:0 sc1 lds
    buffer_load_dwordx4 v1, s[40:43], s59 offen offset:1024 sc1 lds
    s_add_u32 m0, m0, 32
    s_nop 0
    buffer_load_dwordx4 v1, s[40:43], s59 offen offset:2048 sc1 lds
    buffer_load_dwordx4 v1, s[40:43], s59 offen offset:3072 sc1 lds
    s_add_u32 m0, m0, 4128
    s_add_u32 s59, s59, 4096
    buffer_load_dwordx4 v1, s[40:43], s59 offen offset:0 sc1 lds
    buffer_load_dwordx4 v1, s[40:43], s59 offen offset:1024 sc1 lds
    s_add_u32 m0, m0, 32
    s_nop 0
    buffer_load_dwordx4 v1, s[40:43], s59 offen offset:2048 sc1 lds
    buffer_load_dwordx4 v1, s[40:43], s59 offen offset:3072 sc1 lds
    ds_write_b32 v15, v125
L_x1skip:
    s_mul_i32 s59, s48, 14336
    s_add_u32 s59, s59, 105728
    s_cmp_lt_u32 s48, 2
    s_cbranch_scc1 L_x1skip2
    s_waitcnt vmcnt(0)
    s_waitcnt lgkmcnt(0)
L_x1skip2:
    s_barrier
    ds_write_b128 v7, v[8:11] offset:18688
    ds_read_b64 v[28:29], v26
    ds_read_b32 v12, v41
    s_barrier
    s_mov_b32 s56, 262144
    s_mov_b32 s54, 131072
L_x1b:
    buffer_load_dword v3, v2, s[40:43], s56 offen sc1
    s_waitcnt vmcnt(0)
    v_cmp_ne_u32 vcc, s37, v3
    s_cbranch_vccz L_x1b_ok
    s_sub_u32 s54, s54, 1
    s_cbranch_scc0 L_x1b
L_x1b_ok:
    s_waitcnt lgkmcnt(0)
    v_and_b32 v28, v28, v29
    s_nop 0
    v_readfirstlane_b32 s3, v28
    v_mov_b32 v29, s37
    v_mov_b32 v8, -1
    v_mov_b32 v9, -1
    v_mov_b32 v10, -1
    v_mov_b32 v11, -1
    s_setprio 0
    s_lshl_b32 s55, s47, 17
    s_add_u32 s50, s44, 1
    s_and_b32 s50, s50, 7
    s_lshl_b32 s50, s50, 14
    s_add_u32 m0, s57, 16640
    s_add_u32 s50, s50, s58
    buffer_load_dwordx4 v1, s[40:43], s50 offen offset:0 sc1 lds
    buffer_load_dwordx4 v1, s[40:43], s50 offen offset:1024 sc1 lds
    s_add_u32 m0, m0, 32
    s_nop 0
    buffer_load_dwordx4 v1, s[40:43], s50 offen offset:2048 sc1 lds
    buffer_load_dwordx4 v1, s[40:43], s50 offen offset:3072 sc1 lds
    s_cmp_lg_u32 s48, 1
    s_cbranch_scc1 L_nopub
    s_mov_b64 exec, 0xff
    buffer_store_dwordx4 v[244:247], v1, s[40:43], s63 offen sc1
    s_mov_b64 exec, -1
L_nopub:
    s_lshl_b32 s50, s45, 2
    s_add_u32 s50, s50, s48
    s_lshl_b32 s51, s50, 10
    s_add_u32 s51, s51, 0
    s_bfm_b64 exec, 8, 0
    buffer_load_dword v30, v23, s[40:43], s51 offen sc1
    s_mov_b64 exec, -1
    s_add_u32 m0, s59, 0
    s_xor_b32 s51, s55, 0
    buffer_load_dwordx4 v4, s[16:19], s51 offen lds
    s_add_u32 m0, s59, 1024
    s_xor_b32 s51, s55, 16384
    buffer_load_dwordx4 v4, s[16:19], s51 offen lds
    s_add_u32 m0, s59, 2048
    s_xor_b32 s51, s55, 32768
    buffer_load_dwordx4 v4, s[16:19], s51 offen lds
    s_add_u32 m0, s59, 3072
    s_xor_b32 s51, s55, 49152
    buffer_load_dwordx4 v4, s[16:19], s51 offen lds
    s_add_u32 m0, s59, 4096
    s_xor_b32 s51, s55, 65536
    buffer_load_dwordx4 v4, s[16:19], s51 offen lds
    s_add_u32 m0, s59, 5120
    s_xor_b32 s51, s55, 81920
    buffer_load_dwordx4 v4, s[16:19], s51 offen lds
    s_waitcnt vmcnt(7)
    s_barrier
    s_add_u32 s50, s44, 2
    s_and_b32 s50, s50, 7
    s_lshl_b32 s50, s50, 14
    s_add_u32 m0, s57, 0
    s_add_u32 s50, s50, s58
    buffer_load_dwordx4 v1, s[40:43], s50 offen offset:0 sc1 lds
    buffer_load_dwordx4 v1, s[40:43], s50 offen offset:1024 sc1 lds
    s_add_u32 m0, m0, 32
    s_nop 0
    buffer_load_dwordx4 v1, s[40:43], s50 offen offset:2048 sc1 lds
    buffer_load_dwordx4 v1, s[40:43], s50 offen offset:3072 sc1 lds
    s_lshl_b32 s50, s2, 2
    s_add_u32 s50, s50, s48
    s_cmp_lg_u32 s50, 0
    s_cbranch_scc1 L_noep
    s_mov_b32 s51, 295936
    s_mov_b64 exec, 1
    buffer_store_dword v31, off, s[40:43], s51 sc1
    s_mov_b64 exec, -1
L_noep:
    s_waitcnt vmcnt(4)
    ds_read_b64_tr_b16 v[128:129], v5 offset:0
    ds_read_b64_tr_b16 v[130:131], v5 offset:512
    ds_read_b64_tr_b16 v[132:133], v5 offset:1024
    ds_read_b64_tr_b16 v[134:135], v5 offset:1536
    ds_read_b64_tr_b16 v[136:137], v5 offset:2048
    ds_read_b64_tr_b16 v[138:139], v5 offset:2560
    ds_read_b64_tr_b16 v[140:141], v5 offset:3072
    ds_read_b64_tr_b16 v[142:143], v5 offset:3584
    ds_read_b64_tr_b16 v[144:145], v5 offset:4096
    ds_read_b64_tr_b16 v[146:147], v5 offset:4608
    ds_read_b64_tr_b16 v[148:149], v5 offset:5120
    ds_read_b64_tr_b16 v[150:151], v5 offset:5632
    s_waitcnt lgkmcnt(0)
    s_add_u32 m0, s59, 0
    s_xor_b32 s51, s55, 98304
    buffer_load_dwordx4 v4, s[16:19], s51 offen lds
    s_add_u32 m0, s59, 1024
    s_xor_b32 s51, s55, 114688
    buffer_load_dwordx4 v4, s[16:19], s51 offen lds
    s_add_u32 m0, s59, 2048
    s_xor_b32 s51, s55, 131072
    buffer_load_dwordx4 v4, s[16:19], s51 offen lds
    s_add_u32 m0, s59, 3072
    s_xor_b32 s51, s55, 147456
    buffer_load_dwordx4 v4, s[16:19], s51 offen lds
    s_add_u32 m0, s59, 4096
    s_xor_b32 s51, s55, 163840
    buffer_load_dwordx4 v4, s[16:19], s51 offen lds
    s_add_u32 m0, s59, 5120
    s_xor_b32 s51, s55, 180224
    buffer_load_dwordx4 v4, s[16:19], s51 offen lds
    s_add_u32 m0, s59, 6144
    s_xor_b32 s51, s55, 196608
    buffer_load_dwordx4 v4, s[16:19], s51 offen lds
    s_add_u32 m0, s59, 7168
    s_xor_b32 s51, s55, 212992
    buffer_load_dwordx4 v4, s[16:19], s51 offen lds
    s_add_u32 m0, s59, 8192
    s_xor_b32 s51, s55, 229376
    buffer_load_dwordx4 v4, s[16:19], s51 offen lds
    s_add_u32 m0, s59, 9216
    s_xor_b32 s51, s55, 245760
    buffer_load_dwordx4 v4, s[16:19], s51 offen lds
    s_add_u32 m0, s59, 10240
    s_xor_b32 s51, s55, 262144
    buffer_load_dwordx4 v4, s[16:19], s51 offen lds
    s_add_u32 m0, s59, 11264
    s_xor_b32 s51, s55, 278528
    buffer_load_dwordx4 v4, s[16:19], s51 offen lds
    s_add_u32 m0, s59, 12288
    s_xor_b32 s51, s55, 294912
    buffer_load_dwordx4 v4, s[16:19], s51 offen lds
    s_add_u32 m0, s59, 13312
    s_xor_b32 s51, s55, 311296
    buffer_load_dwordx4 v4, s[16:19], s51 offen lds
    s_lshl_b32 s50, s46, 15
    s_lshl_b32 s51, s47, 8
    s_add_u32 s50, s50, s51
    s_lshl_b32 s51, s48, 6
    s_add_u32 s50, s50, s51
    buffer_load_dwordx4 v[32:35], v40, s[4:7], s50 offen offset:0
    buffer_load_dwordx4 v[36:39], v40, s[4:7], s50 offen offset:32
    s_lshl_b32 s50, s2, 2
    s_add_u32 s50, s50, s48
    s_mul_i32 s51, s50, 1792
    s_bfm_b64 exec, 14, 0
    buffer_load_dword v30, v23, s[28:31], s51 offen
    s_mov_b64 exec, -1
    s_lshl_b32 s50, s2, 2
    s_add_u32 s50, s50, s48
    s_lshr_b32 s50, s50, 1
    s_mul_i32 s51, s50, 1792
    s_add_u32 s51, s51, 0
    s_bfm_b64 exec, 14, 0
    buffer_load_dword v30, v23, s[20:23], s51 offen
    s_mov_b64 exec, -1
    s_lshl_b32 s50, s2, 2
    s_add_u32 s50, s50, s48
    s_lshr_b32 s50, s50, 1
    s_mul_i32 s51, s50, 1792
    s_add_u32 s51, s51, 917504
    s_bfm_b64 exec, 14, 0
    buffer_load_dword v30, v23, s[20:23], s51 offen
    s_mov_b64 exec, -1
    s_waitcnt vmcnt(19)
    s_barrier
    s_add_u32 s50, s44, 3
    s_and_b32 s50, s50, 7
    s_lshl_b32 s50, s50, 14
    s_add_u32 m0, s57, 16640
    s_add_u32 s50, s50, s58
    buffer_load_dwordx4 v1, s[40:43], s50 offen offset:0 sc1 lds
    buffer_load_dwordx4 v1, s[40:43], s50 offen offset:1024 sc1 lds
    s_add_u32 m0, m0, 32
    s_nop 0
    buffer_load_dwordx4 v1, s[40:43], s50 offen offset:2048 sc1 lds
    buffer_load_dwordx4 v1, s[40:43], s50 offen offset:3072 sc1 lds
    s_waitcnt vmcnt(9)
    ds_read_b64_tr_b16 v[152:153], v5 offset:0
    ds_read_b64_tr_b16 v[154:155], v5 offset:512
    ds_read_b64_tr_b16 v[156:157], v5 offset:1024
    ds_read_b64_tr_b16 v[158:159], v5 offset:1536
    ds_read_b64_tr_b16 v[160:161], v5 offset:2048
    ds_read_b64_tr_b16 v[162:163], v5 offset:2560
    ds_read_b64_tr_b16 v[164:165], v5 offset:3072
    ds_read_b64_tr_b16 v[166:167], v5 offset:3584
    ds_read_b64_tr_b16 v[168:169], v5 offset:4096
    ds_read_b64_tr_b16 v[170:171], v5 offset:4608
    ds_read_b64_tr_b16 v[172:173], v5 offset:5120
    ds_read_b64_tr_b16 v[174:175], v5 offset:5632
    ds_read_b64_tr_b16 v[176:177], v5 offset:6144
    ds_read_b64_tr_b16 v[178:179], v5 offset:6656
    ds_read_b64_tr_b16 v[180:181], v5 offset:7168
    ds_read_b64_tr_b16 v[182:183], v5 offset:7680
    ds_read_b64_tr_b16 v[184:185], v5 offset:8192
    ds_read_b64_tr_b16 v[186:187], v5 offset:8704
    ds_read_b64_tr_b16 v[188:189], v5 offset:9216
    ds_read_b64_tr_b16 v[190:191], v5 offset:9728
    ds_read_b64_tr_b16 v[192:193], v5 offset:10240
    ds_read_b64_tr_b16 v[194:195], v5 offset:10752
    ds_read_b64_tr_b16 v[196:197], v5 offset:11264
    ds_read_b64_tr_b16 v[198:199], v5 offset:11776
    ds_read_b64_tr_b16 v[200:201], v5 offset:12288
    ds_read_b64_tr_b16 v[202:203], v5 offset:12800
    ds_read_b64_tr_b16 v[204:205], v5 offset:13312
    ds_read_b64_tr_b16 v[206:207], v5 offset:13824
    s_waitcnt lgkmcnt(0)
    s_add_u32 m0, s59, 0
    s_xor_b32 s51, s55, 327680
    buffer_load_dwordx4 v4, s[16:19], s51 offen lds
    s_add_u32 m0, s59, 1024
    s_xor_b32 s51, s55, 344064
    buffer_load_dwordx4 v4, s[16:19], s51 offen lds
    s_add_u32 m0, s59, 2048
    s_xor_b32 s51, s55, 360448
    buffer_load_dwordx4 v4, s[16:19], s51 offen lds
    s_add_u32 m0, s59, 3072
    s_xor_b32 s51, s55, 376832
    buffer_load_dwordx4 v4, s[16:19], s51 offen lds
    s_add_u32 m0, s59, 4096
    s_xor_b32 s51, s55, 393216
    buffer_load_dwordx4 v4, s[16:19], s51 offen lds
    s_add_u32 m0, s59, 5120
    s_xor_b32 s51, s55, 409600
    buffer_load_dwordx4 v4, s[16:19], s51 offen lds
    s_add_u32 m0, s59, 6144
    s_xor_b32 s51, s55, 425984
    buffer_load_dwordx4 v4, s[16:19], s51 offen lds
    s_add_u32 m0, s59, 7168
    s_xor_b32 s51, s55, 442368
    buffer_load_dwordx4 v4, s[16:19], s51 offen lds
    s_add_u32 m0, s59, 8192
    s_xor_b32 s51, s55, 458752
    buffer_load_dwordx4 v4, s[16:19], s51 offen lds
    s_add_u32 m0, s59, 9216
    s_xor_b32 s51, s55, 475136
    buffer_load_dwordx4 v4, s[16:19], s51 offen lds
    s_add_u32 m0, s59, 10240
    s_xor_b32 s51, s55, 491520
    buffer_load_dwordx4 v4, s[16:19], s51 offen lds
    s_add_u32 m0, s59, 11264
    s_xor_b32 s51, s55, 507904
    buffer_load_dwordx4 v4, s[16:19], s51 offen lds
    s_add_u32 m0, s59, 12288
    s_add_u32 s51, s75, 65536
    buffer_load_dwordx4 v6, s[28:31], s51 offen lds
    s_add_u32 m0, s59, 13312
    s_add_u32 s51, s75, 114688
    buffer_load_dwordx4 v6, s[28:31], s51 offen lds
    s_add_u32 m0, s74, 33280
    s_add_u32 s51, s73, 0
    buffer_load_dwordx4 v43, s[20:23], s51 offen lds
    s_add_u32 m0, s74, 34304
    s_add_u32 s51, s73, 28672
    buffer_load_dwordx4 v43, s[20:23], s51 offen lds
    s_waitcnt vmcnt(16)
    s_barrier
    s_add_u32 s50, s44, 4
    s_and_b32 s50, s50, 7
    s_lshl_b32 s50, s50, 14
    s_add_u32 m0, s57, 0
    s_add_u32 s50, s50, s58
    buffer_load_dwordx4 v1, s[40:43], s50 offen offset:0 sc1 lds
    buffer_load_dwordx4 v1, s[40:43], s50 offen offset:1024 sc1 lds
    s_add_u32 m0, m0, 32
    s_nop 0
    buffer_load_dwordx4 v1, s[40:43], s50 offen offset:2048 sc1 lds
    buffer_load_dwordx4 v1, s[40:43], s50 offen offset:3072 sc1 lds
    s_waitcnt vmcnt(6)
    ds_read_b64_tr_b16 v[208:209], v5 offset:0
    ds_read_b64_tr_b16 v[210:211], v5 offset:512
    ds_read_b64_tr_b16 v[212:213], v5 offset:1024
    ds_read_b64_tr_b16 v[214:215], v5 offset:1536
    ds_read_b64_tr_b16 v[216:217], v5 offset:2048
    ds_read_b64_tr_b16 v[218:219], v5 offset:2560
    ds_read_b64_tr_b16 v[220:221], v5 offset:3072
    ds_read_b64_tr_b16 v[222:223], v5 offset:3584
    ds_read_b64_tr_b16 v[224:225], v5 offset:4096
    ds_read_b64_tr_b16 v[226:227], v5 offset:4608
    ds_read_b64_tr_b16 v[228:229], v5 offset:5120
    ds_read_b64_tr_b16 v[230:231], v5 offset:5632
    ds_read_b64_tr_b16 v[232:233], v5 offset:6144
    ds_read_b64_tr_b16 v[234:235], v5 offset:6656
    ds_read_b64_tr_b16 v[236:237], v5 offset:7168
    ds_read_b64_tr_b16 v[238:239], v5 offset:7680
    ds_read_b64_tr_b16 v[240:241], v5 offset:8192
    ds_read_b64_tr_b16 v[242:243], v5 offset:8704
    ds_read_b64_tr_b16 v[244:245], v5 offset:9216
    ds_read_b64_tr_b16 v[246:247], v5 offset:9728
    ds_read_b64_tr_b16 v[248:249], v5 offset:10240
    ds_read_b64_tr_b16 v[250:251], v5 offset:10752
    ds_read_b64_tr_b16 v[252:253], v5 offset:11264
    ds_read_b64_tr_b16 v[254:255], v5 offset:11776
    ds_read_b64_tr_b16 v[48:49], v24 offset:12288
    ds_read_b64_tr_b16 v[52:53], v25 offset:12288
    ds_read_b64_tr_b16 v[56:57], v13 offset:12288
    ds_read_b64_tr_b16 v[60:61], v27 offset:12288
    s_waitcnt lgkmcnt(0)
    s_add_u32 m0, s59, 0
    s_add_u32 s51, s75, 73728
    buffer_load_dwordx4 v6, s[28:31], s51 offen lds
    s_add_u32 m0, s59, 1024
    s_add_u32 s51, s75, 122880
    buffer_load_dwordx4 v6, s[28:31], s51 offen lds
    s_add_u32 m0, s59, 2048
    s_add_u32 s51, s75, 229376
    buffer_load_dwordx4 v6, s[28:31], s51 offen lds
    s_add_u32 m0, s59, 3072
    s_add_u32 s51, s75, 344064
    buffer_load_dwordx4 v6, s[28:31], s51 offen lds
    s_add_u32 m0, s59, 4096
    s_add_u32 s51, s75, 237568
    buffer_load_dwordx4 v6, s[28:31], s51 offen lds
    s_add_u32 m0, s59, 5120
    s_add_u32 s51, s75, 352256
    buffer_load_dwordx4 v6, s[28:31], s51 offen lds
    s_add_u32 m0, s59, 6144
    s_add_u32 s51, s75, 81920
    buffer_load_dwordx4 v6, s[28:31], s51 offen lds
    s_add_u32 m0, s59, 7168
    s_add_u32 s51, s75, 196608
    buffer_load_dwordx4 v6, s[28:31], s51 offen lds
    s_add_u32 m0, s59, 8192
    s_add_u32 s51, s75, 90112
    buffer_load_dwordx4 v6, s[28:31], s51 offen lds
    s_add_u32 m0, s59, 9216
    s_add_u32 s51, s75, 204800
    buffer_load_dwordx4 v6, s[28:31], s51 offen lds
    s_add_u32 m0, s59, 10240
    s_add_u32 s51, s75, 245760
    buffer_load_dwordx4 v6, s[28:31], s51 offen lds
    s_add_u32 m0, s59, 11264
    s_add_u32 s51, s75, 360448
    buffer_load_dwordx4 v6, s[28:31], s51 offen lds
    s_add_u32 m0, s59, 12288
    s_add_u32 s51, s75, 253952
    buffer_load_dwordx4 v6, s[28:31], s51 offen lds
    s_add_u32 m0, s59, 13312
    s_add_u32 s51, s75, 368640
    buffer_load_dwordx4 v6, s[28:31], s51 offen lds
    s_and_b32 s52, s72, 3
    s_xor_b32 s52, s52, 0
    s_mul_i32 s51, s52, 114688
    s_lshl_b32 s52, s52, 1
    s_and_b32 s53, s48, 1
    s_add_u32 s52, s52, s53
    s_mul_i32 s52, s52, 3072
    s_add_u32 m0, s52, 57856
    s_nop 0
    buffer_load_dwordx4 v16, s[20:23], s51 offen lds
    s_add_u32 m0, s52, 58880
    s_nop 0
    buffer_load_dwordx4 v17, s[20:23], s51 offen lds
    s_add_u32 m0, s52, 59904
    s_nop 0
    buffer_load_dwordx4 v18, s[20:23], s51 offen lds
    s_add_u32 m0, s74, 41472
    s_add_u32 s51, s73, 114688
    buffer_load_dwordx4 v43, s[20:23], s51 offen lds
    s_add_u32 m0, s74, 42496
    s_add_u32 s51, s73, 143360
    buffer_load_dwordx4 v43, s[20:23], s51 offen lds
    s_waitcnt vmcnt(19)
    s_barrier
    s_add_u32 s50, s44, 5
    s_and_b32 s50, s50, 7
    s_lshl_b32 s50, s50, 14
    s_add_u32 m0, s57, 16640
    s_add_u32 s50, s50, s58
    buffer_load_dwordx4 v1, s[40:43], s50 offen offset:0 sc1 lds
    buffer_load_dwordx4 v1, s[40:43], s50 offen offset:1024 sc1 lds
    s_add_u32 m0, m0, 32
    s_nop 0
    buffer_load_dwordx4 v1, s[40:43], s50 offen offset:2048 sc1 lds
    buffer_load_dwordx4 v1, s[40:43], s50 offen offset:3072 sc1 lds
    s_waitcnt vmcnt(9)
    ds_read_b64_tr_b16 v[50:51], v24 offset:0
    ds_read_b64_tr_b16 v[54:55], v25 offset:0
    ds_read_b64_tr_b16 v[58:59], v13 offset:0
    ds_read_b64_tr_b16 v[62:63], v27 offset:0
    ds_read_b64_tr_b16 v[64:65], v24 offset:2048
    ds_read_b64_tr_b16 v[68:69], v25 offset:2048
    ds_read_b64_tr_b16 v[72:73], v13 offset:2048
    ds_read_b64_tr_b16 v[76:77], v27 offset:2048
    ds_read_b64_tr_b16 v[66:67], v24 offset:4096
    ds_read_b64_tr_b16 v[70:71], v25 offset:4096
    ds_read_b64_tr_b16 v[74:75], v13 offset:4096
    ds_read_b64_tr_b16 v[78:79], v27 offset:4096
    ds_read_b64_tr_b16 v[80:81], v24 offset:6144
    ds_read_b64_tr_b16 v[84:85], v25 offset:6144
    ds_read_b64_tr_b16 v[88:89], v13 offset:6144
    ds_read_b64_tr_b16 v[92:93], v27 offset:6144
    ds_read_b64_tr_b16 v[82:83], v24 offset:8192
    ds_read_b64_tr_b16 v[86:87], v25 offset:8192
    ds_read_b64_tr_b16 v[90:91], v13 offset:8192
    ds_read_b64_tr_b16 v[94:95], v27 offset:8192
    ds_read_b64_tr_b16 v[96:97], v24 offset:10240
    ds_read_b64_tr_b16 v[100:101], v25 offset:10240
    ds_read_b64_tr_b16 v[104:105], v13 offset:10240
    ds_read_b64_tr_b16 v[108:109], v27 offset:10240
    ds_read_b64_tr_b16 v[98:99], v24 offset:12288
    ds_read_b64_tr_b16 v[102:103], v25 offset:12288
    ds_read_b64_tr_b16 v[106:107], v13 offset:12288
    ds_read_b64_tr_b16 v[110:111], v27 offset:12288
    s_waitcnt lgkmcnt(0)
    s_add_u32 m0, s59, 0
    s_add_u32 s51, s75, 98304
    buffer_load_dwordx4 v6, s[28:31], s51 offen lds
    s_add_u32 m0, s59, 1024
    s_add_u32 s51, s75, 212992
    buffer_load_dwordx4 v6, s[28:31], s51 offen lds
    s_add_u32 m0, s59, 2048
    s_add_u32 s51, s75, 106496
    buffer_load_dwordx4 v6, s[28:31], s51 offen lds
    s_add_u32 m0, s59, 3072
    s_add_u32 s51, s75, 221184
    buffer_load_dwordx4 v6, s[28:31], s51 offen lds
    s_and_b32 s52, s72, 3
    s_xor_b32 s52, s52, 2
    s_mul_i32 s51, s52, 114688
    s_lshl_b32 s52, s52, 1
    s_and_b32 s53, s48, 1
    s_add_u32 s52, s52, s53
    s_mul_i32 s52, s52, 3072
    s_add_u32 m0, s52, 57856
    s_nop 0
    buffer_load_dwordx4 v16, s[20:23], s51 offen lds
    s_add_u32 m0, s52, 58880
    s_nop 0
    buffer_load_dwordx4 v17, s[20:23], s51 offen lds
    s_add_u32 m0, s52, 59904
    s_nop 0
    buffer_load_dwordx4 v18, s[20:23], s51 offen lds
    s_and_b32 s52, s72, 1
    s_xor_b32 s52, s52, 4
    s_mul_i32 s51, s52, 114688
    s_lshl_b32 s52, s52, 1
    s_and_b32 s53, s48, 1
    s_add_u32 s52, s52, s53
    s_mul_i32 s52, s52, 3072
    s_add_u32 m0, s52, 57856
    s_nop 0
    buffer_load_dwordx4 v16, s[20:23], s51 offen lds
    s_add_u32 m0, s52, 58880
    s_nop 0
    buffer_load_dwordx4 v17, s[20:23], s51 offen lds
    s_add_u32 m0, s52, 59904
    s_nop 0
    buffer_load_dwordx4 v18, s[20:23], s51 offen lds
    s_add_u32 m0, s74, 49664
    s_add_u32 s51, s73, 229376
    buffer_load_dwordx4 v43, s[20:23], s51 offen lds
    s_add_u32 m0, s74, 50688
    s_add_u32 s51, s73, 258048
    buffer_load_dwordx4 v43, s[20:23], s51 offen lds
    s_waitcnt vmcnt(8)
    ds_read_b64_tr_b16 v[112:113], v24 offset:0
    ds_read_b64_tr_b16 v[116:117], v25 offset:0
    ds_read_b64_tr_b16 v[120:121], v13 offset:0
    ds_read_b64_tr_b16 v[124:125], v27 offset:0
    ds_read_b64_tr_b16 v[114:115], v24 offset:2048
    ds_read_b64_tr_b16 v[118:119], v25 offset:2048
    ds_read_b64_tr_b16 v[122:123], v13 offset:2048
    ds_read_b64_tr_b16 v[126:127], v27 offset:2048
    s_waitcnt lgkmcnt(0)
    s_lshl_b32 s50, s46, 1
    s_and_b32 s53, s48, 1
    s_add_u32 s50, s50, s53
    s_lshl_b32 s50, s50, 14
    s_lshl_b32 s53, s47, 2
    s_add_u32 s53, s53, s48
    s_lshr_b32 s53, s53, 1
    s_lshl_b32 s53, s53, 7
    s_add_u32 s50, s50, s53
    s_bfm_b64 exec, 16, 0
    buffer_load_dword v30, v22, s[32:35], s50 offen sc1
    s_mov_b64 exec, -1
    s_bfm_b64 exec, 21, 0
    buffer_load_dword v30, v21, s[40:43], 0 offen sc1
    s_mov_b64 exec, -1
    s_barrier
    s_add_u32 s50, s44, 6
    s_and_b32 s50, s50, 7
    s_lshl_b32 s50, s50, 14
    s_add_u32 m0, s57, 0
    s_add_u32 s50, s50, s58
    buffer_load_dwordx4 v1, s[40:43], s50 offen offset:0 sc1 lds
    buffer_load_dwordx4 v1, s[40:43], s50 offen offset:1024 sc1 lds
    s_add_u32 m0, m0, 32
    s_nop 0
    buffer_load_dwordx4 v1, s[40:43], s50 offen offset:2048 sc1 lds
    buffer_load_dwordx4 v1, s[40:43], s50 offen offset:3072 sc1 lds
    s_and_b32 s52, s72, 7
    s_xor_b32 s52, s52, 8
    s_mul_i32 s51, s52, 114688
    s_lshl_b32 s52, s52, 1
    s_and_b32 s53, s48, 1
    s_add_u32 s52, s52, s53
    s_mul_i32 s52, s52, 3072
    s_add_u32 m0, s52, 57856
    s_nop 0
    buffer_load_dwordx4 v16, s[20:23], s51 offen lds
    s_add_u32 m0, s52, 58880
    s_nop 0
    buffer_load_dwordx4 v17, s[20:23], s51 offen lds
    s_add_u32 m0, s52, 59904
    s_nop 0
    buffer_load_dwordx4 v18, s[20:23], s51 offen lds
    s_and_b32 s52, s72, 7
    s_xor_b32 s52, s52, 10
    s_mul_i32 s51, s52, 114688
    s_lshl_b32 s52, s52, 1
    s_and_b32 s53, s48, 1
    s_add_u32 s52, s52, s53
    s_mul_i32 s52, s52, 3072
    s_add_u32 m0, s52, 57856
    s_nop 0
    buffer_load_dwordx4 v16, s[20:23], s51 offen lds
    s_add_u32 m0, s52, 58880
    s_nop 0
    buffer_load_dwordx4 v17, s[20:23], s51 offen lds
    s_add_u32 m0, s52, 59904
    s_nop 0
    buffer_load_dwordx4 v18, s[20:23], s51 offen lds
    s_lshl_b32 s50, s46, 4
    s_lshl_b32 s51, s47, 2
    s_add_u32 s50, s50, s51
    s_add_u32 s50, s50, s48
    s_waitcnt vmcnt(10)
    s_cmp_eq_u32 s3, 1
    s_cbranch_scc0 L_Cxs
    s_lshl_b32 s51, s50, 11
    s_add_u32 s51, s51, 1048576
    buffer_store_dwordx4 v[8:11], v1, s[40:43], s51 offen offset:0
    buffer_store_dwordx4 v[8:11], v1, s[40:43], s51 offen offset:1024
    s_lshl_b32 s51, s46, 1
    s_and_b32 s53, s48, 1
    s_add_u32 s51, s51, s53
    s_lshl_b32 s51, s51, 14
    s_lshl_b32 s53, s47, 2
    s_add_u32 s53, s53, s48
    s_lshr_b32 s53, s53, 1
    s_lshl_b32 s53, s53, 7
    s_add_u32 s51, s51, s53
    buffer_store_dwordx4 v[8:11], v19, s[32:35], s51 offen
    s_add_u32 s51, s51, 8192
    buffer_store_dwordx4 v[8:11], v19, s[32:35], s51 offen
    s_bfm_b64 exec, 16, 0
    s_lshl_b32 s51, s50, 8
    s_add_u32 s51, s51, 393216
    buffer_store_dwordx4 v[8:11], v1, s[40:43], s51 offen
    s_lshl_b32 s51, s50, 8
    s_add_u32 s51, s51, 786432
    buffer_store_dwordx4 v[8:11], v1, s[40:43], s51 offen
    s_mov_b64 exec, -1
L_Cxd:
    s_waitcnt vmcnt(12)
    s_barrier
    s_add_u32 s50, s44, 7
    s_and_b32 s50, s50, 7
    s_lshl_b32 s50, s50, 14
    s_add_u32 m0, s57, 16640
    s_add_u32 s50, s50, s58
    buffer_load_dwordx4 v1, s[40:43], s50 offen offset:0 sc1 lds
    buffer_load_dwordx4 v1, s[40:43], s50 offen offset:1024 sc1 lds
    s_add_u32 m0, m0, 32
    s_nop 0
    buffer_load_dwordx4 v1, s[40:43], s50 offen offset:2048 sc1 lds
    buffer_load_dwordx4 v1, s[40:43], s50 offen offset:3072 sc1 lds
    s_lshl_b32 s50, s46, 4
    s_lshl_b32 s51, s47, 2
    s_add_u32 s50, s50, s51
    s_add_u32 s50, s50, s48
    s_waitcnt vmcnt(4)
    s_cmp_eq_u32 s3, 1
    s_cbranch_scc0 L_Cfs
    s_lshl_b32 s51, s50, 2
    s_add_u32 s51, s51, 327680
    s_mov_b64 exec, 1
    buffer_store_dword v29, off, s[40:43], s51
    s_mov_b64 exec, -1
L_Cfd:
    s_and_b32 s52, s72, 7
    s_xor_b32 s52, s52, 12
    s_mul_i32 s51, s52, 114688
    s_lshl_b32 s52, s52, 1
    s_and_b32 s53, s48, 1
    s_add_u32 s52, s52, s53
    s_mul_i32 s52, s52, 3072
    s_add_u32 m0, s52, 57856
    s_nop 0
    buffer_load_dwordx4 v16, s[20:23], s51 offen lds
    s_add_u32 m0, s52, 58880
    s_nop 0
    buffer_load_dwordx4 v17, s[20:23], s51 offen lds
    s_add_u32 m0, s52, 59904
    s_nop 0
    buffer_load_dwordx4 v18, s[20:23], s51 offen lds
    s_and_b32 s52, s72, 7
    s_xor_b32 s52, s52, 14
    s_mul_i32 s51, s52, 114688
    s_lshl_b32 s52, s52, 1
    s_and_b32 s53, s48, 1
    s_add_u32 s52, s52, s53
    s_mul_i32 s52, s52, 3072
    s_add_u32 m0, s52, 57856
    s_nop 0
    buffer_load_dwordx4 v16, s[20:23], s51 offen lds
    s_add_u32 m0, s52, 58880
    s_nop 0
    buffer_load_dwordx4 v17, s[20:23], s51 offen lds
    s_add_u32 m0, s52, 59904
    s_nop 0
    buffer_load_dwordx4 v18, s[20:23], s51 offen lds
    s_and_b32 s52, s72, 1
    s_xor_b32 s52, s52, 6
    s_mul_i32 s51, s52, 114688
    s_lshl_b32 s52, s52, 1
    s_and_b32 s53, s48, 1
    s_add_u32 s52, s52, s53
    s_mul_i32 s52, s52, 3072
    s_add_u32 m0, s52, 57856
    s_nop 0
    buffer_load_dwordx4 v16, s[20:23], s51 offen lds
    s_add_u32 m0, s52, 58880
    s_nop 0
    buffer_load_dwordx4 v17, s[20:23], s51 offen lds
    s_add_u32 m0, s52, 59904
    s_nop 0
    buffer_load_dwordx4 v18, s[20:23], s51 offen lds
    s_cmp_lg_u32 s48, 3
    s_cbranch_scc1 L_nowb2
    s_lshl_b32 s50, s47, 13
    s_add_u32 s50, s50, 360448
    s_mov_b32 s54, 131072
    s_setprio 2
L_wb:
    buffer_load_dwordx3 v[44:46], v23, s[40:43], s50 offen sc1
    s_waitcnt vmcnt(0)
    v_cmp_ne_u32 vcc, s37, v46
    s_cbranch_vccz L_wb_ok
    s_sub_u32 s54, s54, 1
    s_cbranch_scc0 L_wb
L_wb_ok:
    s_setprio 0
    ds_write2_b32 v42, v44, v45 offset0:0 offset1:8
    s_waitcnt lgkmcnt(0)
L_nowb2:
    s_waitcnt vmcnt(10)
    s_barrier
    s_lshl_b32 s50, s44, 9
    s_lshl_b32 s51, s48, 7
    s_add_u32 s50, s50, s51
    s_add_u32 s50, s50, 327680
    s_setprio 2
    s_mov_b32 s54, 131072
    s_bfm_b64 exec, 32, 0
L_clr:
    buffer_load_dword v3, v47, s[40:43], s50 offen sc1
    s_waitcnt vmcnt(0)
    v_cmp_ne_u32 vcc, s37, v3
    s_cbranch_vccz L_clr_ok
    s_sub_u32 s54, s54, 1
    s_cbranch_scc0 L_clr
L_clr_ok:
    s_mov_b64 exec, -1
    s_setprio 0
    s_lshl_b32 s50, s45, 2
    s_add_u32 s50, s50, s48
    s_lshl_b32 s51, s50, 9
    s_bfm_b64 exec, 4, 0
    buffer_load_dword v30, v23, s[64:67], s51 offen
    s_mov_b64 exec, -1
    s_barrier
    s_setprio 2
L_phc:
    s_lshl_b32 s50, s46, 2
    s_add_u32 s50, s50, s47
    s_lshl_b32 s59, s50, 10
    s_lshl_b32 s51, s48, 2
    s_add_u32 s59, s59, s51
    s_add_u32 s59, s59, 393216
    s_lshl_b32 s55, s46, 1
    s_and_b32 s53, s48, 1
    s_add_u32 s55, s55, s53
    s_lshl_b32 s55, s55, 14
    s_lshl_b32 s53, s47, 2
    s_add_u32 s53, s53, s48
    s_lshr_b32 s53, s53, 1
    s_lshl_b32 s53, s53, 7
    s_add_u32 s55, s55, s53
    s_add_u32 s56, s55, 8192
    s_barrier
    s_waitcnt vmcnt(0)
    s_barrier
    v_mov_b32 v13, v43
    v_mov_b32 v3, v19
    ds_read_b128 v[4:7], v1 offset:0
    ds_read_b128 v[8:11], v1 offset:1024
    ds_read_b128 v[40:43], v1 offset:2048
    v_permlane32_swap_b32 v32, v34
    v_permlane32_swap_b32 v33, v35
    v_permlane32_swap_b32 v36, v38
    v_permlane32_swap_b32 v37, v39
    v_lshlrev_b32 v16, 16, v32
    v_and_b32 v17, 0xffff0000, v32
    v_lshlrev_b32 v18, 16, v33
    v_and_b32 v19, 0xffff0000, v33
    v_lshlrev_b32 v20, 16, v34
    v_and_b32 v21, 0xffff0000, v34
    v_lshlrev_b32 v22, 16, v35
    v_and_b32 v23, 0xffff0000, v35
    v_lshlrev_b32 v24, 16, v36
    v_and_b32 v25, 0xffff0000, v36
    v_lshlrev_b32 v26, 16, v37
    v_and_b32 v27, 0xffff0000, v37
    v_lshlrev_b32 v28, 16, v38
    v_and_b32 v29, 0xffff0000, v38
    v_lshlrev_b32 v30, 16, v39
    v_and_b32 v31, 0xffff0000, v39
    v_add_u32 v2, 156160, v1
    s_waitcnt lgkmcnt(2)
    v_mfma_f32_32x32x16_bf16 v[16:31], v[128:131], v[4:7], v[16:31]
    ds_read_b128 v[44:47], v1 offset:3072
    s_waitcnt lgkmcnt(2)
    v_mfma_f32_32x32x16_bf16 v[16:31], v[132:135], v[8:11], v[16:31]
    ds_read_b128 v[4:7], v1 offset:4096
    s_waitcnt lgkmcnt(2)
    v_mfma_f32_32x32x16_bf16 v[16:31], v[136:139], v[40:43], v[16:31]
    ds_read_b128 v[8:11], v1 offset:5120
    s_waitcnt lgkmcnt(2)
    v_mfma_f32_32x32x16_bf16 v[16:31], v[140:143], v[44:47], v[16:31]
    ds_read_b128 v[40:43], v1 offset:6144
    s_waitcnt lgkmcnt(2)
    v_mfma_f32_32x32x16_bf16 v[16:31], v[144:147], v[4:7], v[16:31]
    ds_read_b128 v[44:47], v1 offset:7168
    s_waitcnt lgkmcnt(2)
    v_mfma_f32_32x32x16_bf16 v[16:31], v[148:151], v[8:11], v[16:31]
    s_waitcnt lgkmcnt(1)
    v_mfma_f32_32x32x16_bf16 v[16:31], v[152:155], v[40:43], v[16:31]
    s_waitcnt lgkmcnt(0)
    v_mfma_f32_32x32x16_bf16 v[16:31], v[156:159], v[44:47], v[16:31]
    s_barrier
    ds_read_b128 v[4:7], v1 offset:8192
    ds_read_b128 v[8:11], v1 offset:9216
    ds_read_b128 v[40:43], v1 offset:10240
    s_waitcnt lgkmcnt(2)
    v_mfma_f32_32x32x16_bf16 v[16:31], v[160:163], v[4:7], v[16:31]
    ds_read_b128 v[44:47], v1 offset:11264
    s_waitcnt lgkmcnt(2)
    v_mfma_f32_32x32x16_bf16 v[16:31], v[164:167], v[8:11], v[16:31]
    ds_read_b128 v[4:7], v1 offset:12288
    s_waitcnt lgkmcnt(2)
    v_mfma_f32_32x32x16_bf16 v[16:31], v[168:171], v[40:43], v[16:31]
    ds_read_b128 v[8:11], v1 offset:13312
    s_waitcnt lgkmcnt(2)
    v_mfma_f32_32x32x16_bf16 v[16:31], v[172:175], v[44:47], v[16:31]
    ds_read_b128 v[40:43], v1 offset:14336
    s_waitcnt lgkmcnt(2)
    v_mfma_f32_32x32x16_bf16 v[16:31], v[176:179], v[4:7], v[16:31]
    ds_read_b128 v[44:47], v1 offset:15360
    s_waitcnt lgkmcnt(2)
    v_mfma_f32_32x32x16_bf16 v[16:31], v[180:183], v[8:11], v[16:31]
    s_barrier
    ds_read_b128 v[4:7], v1 offset:16384
    s_waitcnt lgkmcnt(2)
    v_mfma_f32_32x32x16_bf16 v[16:31], v[184:187], v[40:43], v[16:31]
    ds_read_b128 v[8:11], v1 offset:17408
    s_waitcnt lgkmcnt(2)
    v_mfma_f32_32x32x16_bf16 v[16:31], v[188:191], v[44:47], v[16:31]
    s_add_u32 m0, s74, 0
    s_add_u32 s51, s73, 344064
    buffer_load_dwordx4 v13, s[20:23], s51 offen lds
    ds_read_b128 v[40:43], v1 offset:18432
    s_waitcnt lgkmcnt(2)
    v_mfma_f32_32x32x16_bf16 v[16:31], v[192:195], v[4:7], v[16:31]
    ds_read_b128 v[44:47], v1 offset:19456
    s_waitcnt lgkmcnt(2)
    v_mfma_f32_32x32x16_bf16 v[16:31], v[196:199], v[8:11], v[16:31]
    s_add_u32 m0, s74, 1024
    s_add_u32 s51, s73, 372736
    buffer_load_dwordx4 v13, s[20:23], s51 offen lds
    ds_read_b128 v[4:7], v1 offset:20480
    s_waitcnt lgkmcnt(2)
    v_mfma_f32_32x32x16_bf16 v[16:31], v[200:203], v[40:43], v[16:31]
    ds_read_b128 v[8:11], v1 offset:21504
    s_waitcnt lgkmcnt(2)
    v_mfma_f32_32x32x16_bf16 v[16:31], v[204:207], v[44:47], v[16:31]
    ds_read_b128 v[40:43], v1 offset:22528
    s_waitcnt lgkmcnt(2)
    v_mfma_f32_32x32x16_bf16 v[16:31], v[208:211], v[4:7], v[16:31]
    ds_read_b128 v[44:47], v1 offset:23552
    s_waitcnt lgkmcnt(2)
    v_mfma_f32_32x32x16_bf16 v[16:31], v[212:215], v[8:11], v[16:31]
    s_barrier
    ds_read_b128 v[128:131], v2
    ds_read_b128 v[4:7], v1 offset:24576
    s_waitcnt lgkmcnt(3)
    v_mfma_f32_32x32x16_bf16 v[16:31], v[216:219], v[40:43], v[16:31]
    s_add_u32 m0, s74, 8192
    s_add_u32 s51, s73, 458752
    buffer_load_dwordx4 v13, s[20:23], s51 offen lds
    ds_read_b128 v[8:11], v1 offset:25600
    s_waitcnt lgkmcnt(3)
    v_mfma_f32_32x32x16_bf16 v[16:31], v[220:223], v[44:47], v[16:31]
    ds_read_b128 v[40:43], v1 offset:26624
    s_waitcnt lgkmcnt(2)
    v_mfma_f32_32x32x16_bf16 v[16:31], v[224:227], v[4:7], v[16:31]
    s_add_u32 m0, s74, 9216
    s_add_u32 s51, s73, 487424
    buffer_load_dwordx4 v13, s[20:23], s51 offen lds
    ds_read_b128 v[44:47], v1 offset:27648
    s_waitcnt lgkmcnt(2)
    v_mfma_f32_32x32x16_bf16 v[16:31], v[228:231], v[8:11], v[16:31]
    ds_read_b128 v[4:7], v1 offset:28672
    v_add_f32 v128, v128, v129
    v_add_f32 v130, v130, v131
    v_add_f32 v128, v128, v130
    s_waitcnt lgkmcnt(2)
    v_mfma_f32_32x32x16_bf16 v[16:31], v[232:235], v[40:43], v[16:31]
    ds_read_b128 v[8:11], v1 offset:29696
    v_mov_b32 v129, v128
    s_waitcnt lgkmcnt(2)
    v_mfma_f32_32x32x16_bf16 v[16:31], v[236:239], v[44:47], v[16:31]
    ds_read_b128 v[40:43], v1 offset:30720
    v_permlane32_swap_b32 v128, v129
    v_add_f32 v128, v128, v129
    v_sub_f32 v12, v12, v128
    s_waitcnt lgkmcnt(2)
    v_mfma_f32_32x32x16_bf16 v[16:31], v[240:243], v[4:7], v[16:31]
    ds_read_b128 v[44:47], v1 offset:31744
    v_mul_f32 v14, -0.5, v12
    s_waitcnt lgkmcnt(2)
    v_mfma_f32_32x32x16_bf16 v[16:31], v[244:247], v[8:11], v[16:31]
    s_waitcnt lgkmcnt(1)
    v_mfma_f32_32x32x16_bf16 v[16:31], v[248:251], v[40:43], v[16:31]
    s_waitcnt lgkmcnt(0)
    v_mfma_f32_32x32x16_bf16 v[16:31], v[252:255], v[44:47], v[16:31]
    s_cmp_eq_u32 s3, 1
    s_cbranch_scc0 L_c_slow
    s_nop 9
    v_pk_add_f32 v[16:17], v[16:17], v[12:13] op_sel_hi:[1,0]
    v_pk_add_f32 v[18:19], v[18:19], v[12:13] op_sel_hi:[1,0]
    v_pk_add_f32 v[20:21], v[20:21], v[12:13] op_sel_hi:[1,0]
    v_pk_add_f32 v[22:23], v[22:23], v[12:13] op_sel_hi:[1,0]
    v_cvt_pk_bf16_f32 v40, v16, v17
    v_cvt_pk_bf16_f32 v41, v18, v19
    v_cvt_pk_bf16_f32 v42, v20, v21
    v_cvt_pk_bf16_f32 v43, v22, v23
    v_min_u32 v40, -2, v40
    buffer_store_dwordx4 v[40:43], v3, s[32:35], s55 offen
    v_pk_add_f32 v[24:25], v[24:25], v[12:13] op_sel_hi:[1,0]
    v_pk_add_f32 v[26:27], v[26:27], v[12:13] op_sel_hi:[1,0]
    v_pk_add_f32 v[28:29], v[28:29], v[12:13] op_sel_hi:[1,0]
    v_pk_add_f32 v[30:31], v[30:31], v[12:13] op_sel_hi:[1,0]
    v_cvt_pk_bf16_f32 v44, v24, v25
    v_cvt_pk_bf16_f32 v45, v26, v27
    v_cvt_pk_bf16_f32 v46, v28, v29
    v_cvt_pk_bf16_f32 v47, v30, v31
    v_min_u32 v44, -2, v44
    buffer_store_dwordx4 v[44:47], v3, s[32:35], s56 offen
    s_barrier
    v_dot2_f32_bf16 v15, v40, v40, 0
    v_dot2_f32_bf16 v15, v41, v41, v15
    v_dot2_f32_bf16 v15, v42, v42, v15
    v_dot2_f32_bf16 v15, v43, v43, v15
    v_dot2_f32_bf16 v15, v44, v44, v15
    v_dot2_f32_bf16 v15, v45, v45, v15
    v_dot2_f32_bf16 v15, v46, v46, v15
    v_dot2_f32_bf16 v15, v47, v47, v15
    s_nop 2
    v_permlane32_swap_b32 v14, v15
    v_add_f32 v2, v14, v15
    v_min_u32 v2, -2, v2
    buffer_store_dword v2, v1, s[40:43], s59 offen
L_c_done:
    v_mov_b32 v192, v13
    s_lshl_b32 s59, s48, 11
    s_add_u32 s51, s59, 66048
    v_lshrrev_b32 v14, 3, v0
    v_and_b32 v15, 6, v14
    v_and_b32 v4, 7, v0
    v_xor_b32 v4, v4, v15
    v_lshlrev_b32 v4, 4, v4
    v_lshl_add_u32 v4, v14, 10, v4
    v_lshrrev_b32 v14, 2, v0
    v_lshlrev_b32 v14, 7, v14
    v_bfe_u32 v15, v0, 3, 2
    s_and_b32 s50, s48, 1
    s_lshl_b32 s50, s50, 1
    v_xor_b32 v15, s50, v15
    v_lshl_add_u32 v14, v15, 5, v14
    v_and_b32 v15, 3, v0
    v_lshlrev_b32 v15, 3, v15
    v_add3_u32 v5, v14, v15, s51
    v_xor_b32 v6, 32, v5
    v_xor_b32 v12, 64, v5
    v_xor_b32 v13, 96, v5
    s_lshl_b32 s50, s48, 2
    s_add_u32 s50, s50, 163760
    v_mov_b32 v201, s50
    v_mov_b32 v200, 163744
    s_lshr_b32 s50, s45, 3
    s_lshl_b32 s51, s44, 2
    s_add_u32 s50, s50, s51
    s_lshl_b32 s55, s50, 1
    s_mul_i32 s50, s55, 114688
    s_mul_i32 s51, s48, 28672
    s_add_u32 s50, s50, s51
    s_add_u32 s68, s50, 5242880
    s_add_u32 s69, s50, 5257216
    v_bfe_u32 v14, v0, 4, 1
    v_lshlrev_b32 v14, 9, v14
    v_and_b32 v15, 15, v0
    v_lshl_add_u32 v14, v15, 4, v14
    v_lshrrev_b32 v11, 5, v0
    v_bfe_u32 v15, v0, 4, 1
    v_lshlrev_b32 v15, 12, v15
    v_lshl_add_u32 v15, v11, 11, v15
    v_mul_u32_u24 v11, 7168, v11
    v_add_u32 v11, v11, v14
    v_bfe_u32 v14, v0, 3, 1
    v_lshl_add_u32 v15, v14, 10, v15
    v_and_b32 v14, 7, v0
    v_lshl_add_u32 v15, v14, 4, v15
    s_lshr_b32 s52, s48, 1
    s_mul_i32 s50, s52, 114688
    s_sub_u32 s51, 114688, s50
    v_add_u32 v7, s50, v11
    v_add_u32 v8, s51, v11
    v_add_u32 v9, 4096, v7
    v_add_u32 v10, 4096, v8
    v_bfe_u32 v2, v0, 2, 1
    v_lshlrev_b32 v2, 7, v2
    v_and_b32 v14, 3, v0
    v_lshl_add_u32 v2, v14, 2, v2
    v_lshrrev_b32 v14, 3, v0
    v_lshl_add_u32 v2, v14, 28, v2
    s_lshl_b32 s50, s55, 7
    s_lshl_b32 s51, s48, 4
    s_add_u32 s56, s50, s51
    s_add_u32 s56, s56, 344064
    s_add_u32 s55, s55, s52
    s_and_b32 s50, s45, 7
    s_lshl_b32 s50, s50, 1
    s_and_b32 s51, s48, 1
    s_add_u32 s50, s50, s51
    s_lshl_b32 s57, s51, 14
    s_lshl_b32 s51, s55, 15
    s_add_u32 s57, s57, s51
    s_and_b32 s52, s45, 7
    s_lshl_b32 s52, s52, 7
    s_add_u32 s57, s57, s52
    s_add_u32 s49, s57, 8192
    s_lshl_b32 s58, s50, 6
    s_add_u32 s58, s58, s51
    s_lshl_b32 s63, s55, 12
    s_add_u32 s63, s63, 393216
    v_and_b32 v14, 31, v0
    v_lshlrev_b32 v14, 10, v14
    v_lshrrev_b32 v3, 5, v0
    v_lshl_add_u32 v14, v3, 4, v14
    v_and_b32 v11, 15, v0
    v_lshl_add_u32 v11, v3, 4, v11
    v_lshlrev_b32 v11, 4, v11
    s_setprio 0
    v_mov_b32 v202, 5
    s_waitcnt vmcnt(3)
    ds_write_b32 v201, v202
    s_mov_b32 s54, 2097152
L_pg1:
    ds_read_b128 v[204:207], v200
    s_waitcnt lgkmcnt(0)
    v_min3_u32 v204, v204, v205, v206
    v_min_u32 v204, v204, v207
    v_cmp_gt_u32 vcc, 1, v204
    s_cbranch_vccz L_pg1_ok
    s_sub_u32 s54, s54, 1
    s_cbranch_scc0 L_pg1
L_pg1_ok:
    s_add_u32 m0, s74, 16384
    s_add_u32 s51, s73, 573440
    s_waitcnt vmcnt(4)
    buffer_load_dwordx4 v192, s[20:23], s51 offen lds
    s_add_u32 m0, s74, 17408
    s_add_u32 s51, s73, 602112
    s_waitcnt vmcnt(4)
    buffer_load_dwordx4 v192, s[20:23], s51 offen lds
    s_add_u32 m0, s74, 24576
    s_add_u32 s51, s73, 688128
    s_waitcnt vmcnt(4)
    buffer_load_dwordx4 v192, s[20:23], s51 offen lds
    s_add_u32 m0, s74, 25600
    s_add_u32 s51, s73, 716800
    s_waitcnt vmcnt(4)
    buffer_load_dwordx4 v192, s[20:23], s51 offen lds
    s_mov_b32 s54, 2097152
L_pg2:
    ds_read_b128 v[204:207], v200
    s_waitcnt lgkmcnt(0)
    v_min3_u32 v204, v204, v205, v206
    v_min_u32 v204, v204, v207
    v_cmp_gt_u32 vcc, 2, v204
    s_cbranch_vccz L_pg2_ok
    s_sub_u32 s54, s54, 1
    s_cbranch_scc0 L_pg2
L_pg2_ok:
    s_add_u32 m0, s74, 33280
    s_add_u32 s51, s73, 802816
    s_waitcnt vmcnt(4)
    buffer_load_dwordx4 v192, s[20:23], s51 offen lds
    s_add_u32 m0, s74, 34304
    s_add_u32 s51, s73, 831488
    s_waitcnt vmcnt(4)
    buffer_load_dwordx4 v192, s[20:23], s51 offen lds
    s_mov_b32 s54, 2097152
L_pg3:
    ds_read_b128 v[204:207], v200
    s_waitcnt lgkmcnt(0)
    v_min3_u32 v204, v204, v205, v206
    v_min_u32 v204, v204, v207
    v_cmp_gt_u32 vcc, 3, v204
    s_cbranch_vccz L_pg3_ok
    s_sub_u32 s54, s54, 1
    s_cbranch_scc0 L_pg3
L_pg3_ok:
    s_add_u32 m0, s74, 41472
    s_add_u32 s51, s73, 917504
    s_waitcnt vmcnt(4)
    buffer_load_dwordx4 v192, s[20:23], s51 offen lds
    s_add_u32 m0, s74, 42496
    s_add_u32 s51, s73, 946176
    s_waitcnt vmcnt(4)
    buffer_load_dwordx4 v192, s[20:23], s51 offen lds
    v_mov_b32 v202, 7
    s_waitcnt vmcnt(4)
    ds_write_b32 v201, v202
    s_add_u32 m0, s74, 57856
    s_add_u32 s51, s73, 1032192
    s_waitcnt vmcnt(4)
    buffer_load_dwordx4 v192, s[20:23], s51 offen lds
    s_add_u32 m0, s74, 58880
    s_add_u32 s51, s73, 1060864
    s_waitcnt vmcnt(4)
    buffer_load_dwordx4 v192, s[20:23], s51 offen lds
    s_mov_b32 s54, 2097152
L_pg4:
    ds_read_b128 v[204:207], v200
    s_waitcnt lgkmcnt(0)
    v_min3_u32 v204, v204, v205, v206
    v_min_u32 v204, v204, v207
    v_cmp_gt_u32 vcc, 4, v204
    s_cbranch_vccz L_pg4_ok
    s_sub_u32 s54, s54, 1
    s_cbranch_scc0 L_pg4
L_pg4_ok:
    s_add_u32 m0, s74, 49664
    s_add_u32 s51, s73, 1146880
    s_waitcnt vmcnt(4)
    buffer_load_dwordx4 v192, s[20:23], s51 offen lds
    s_add_u32 m0, s74, 50688
    s_add_u32 s51, s73, 1175552
    s_waitcnt vmcnt(4)
    buffer_load_dwordx4 v192, s[20:23], s51 offen lds
    v_mov_b32 v202, 9
    s_waitcnt vmcnt(4)
    ds_write_b32 v201, v202
    s_add_u32 m0, s59, 66048
    s_add_u32 s51, s75, 327680
    s_waitcnt vmcnt(4)
    buffer_load_dwordx4 v4, s[28:31], s51 offen lds
    s_add_u32 m0, s59, 67072
    s_add_u32 s51, s75, 376832
    s_waitcnt vmcnt(4)
    buffer_load_dwordx4 v4, s[28:31], s51 offen lds
    s_mov_b32 s54, 2097152
L_pg5:
    ds_read_b128 v[204:207], v200
    s_waitcnt lgkmcnt(0)
    v_min3_u32 v204, v204, v205, v206
    v_min_u32 v204, v204, v207
    v_cmp_gt_u32 vcc, 5, v204
    s_cbranch_vccz L_pg5_ok
    s_sub_u32 s54, s54, 1
    s_cbranch_scc0 L_pg5
L_pg5_ok:
    s_add_u32 m0, s74, 0
    s_add_u32 s51, s73, 1261568
    s_waitcnt vmcnt(4)
    buffer_load_dwordx4 v192, s[20:23], s51 offen lds
    s_add_u32 m0, s74, 1024
    s_add_u32 s51, s73, 1290240
    s_waitcnt vmcnt(4)
    buffer_load_dwordx4 v192, s[20:23], s51 offen lds
    s_add_u32 m0, s59, 74240
    s_add_u32 s51, s75, 335872
    s_waitcnt vmcnt(4)
    buffer_load_dwordx4 v4, s[28:31], s51 offen lds
    s_add_u32 m0, s59, 75264
    s_add_u32 s51, s75, 385024
    s_waitcnt vmcnt(4)
    buffer_load_dwordx4 v4, s[28:31], s51 offen lds
    s_mov_b32 s54, 2097152
L_pg6:
    ds_read_b128 v[204:207], v200
    s_waitcnt lgkmcnt(0)
    v_min3_u32 v204, v204, v205, v206
    v_min_u32 v204, v204, v207
    v_cmp_gt_u32 vcc, 6, v204
    s_cbranch_vccz L_pg6_ok
    s_sub_u32 s54, s54, 1
    s_cbranch_scc0 L_pg6
L_pg6_ok:
    s_add_u32 m0, s74, 8192
    s_add_u32 s51, s73, 1376256
    s_waitcnt vmcnt(4)
    buffer_load_dwordx4 v192, s[20:23], s51 offen lds
    s_add_u32 m0, s74, 9216
    s_add_u32 s51, s73, 1404928
    s_waitcnt vmcnt(4)
    buffer_load_dwordx4 v192, s[20:23], s51 offen lds
    s_waitcnt vmcnt(6)
    ds_read_b64_tr_b16 v[128:129], v5 offset:0
    ds_read_b64_tr_b16 v[132:133], v6 offset:0
    ds_read_b64_tr_b16 v[136:137], v12 offset:0
    ds_read_b64_tr_b16 v[140:141], v13 offset:0
    s_mov_b32 s54, 2097152
L_pg7:
    ds_read_b128 v[204:207], v200
    s_waitcnt lgkmcnt(0)
    v_min3_u32 v204, v204, v205, v206
    v_min_u32 v204, v204, v207
    v_cmp_gt_u32 vcc, 7, v204
    s_cbranch_vccz L_pg7_ok
    s_sub_u32 s54, s54, 1
    s_cbranch_scc0 L_pg7
L_pg7_ok:
    s_add_u32 m0, s74, 16384
    s_add_u32 s51, s73, 1490944
    s_waitcnt vmcnt(4)
    buffer_load_dwordx4 v192, s[20:23], s51 offen lds
    s_add_u32 m0, s74, 17408
    s_add_u32 s51, s73, 1519616
    s_waitcnt vmcnt(4)
    buffer_load_dwordx4 v192, s[20:23], s51 offen lds
    s_add_u32 m0, s59, 66048
    s_add_u32 s51, s75, 0
    s_waitcnt vmcnt(4)
    buffer_load_dwordx4 v4, s[28:31], s51 offen lds
    s_add_u32 m0, s59, 67072
    s_add_u32 s51, s75, 131072
    s_waitcnt vmcnt(4)
    buffer_load_dwordx4 v4, s[28:31], s51 offen lds
    s_waitcnt vmcnt(6)
    ds_read_b64_tr_b16 v[130:131], v5 offset:8192
    ds_read_b64_tr_b16 v[134:135], v6 offset:8192
    ds_read_b64_tr_b16 v[138:139], v12 offset:8192
    ds_read_b64_tr_b16 v[142:143], v13 offset:8192
    s_add_u32 m0, s59, 82432
    s_add_u32 s51, s75, 8192
    s_waitcnt vmcnt(4)
    buffer_load_dwordx4 v4, s[28:31], s51 offen lds
    s_add_u32 m0, s59, 83456
    s_add_u32 s51, s75, 139264
    s_waitcnt vmcnt(4)
    buffer_load_dwordx4 v4, s[28:31], s51 offen lds
    s_waitcnt lgkmcnt(0)
    s_add_u32 m0, s59, 74240
    s_add_u32 s51, s75, 262144
    s_waitcnt vmcnt(4)
    buffer_load_dwordx4 v4, s[28:31], s51 offen lds
    s_add_u32 m0, s59, 75264
    s_add_u32 s51, s75, 393216
    s_waitcnt vmcnt(4)
    buffer_load_dwordx4 v4, s[28:31], s51 offen lds
    s_mov_b32 s54, 2097152
L_pg8:
    ds_read_b128 v[204:207], v200
    s_waitcnt lgkmcnt(0)
    v_min3_u32 v204, v204, v205, v206
    v_min_u32 v204, v204, v207
    v_cmp_gt_u32 vcc, 8, v204
    s_cbranch_vccz L_pg8_ok
    s_sub_u32 s54, s54, 1
    s_cbranch_scc0 L_pg8
L_pg8_ok:
    s_add_u32 m0, s74, 24576
    s_add_u32 s51, s73, 1605632
    s_waitcnt vmcnt(4)
    buffer_load_dwordx4 v192, s[20:23], s51 offen lds
    s_add_u32 m0, s74, 25600
    s_add_u32 s51, s73, 1634304
    s_waitcnt vmcnt(4)
    buffer_load_dwordx4 v192, s[20:23], s51 offen lds
    s_waitcnt vmcnt(6)
    ds_read_b64_tr_b16 v[144:145], v5 offset:0
    ds_read_b64_tr_b16 v[148:149], v6 offset:0
    ds_read_b64_tr_b16 v[152:153], v12 offset:0
    ds_read_b64_tr_b16 v[156:157], v13 offset:0
    s_mov_b32 s54, 2097152
L_pg9:
    ds_read_b128 v[204:207], v200
    s_waitcnt lgkmcnt(0)
    v_min3_u32 v204, v204, v205, v206
    v_min_u32 v204, v204, v207
    v_cmp_gt_u32 vcc, 9, v204
    s_cbranch_vccz L_pg9_ok
    s_sub_u32 s54, s54, 1
    s_cbranch_scc0 L_pg9
L_pg9_ok:
    s_add_u32 m0, s74, 33280
    s_add_u32 s51, s73, 1720320
    s_waitcnt vmcnt(4)
    buffer_load_dwordx4 v192, s[20:23], s51 offen lds
    s_add_u32 m0, s74, 34304
    s_add_u32 s51, s73, 1748992
    s_waitcnt vmcnt(4)
    buffer_load_dwordx4 v192, s[20:23], s51 offen lds
    s_setprio 0
    s_add_u32 m0, s59, 66048
    s_add_u32 s51, s75, 270336
    s_waitcnt vmcnt(6)
    buffer_load_dwordx4 v4, s[28:31], s51 offen lds
    s_add_u32 m0, s59, 67072
    s_add_u32 s51, s75, 401408
    s_waitcnt vmcnt(6)
    buffer_load_dwordx4 v4, s[28:31], s51 offen lds
    s_waitcnt vmcnt(8)
    ds_read_b64_tr_b16 v[146:147], v5 offset:16384
    ds_read_b64_tr_b16 v[150:151], v6 offset:16384
    ds_read_b64_tr_b16 v[154:155], v12 offset:16384
    ds_read_b64_tr_b16 v[158:159], v13 offset:16384
    s_add_u32 m0, s59, 90624
    s_add_u32 s51, s75, 16384
    s_waitcnt vmcnt(6)
    buffer_load_dwordx4 v4, s[28:31], s51 offen lds
    s_add_u32 m0, s59, 91648
    s_add_u32 s51, s75, 147456
    s_waitcnt vmcnt(6)
    buffer_load_dwordx4 v4, s[28:31], s51 offen lds
    v_mov_b32 v202, 16
    s_waitcnt vmcnt(4)
    ds_write_b32 v201, v202
    ds_read_b64_tr_b16 v[160:161], v5 offset:8192
    ds_read_b64_tr_b16 v[164:165], v6 offset:8192
    ds_read_b64_tr_b16 v[168:169], v12 offset:8192
    ds_read_b64_tr_b16 v[172:173], v13 offset:8192
    s_add_u32 m0, s59, 98816
    s_add_u32 s51, s75, 24576
    s_waitcnt vmcnt(6)
    buffer_load_dwordx4 v4, s[28:31], s51 offen lds
    s_add_u32 m0, s59, 99840
    s_add_u32 s51, s75, 155648
    s_waitcnt vmcnt(6)
    buffer_load_dwordx4 v4, s[28:31], s51 offen lds
    s_waitcnt lgkmcnt(5)
    s_add_u32 m0, s59, 82432
    s_add_u32 s51, s75, 278528
    s_waitcnt vmcnt(6)
    buffer_load_dwordx4 v4, s[28:31], s51 offen lds
    s_add_u32 m0, s59, 83456
    s_add_u32 s51, s75, 409600
    s_waitcnt vmcnt(6)
    buffer_load_dwordx4 v4, s[28:31], s51 offen lds
    s_waitcnt vmcnt(6)
    ds_read_b64_tr_b16 v[162:163], v5 offset:0
    ds_read_b64_tr_b16 v[166:167], v6 offset:0
    ds_read_b64_tr_b16 v[170:171], v12 offset:0
    ds_read_b64_tr_b16 v[174:175], v13 offset:0
    s_waitcnt lgkmcnt(4)
    s_add_u32 m0, s59, 74240
    s_add_u32 s51, s75, 286720
    s_waitcnt vmcnt(6)
    buffer_load_dwordx4 v4, s[28:31], s51 offen lds
    s_add_u32 m0, s59, 75264
    s_add_u32 s51, s75, 417792
    s_waitcnt vmcnt(6)
    buffer_load_dwordx4 v4, s[28:31], s51 offen lds
    s_waitcnt vmcnt(6)
    ds_read_b64_tr_b16 v[176:177], v5 offset:24576
    ds_read_b64_tr_b16 v[180:181], v6 offset:24576
    ds_read_b64_tr_b16 v[184:185], v12 offset:24576
    ds_read_b64_tr_b16 v[188:189], v13 offset:24576
    s_waitcnt lgkmcnt(4)
    s_add_u32 m0, s59, 66048
    s_add_u32 s51, s75, 32768
    s_waitcnt vmcnt(6)
    buffer_load_dwordx4 v4, s[28:31], s51 offen lds
    s_add_u32 m0, s59, 67072
    s_add_u32 s51, s75, 163840
    s_waitcnt vmcnt(6)
    buffer_load_dwordx4 v4, s[28:31], s51 offen lds
    s_waitcnt vmcnt(6)
    ds_read_b64_tr_b16 v[178:179], v5 offset:32768
    ds_read_b64_tr_b16 v[182:183], v6 offset:32768
    ds_read_b64_tr_b16 v[186:187], v12 offset:32768
    ds_read_b64_tr_b16 v[190:191], v13 offset:32768
    s_waitcnt lgkmcnt(4)
    s_add_u32 m0, s59, 90624
    s_add_u32 s51, s75, 40960
    s_waitcnt vmcnt(6)
    buffer_load_dwordx4 v4, s[28:31], s51 offen lds
    s_add_u32 m0, s59, 91648
    s_add_u32 s51, s75, 172032
    s_waitcnt vmcnt(6)
    buffer_load_dwordx4 v4, s[28:31], s51 offen lds
    s_waitcnt lgkmcnt(0)
    s_add_u32 m0, s59, 98816
    s_add_u32 s51, s75, 294912
    s_waitcnt vmcnt(6)
    buffer_load_dwordx4 v4, s[28:31], s51 offen lds
    s_add_u32 m0, s59, 99840
    s_add_u32 s51, s75, 425984
    s_waitcnt vmcnt(6)
    buffer_load_dwordx4 v4, s[28:31], s51 offen lds
    s_mov_b32 s54, 2097152
L_pg20:
    ds_read_b128 v[204:207], v200
    s_waitcnt lgkmcnt(0)
    v_min3_u32 v204, v204, v205, v206
    v_min_u32 v204, v204, v207
    v_cmp_gt_u32 vcc, 20, v204
    s_cbranch_vccz L_pg20_ok
    s_sub_u32 s54, s54, 1
    s_cbranch_scc0 L_pg20
L_pg20_ok:
    s_add_u32 m0, s59, 107008
    s_add_u32 s51, s75, 303104
    s_waitcnt vmcnt(6)
    buffer_load_dwordx4 v4, s[28:31], s51 offen lds
    s_add_u32 m0, s59, 108032
    s_add_u32 s51, s75, 434176
    s_waitcnt vmcnt(6)
    buffer_load_dwordx4 v4, s[28:31], s51 offen lds
    s_add_u32 m0, s59, 115200
    s_add_u32 s51, s75, 49152
    s_waitcnt vmcnt(6)
    buffer_load_dwordx4 v4, s[28:31], s51 offen lds
    s_add_u32 m0, s59, 116224
    s_add_u32 s51, s75, 180224
    s_waitcnt vmcnt(6)
    buffer_load_dwordx4 v4, s[28:31], s51 offen lds
    s_add_u32 m0, s59, 123392
    s_add_u32 s51, s75, 57344
    s_waitcnt vmcnt(6)
    buffer_load_dwordx4 v4, s[28:31], s51 offen lds
    s_add_u32 m0, s59, 124416
    s_add_u32 s51, s75, 188416
    s_waitcnt vmcnt(6)
    buffer_load_dwordx4 v4, s[28:31], s51 offen lds
    s_add_u32 m0, s59, 131584
    s_add_u32 s51, s75, 311296
    s_waitcnt vmcnt(6)
    buffer_load_dwordx4 v4, s[28:31], s51 offen lds
    s_add_u32 m0, s59, 132608
    s_add_u32 s51, s75, 442368
    s_waitcnt vmcnt(6)
    buffer_load_dwordx4 v4, s[28:31], s51 offen lds
    s_add_u32 m0, s59, 139776
    s_add_u32 s51, s75, 319488
    s_waitcnt vmcnt(6)
    buffer_load_dwordx4 v4, s[28:31], s51 offen lds
    s_add_u32 m0, s59, 140800
    s_add_u32 s51, s75, 450560
    s_waitcnt vmcnt(6)
    buffer_load_dwordx4 v4, s[28:31], s51 offen lds
    s_setprio 2
    s_mov_b32 s54, 131072
    s_bfm_b64 exec, 8, 0
L_x4:
    buffer_load_dword v3, v2, s[40:43], s56 offen sc1
    s_waitcnt vmcnt(0)
    v_subrev_u32 v3, s36, v3
    v_subrev_u32 v3, 2, v3
    v_cmp_lt_u32 vcc, 13, v3
    s_cbranch_vccz L_x4_ok
    s_sub_u32 s54, s54, 1
    s_cbranch_scc0 L_x4
L_x4_ok:
    s_mov_b64 exec, -1
    s_setprio 0
    buffer_load_dwordx4 v[16:19], v7, s[40:43], s68 offen offset:0 sc1
    buffer_load_dwordx4 v[20:23], v7, s[40:43], s68 offen offset:256 sc1
    buffer_load_dwordx4 v[24:27], v8, s[40:43], s68 offen offset:0 sc1
    buffer_load_dwordx4 v[28:31], v8, s[40:43], s68 offen offset:256 sc1
    buffer_load_dwordx4 v[32:35], v7, s[40:43], s69 offen offset:0 sc1
    buffer_load_dwordx4 v[36:39], v7, s[40:43], s69 offen offset:256 sc1
    buffer_load_dwordx4 v[40:43], v8, s[40:43], s69 offen offset:0 sc1
    buffer_load_dwordx4 v[44:47], v8, s[40:43], s69 offen offset:256 sc1
    v_mov_b32 v4, v15
    s_waitcnt vmcnt(6)
    v_mfma_f32_16x16x32_bf16 v[192:195], v[48:51], v[16:19], 0
    v_mfma_f32_16x16x32_bf16 v[196:199], v[48:51], v[20:23], 0
    v_mfma_f32_16x16x32_bf16 v[204:207], v[52:55], v[20:23], 0
    v_mfma_f32_16x16x32_bf16 v[200:203], v[52:55], v[16:19], 0
    v_mfma_f32_16x16x32_bf16 v[208:211], v[56:59], v[16:19], 0
    v_mfma_f32_16x16x32_bf16 v[212:215], v[56:59], v[20:23], 0
    v_mfma_f32_16x16x32_bf16 v[220:223], v[60:63], v[20:23], 0
    v_mfma_f32_16x16x32_bf16 v[216:219], v[60:63], v[16:19], 0
    buffer_load_dwordx4 v[16:19], v7, s[40:43], s68 offen offset:1024 sc1
    buffer_load_dwordx4 v[20:23], v7, s[40:43], s68 offen offset:1280 sc1
    s_waitcnt vmcnt(6)
    v_mfma_f32_16x16x32_bf16 v[224:227], v[48:51], v[24:27], 0
    v_mfma_f32_16x16x32_bf16 v[228:231], v[48:51], v[28:31], 0
    v_mfma_f32_16x16x32_bf16 v[236:239], v[52:55], v[28:31], 0
    v_mfma_f32_16x16x32_bf16 v[232:235], v[52:55], v[24:27], 0
    v_mfma_f32_16x16x32_bf16 v[240:243], v[56:59], v[24:27], 0
    v_mfma_f32_16x16x32_bf16 v[244:247], v[56:59], v[28:31], 0
    v_mfma_f32_16x16x32_bf16 v[252:255], v[60:63], v[28:31], 0
    v_mfma_f32_16x16x32_bf16 v[248:251], v[60:63], v[24:27], 0
    buffer_load_dwordx4 v[24:27], v8, s[40:43], s68 offen offset:1024 sc1
    buffer_load_dwordx4 v[28:31], v8, s[40:43], s68 offen offset:1280 sc1
    s_waitcnt vmcnt(6)
    v_mfma_f32_16x16x32_bf16 v[192:195], v[64:67], v[32:35], v[192:195]
    buffer_load_dword v3, v2, s[40:43], s56 offen sc1
    v_mfma_f32_16x16x32_bf16 v[196:199], v[64:67], v[36:39], v[196:199]
    buffer_load_dwordx4 v[48:51], v7, s[40:43], s69 offen offset:1024 sc1
    buffer_load_dwordx4 v[52:55], v7, s[40:43], s69 offen offset:1280 sc1
    v_mfma_f32_16x16x32_bf16 v[204:207], v[68:71], v[36:39], v[204:207]
    buffer_load_dwordx4 v[56:59], v8, s[40:43], s69 offen offset:1024 sc1
    buffer_load_dwordx4 v[60:63], v8, s[40:43], s69 offen offset:1280 sc1
    v_mfma_f32_16x16x32_bf16 v[200:203], v[68:71], v[32:35], v[200:203]
    v_mfma_f32_16x16x32_bf16 v[208:211], v[72:75], v[32:35], v[208:211]
    v_mfma_f32_16x16x32_bf16 v[212:215], v[72:75], v[36:39], v[212:215]
    v_mfma_f32_16x16x32_bf16 v[220:223], v[76:79], v[36:39], v[220:223]
    v_mfma_f32_16x16x32_bf16 v[216:219], v[76:79], v[32:35], v[216:219]
    s_waitcnt vmcnt(9)
    v_mfma_f32_16x16x32_bf16 v[224:227], v[64:67], v[40:43], v[224:227]
    v_mfma_f32_16x16x32_bf16 v[228:231], v[64:67], v[44:47], v[228:231]
    v_mfma_f32_16x16x32_bf16 v[236:239], v[68:71], v[44:47], v[236:239]
    v_mfma_f32_16x16x32_bf16 v[232:235], v[68:71], v[40:43], v[232:235]
    v_mfma_f32_16x16x32_bf16 v[240:243], v[72:75], v[40:43], v[240:243]
    v_mfma_f32_16x16x32_bf16 v[244:247], v[72:75], v[44:47], v[244:247]
    v_mfma_f32_16x16x32_bf16 v[252:255], v[76:79], v[44:47], v[252:255]
    v_mfma_f32_16x16x32_bf16 v[248:251], v[76:79], v[40:43], v[248:251]
    s_waitcnt vmcnt(7)
    v_mfma_f32_16x16x32_bf16 v[192:195], v[80:83], v[16:19], v[192:195]
    v_mfma_f32_16x16x32_bf16 v[196:199], v[80:83], v[20:23], v[196:199]
    v_mfma_f32_16x16x32_bf16 v[204:207], v[84:87], v[20:23], v[204:207]
    v_mfma_f32_16x16x32_bf16 v[200:203], v[84:87], v[16:19], v[200:203]
    v_mfma_f32_16x16x32_bf16 v[208:211], v[88:91], v[16:19], v[208:211]
    v_mfma_f32_16x16x32_bf16 v[212:215], v[88:91], v[20:23], v[212:215]
    v_mfma_f32_16x16x32_bf16 v[220:223], v[92:95], v[20:23], v[220:223]
    v_mfma_f32_16x16x32_bf16 v[216:219], v[92:95], v[16:19], v[216:219]
    s_waitcnt vmcnt(5)
    v_mfma_f32_16x16x32_bf16 v[224:227], v[80:83], v[24:27], v[224:227]
    s_waitcnt vmcnt(4)
    v_subrev_u32 v3, s36, v3
    v_subrev_u32 v3, 4, v3
    v_cmp_lt_u32 vcc, 11, v3
    s_and_b64 vcc, vcc, 0xff
    s_cbranch_scc1 L_x4s3
L_x4r3:
    buffer_load_dwordx4 v[32:35], v7, s[40:43], s68 offen offset:2048 sc1
    buffer_load_dwordx4 v[36:39], v7, s[40:43], s68 offen offset:2304 sc1
    v_mfma_f32_16x16x32_bf16 v[228:231], v[80:83], v[28:31], v[228:231]
    buffer_load_dwordx4 v[40:43], v8, s[40:43], s68 offen offset:2048 sc1
    buffer_load_dwordx4 v[44:47], v8, s[40:43], s68 offen offset:2304 sc1
    v_mfma_f32_16x16x32_bf16 v[236:239], v[84:87], v[28:31], v[236:239]
    buffer_load_dwordx4 v[64:67], v7, s[40:43], s69 offen offset:2048 sc1
    buffer_load_dwordx4 v[68:71], v7, s[40:43], s69 offen offset:2304 sc1
    v_mfma_f32_16x16x32_bf16 v[232:235], v[84:87], v[24:27], v[232:235]
    v_mfma_f32_16x16x32_bf16 v[240:243], v[88:91], v[24:27], v[240:243]
    v_mfma_f32_16x16x32_bf16 v[244:247], v[88:91], v[28:31], v[244:247]
    v_mfma_f32_16x16x32_bf16 v[252:255], v[92:95], v[28:31], v[252:255]
    v_mfma_f32_16x16x32_bf16 v[248:251], v[92:95], v[24:27], v[248:251]
    s_waitcnt vmcnt(8)
    v_mfma_f32_16x16x32_bf16 v[192:195], v[96:99], v[48:51], v[192:195]
    buffer_load_dwordx4 v[72:75], v8, s[40:43], s69 offen offset:2048 sc1
    buffer_load_dwordx4 v[76:79], v8, s[40:43], s69 offen offset:2304 sc1
    v_mfma_f32_16x16x32_bf16 v[196:199], v[96:99], v[52:55], v[196:199]
    buffer_load_dwordx4 v[16:19], v4, s[32:35], s57 offen sc1
    buffer_load_dwordx4 v[20:23], v4, s[32:35], s49 offen sc1
    buffer_load_dword v15, v11, s[40:43], s63 offen sc1
    v_mfma_f32_16x16x32_bf16 v[204:207], v[100:103], v[52:55], v[204:207]
    v_mfma_f32_16x16x32_bf16 v[200:203], v[100:103], v[48:51], v[200:203]
    v_mfma_f32_16x16x32_bf16 v[208:211], v[104:107], v[48:51], v[208:211]
    v_mfma_f32_16x16x32_bf16 v[212:215], v[104:107], v[52:55], v[212:215]
    v_mfma_f32_16x16x32_bf16 v[220:223], v[108:111], v[52:55], v[220:223]
    v_mfma_f32_16x16x32_bf16 v[216:219], v[108:111], v[48:51], v[216:219]
    s_waitcnt vmcnt(11)
    v_mfma_f32_16x16x32_bf16 v[224:227], v[96:99], v[56:59], v[224:227]
    buffer_load_dwordx4 v[88:91], v7, s[40:43], s68 offen offset:3072 sc1
    buffer_load_dwordx4 v[92:95], v7, s[40:43], s68 offen offset:3328 sc1
    v_mfma_f32_16x16x32_bf16 v[228:231], v[96:99], v[60:63], v[228:231]
    v_mfma_f32_16x16x32_bf16 v[236:239], v[100:103], v[60:63], v[236:239]
    v_mfma_f32_16x16x32_bf16 v[232:235], v[100:103], v[56:59], v[232:235]
    v_mfma_f32_16x16x32_bf16 v[240:243], v[104:107], v[56:59], v[240:243]
    v_mfma_f32_16x16x32_bf16 v[244:247], v[104:107], v[60:63], v[244:247]
    v_mfma_f32_16x16x32_bf16 v[252:255], v[108:111], v[60:63], v[252:255]
    v_mfma_f32_16x16x32_bf16 v[248:251], v[108:111], v[56:59], v[248:251]
    s_waitcnt vmcnt(11)
    v_mfma_f32_16x16x32_bf16 v[192:195], v[112:115], v[32:35], v[192:195]
    buffer_load_dwordx4 v[48:51], v8, s[40:43], s68 offen offset:3072 sc1
    buffer_load_dwordx4 v[52:55], v8, s[40:43], s68 offen offset:3328 sc1
    v_mfma_f32_16x16x32_bf16 v[196:199], v[112:115], v[36:39], v[196:199]
    v_mfma_f32_16x16x32_bf16 v[204:207], v[116:119], v[36:39], v[204:207]
    v_mfma_f32_16x16x32_bf16 v[200:203], v[116:119], v[32:35], v[200:203]
    v_mfma_f32_16x16x32_bf16 v[208:211], v[120:123], v[32:35], v[208:211]
    v_mfma_f32_16x16x32_bf16 v[212:215], v[120:123], v[36:39], v[212:215]
    v_mfma_f32_16x16x32_bf16 v[220:223], v[124:127], v[36:39], v[220:223]
    v_mfma_f32_16x16x32_bf16 v[216:219], v[124:127], v[32:35], v[216:219]
    s_waitcnt vmcnt(11)
    v_mfma_f32_16x16x32_bf16 v[224:227], v[112:115], v[40:43], v[224:227]
    buffer_load_dword v3, v2, s[40:43], s56 offen sc1
    v_mfma_f32_16x16x32_bf16 v[228:231], v[112:115], v[44:47], v[228:231]
    buffer_load_dwordx4 v[56:59], v7, s[40:43], s69 offen offset:3072 sc1
    buffer_load_dwordx4 v[60:63], v7, s[40:43], s69 offen offset:3328 sc1
    v_mfma_f32_16x16x32_bf16 v[236:239], v[116:119], v[44:47], v[236:239]
    v_mfma_f32_16x16x32_bf16 v[232:235], v[116:119], v[40:43], v[232:235]
    v_mfma_f32_16x16x32_bf16 v[240:243], v[120:123], v[40:43], v[240:243]
    v_mfma_f32_16x16x32_bf16 v[244:247], v[120:123], v[44:47], v[244:247]
    v_mfma_f32_16x16x32_bf16 v[252:255], v[124:127], v[44:47], v[252:255]
    v_mfma_f32_16x16x32_bf16 v[248:251], v[124:127], v[40:43], v[248:251]
    s_waitcnt vmcnt(12)
    v_mfma_f32_16x16x32_bf16 v[192:195], v[128:131], v[64:67], v[192:195]
    buffer_load_dwordx4 v[96:99], v8, s[40:43], s69 offen offset:3072 sc1
    buffer_load_dwordx4 v[100:103], v8, s[40:43], s69 offen offset:3328 sc1
    v_mfma_f32_16x16x32_bf16 v[196:199], v[128:131], v[68:71], v[196:199]
    v_mfma_f32_16x16x32_bf16 v[204:207], v[132:135], v[68:71], v[204:207]
    v_mfma_f32_16x16x32_bf16 v[200:203], v[132:135], v[64:67], v[200:203]
    v_mfma_f32_16x16x32_bf16 v[208:211], v[136:139], v[64:67], v[208:211]
    v_mfma_f32_16x16x32_bf16 v[212:215], v[136:139], v[68:71], v[212:215]
    v_mfma_f32_16x16x32_bf16 v[220:223], v[140:143], v[68:71], v[220:223]
    v_mfma_f32_16x16x32_bf16 v[216:219], v[140:143], v[64:67], v[216:219]
    s_waitcnt vmcnt(12)
    v_mfma_f32_16x16x32_bf16 v[224:227], v[128:131], v[72:75], v[224:227]
    v_mfma_f32_16x16x32_bf16 v[228:231], v[128:131], v[76:79], v[228:231]
    v_mfma_f32_16x16x32_bf16 v[236:239], v[132:135], v[76:79], v[236:239]
    v_mfma_f32_16x16x32_bf16 v[232:235], v[132:135], v[72:75], v[232:235]
    v_mfma_f32_16x16x32_bf16 v[240:243], v[136:139], v[72:75], v[240:243]
    v_mfma_f32_16x16x32_bf16 v[244:247], v[136:139], v[76:79], v[244:247]
    v_mfma_f32_16x16x32_bf16 v[252:255], v[140:143], v[76:79], v[252:255]
    v_mfma_f32_16x16x32_bf16 v[248:251], v[140:143], v[72:75], v[248:251]
    s_waitcnt vmcnt(7)
    v_mfma_f32_16x16x32_bf16 v[192:195], v[144:147], v[88:91], v[192:195]
    s_waitcnt vmcnt(4)
    v_subrev_u32 v3, s36, v3
    v_subrev_u32 v3, 7, v3
    v_cmp_lt_u32 vcc, 8, v3
    s_and_b64 vcc, vcc, 0xff
    s_cbranch_scc1 L_x4s6
L_x4r6:
    buffer_load_dwordx4 v[104:107], v9, s[40:43], s68 offen offset:0 sc1
    buffer_load_dwordx4 v[108:111], v9, s[40:43], s68 offen offset:256 sc1
    v_mfma_f32_16x16x32_bf16 v[196:199], v[144:147], v[92:95], v[196:199]
    buffer_load_dwordx4 v[32:35], v10, s[40:43], s68 offen offset:0 sc1
    buffer_load_dwordx4 v[36:39], v10, s[40:43], s68 offen offset:256 sc1
    v_mfma_f32_16x16x32_bf16 v[204:207], v[148:151], v[92:95], v[204:207]
    v_mfma_f32_16x16x32_bf16 v[200:203], v[148:151], v[88:91], v[200:203]
    v_mfma_f32_16x16x32_bf16 v[208:211], v[152:155], v[88:91], v[208:211]
    v_mfma_f32_16x16x32_bf16 v[212:215], v[152:155], v[92:95], v[212:215]
    v_mfma_f32_16x16x32_bf16 v[220:223], v[156:159], v[92:95], v[220:223]
    v_mfma_f32_16x16x32_bf16 v[216:219], v[156:159], v[88:91], v[216:219]
    v_max3_u32 v24, v16, v20, v15
    v_cmp_eq_u32 vcc, -1, v24
    s_cbranch_vccnz L_hrs
L_hrr:
    v_mfma_f32_16x16x32_bf16 v[224:227], v[144:147], v[48:51], v[224:227]
    buffer_load_dwordx4 v[40:43], v9, s[40:43], s69 offen offset:0 sc1
    buffer_load_dwordx4 v[44:47], v9, s[40:43], s69 offen offset:256 sc1
    v_mfma_f32_16x16x32_bf16 v[228:231], v[144:147], v[52:55], v[228:231]
    v_mov_b32 v11, v15
    v_permlane32_swap_b32 v16, v18
    v_mfma_f32_16x16x32_bf16 v[236:239], v[148:151], v[52:55], v[236:239]
    v_permlane32_swap_b32 v17, v19
    v_permlane32_swap_b32 v20, v22
    v_mfma_f32_16x16x32_bf16 v[232:235], v[148:151], v[48:51], v[232:235]
    v_permlane32_swap_b32 v21, v23
    v_permlane32_swap_b32 v15, v11
    v_mfma_f32_16x16x32_bf16 v[240:243], v[152:155], v[48:51], v[240:243]
    v_lshlrev_b32 v24, 16, v16
    v_and_b32 v25, 0xffff0000, v16
    v_mfma_f32_16x16x32_bf16 v[244:247], v[152:155], v[52:55], v[244:247]
    v_lshlrev_b32 v26, 16, v17
    v_and_b32 v27, 0xffff0000, v17
    v_mfma_f32_16x16x32_bf16 v[252:255], v[156:159], v[52:55], v[252:255]
    v_lshlrev_b32 v28, 16, v18
    v_and_b32 v29, 0xffff0000, v18
    v_mfma_f32_16x16x32_bf16 v[248:251], v[156:159], v[48:51], v[248:251]
    s_waitcnt vmcnt(8)
    v_mfma_f32_16x16x32_bf16 v[192:195], v[160:163], v[56:59], v[192:195]
    buffer_load_dwordx4 v[112:115], v10, s[40:43], s69 offen offset:0 sc1
    buffer_load_dwordx4 v[116:119], v10, s[40:43], s69 offen offset:256 sc1
    v_mfma_f32_16x16x32_bf16 v[196:199], v[160:163], v[60:63], v[196:199]
    v_lshlrev_b32 v30, 16, v19
    v_and_b32 v31, 0xffff0000, v19
    v_mfma_f32_16x16x32_bf16 v[204:207], v[164:167], v[60:63], v[204:207]
    v_lshlrev_b32 v80, 16, v20
    v_and_b32 v81, 0xffff0000, v20
    v_mfma_f32_16x16x32_bf16 v[200:203], v[164:167], v[56:59], v[200:203]
    v_lshlrev_b32 v82, 16, v21
    v_and_b32 v83, 0xffff0000, v21
    v_mfma_f32_16x16x32_bf16 v[208:211], v[168:171], v[56:59], v[208:211]
    v_lshlrev_b32 v84, 16, v22
    v_and_b32 v85, 0xffff0000, v22
    v_mfma_f32_16x16x32_bf16 v[212:215], v[168:171], v[60:63], v[212:215]
    v_lshlrev_b32 v86, 16, v23
    v_and_b32 v87, 0xffff0000, v23
    v_mfma_f32_16x16x32_bf16 v[220:223], v[172:175], v[60:63], v[220:223]
    v_add_f32 v24, v15, v24
    v_add_f32 v25, v15, v25
    v_mfma_f32_16x16x32_bf16 v[216:219], v[172:175], v[56:59], v[216:219]
    s_waitcnt vmcnt(8)
    v_mfma_f32_16x16x32_bf16 v[224:227], v[160:163], v[96:99], v[224:227]
    ds_read_b64_tr_b16 v[120:121], v5 offset:16384
    ds_read_b64_tr_b16 v[124:125], v6 offset:16384
    v_mfma_f32_16x16x32_bf16 v[228:231], v[160:163], v[100:103], v[228:231]
    ds_read_b64_tr_b16 v[64:65], v12 offset:16384
    ds_read_b64_tr_b16 v[68:69], v13 offset:16384
    v_mfma_f32_16x16x32_bf16 v[236:239], v[164:167], v[100:103], v[236:239]
    ds_read_b64_tr_b16 v[122:123], v5 offset:8192
    ds_read_b64_tr_b16 v[126:127], v6 offset:8192
    v_mfma_f32_16x16x32_bf16 v[232:235], v[164:167], v[96:99], v[232:235]
    ds_read_b64_tr_b16 v[66:67], v12 offset:8192
    ds_read_b64_tr_b16 v[70:71], v13 offset:8192
    v_mfma_f32_16x16x32_bf16 v[240:243], v[168:171], v[96:99], v[240:243]
    buffer_load_dwordx4 v[72:75], v10, s[40:43], s68 offen offset:1024 sc1
    buffer_load_dwordx4 v[76:79], v10, s[40:43], s68 offen offset:1280 sc1
    v_mfma_f32_16x16x32_bf16 v[244:247], v[168:171], v[100:103], v[244:247]
    v_add_f32 v26, v15, v26
    v_add_f32 v27, v15, v27
    v_mfma_f32_16x16x32_bf16 v[252:255], v[172:175], v[100:103], v[252:255]
    v_add_f32 v28, v11, v28
    v_add_f32 v29, v11, v29
    v_mfma_f32_16x16x32_bf16 v[248:251], v[172:175], v[96:99], v[248:251]
    s_waitcnt vmcnt(8)
    v_mfma_f32_16x16x32_bf16 v[192:195], v[176:179], v[104:107], v[192:195]
    buffer_load_dwordx4 v[128:131], v10, s[40:43], s69 offen offset:1024 sc1
    buffer_load_dwordx4 v[132:135], v10, s[40:43], s69 offen offset:1280 sc1
    v_mfma_f32_16x16x32_bf16 v[196:199], v[176:179], v[108:111], v[196:199]
    v_add_f32 v30, v11, v30
    v_add_f32 v31, v11, v31
    v_mfma_f32_16x16x32_bf16 v[204:207], v[180:183], v[108:111], v[204:207]
    v_add_f32 v80, v15, v80
    v_add_f32 v81, v15, v81
    v_mfma_f32_16x16x32_bf16 v[200:203], v[180:183], v[104:107], v[200:203]
    v_add_f32 v82, v15, v82
    v_add_f32 v83, v15, v83
    v_mfma_f32_16x16x32_bf16 v[208:211], v[184:187], v[104:107], v[208:211]
    v_add_f32 v84, v11, v84
    v_add_f32 v85, v11, v85
    v_mfma_f32_16x16x32_bf16 v[212:215], v[184:187], v[108:111], v[212:215]
    v_add_f32 v86, v11, v86
    v_add_f32 v87, v11, v87
    v_mfma_f32_16x16x32_bf16 v[220:223], v[188:191], v[108:111], v[220:223]
    v_mfma_f32_16x16x32_bf16 v[216:219], v[188:191], v[104:107], v[216:219]
    s_waitcnt vmcnt(8)
    v_mfma_f32_16x16x32_bf16 v[224:227], v[176:179], v[32:35], v[224:227]
    ds_read_b64_tr_b16 v[136:137], v5 offset:0
    ds_read_b64_tr_b16 v[140:141], v6 offset:0
    v_mfma_f32_16x16x32_bf16 v[228:231], v[176:179], v[36:39], v[228:231]
    ds_read_b64_tr_b16 v[88:89], v12 offset:0
    ds_read_b64_tr_b16 v[92:93], v13 offset:0
    v_mfma_f32_16x16x32_bf16 v[236:239], v[180:183], v[36:39], v[236:239]
    ds_read_b64_tr_b16 v[138:139], v5 offset:24576
    ds_read_b64_tr_b16 v[142:143], v6 offset:24576
    v_mfma_f32_16x16x32_bf16 v[232:235], v[180:183], v[32:35], v[232:235]
    ds_read_b64_tr_b16 v[90:91], v12 offset:24576
    ds_read_b64_tr_b16 v[94:95], v13 offset:24576
    v_mfma_f32_16x16x32_bf16 v[240:243], v[184:187], v[32:35], v[240:243]
    buffer_load_dwordx4 v[48:51], v10, s[40:43], s68 offen offset:2048 sc1
    buffer_load_dwordx4 v[52:55], v10, s[40:43], s68 offen offset:2304 sc1
    v_mfma_f32_16x16x32_bf16 v[244:247], v[184:187], v[36:39], v[244:247]
    v_mfma_f32_16x16x32_bf16 v[252:255], v[188:191], v[36:39], v[252:255]
    v_mfma_f32_16x16x32_bf16 v[248:251], v[188:191], v[32:35], v[248:251]
    s_waitcnt vmcnt(8)
    s_waitcnt lgkmcnt(8)
    v_mfma_f32_16x16x32_bf16 v[192:195], v[120:123], v[40:43], v[192:195]
    ds_read_b64_tr_b16 v[144:145], v5 offset:32768
    ds_read_b64_tr_b16 v[148:149], v6 offset:32768
    v_mfma_f32_16x16x32_bf16 v[196:199], v[120:123], v[44:47], v[196:199]
    ds_read_b64_tr_b16 v[152:153], v12 offset:32768
    ds_read_b64_tr_b16 v[156:157], v13 offset:32768
    v_mfma_f32_16x16x32_bf16 v[204:207], v[124:127], v[44:47], v[204:207]
    ds_read_b64_tr_b16 v[146:147], v5 offset:40960
    ds_read_b64_tr_b16 v[150:151], v6 offset:40960
    v_mfma_f32_16x16x32_bf16 v[200:203], v[124:127], v[40:43], v[200:203]
    ds_read_b64_tr_b16 v[154:155], v12 offset:40960
    ds_read_b64_tr_b16 v[158:159], v13 offset:40960
    v_mfma_f32_16x16x32_bf16 v[208:211], v[64:67], v[40:43], v[208:211]
    buffer_load_dwordx4 v[56:59], v10, s[40:43], s69 offen offset:2048 sc1
    buffer_load_dwordx4 v[60:63], v10, s[40:43], s69 offen offset:2304 sc1
    v_mfma_f32_16x16x32_bf16 v[212:215], v[64:67], v[44:47], v[212:215]
    v_mfma_f32_16x16x32_bf16 v[220:223], v[68:71], v[44:47], v[220:223]
    v_mfma_f32_16x16x32_bf16 v[216:219], v[68:71], v[40:43], v[216:219]
    s_waitcnt vmcnt(8)
    v_mfma_f32_16x16x32_bf16 v[224:227], v[120:123], v[112:115], v[224:227]
    ds_read_b64_tr_b16 v[96:97], v5 offset:49152
    ds_read_b64_tr_b16 v[100:101], v6 offset:49152
    v_mfma_f32_16x16x32_bf16 v[228:231], v[120:123], v[116:119], v[228:231]
    ds_read_b64_tr_b16 v[160:161], v12 offset:49152
    ds_read_b64_tr_b16 v[164:165], v13 offset:49152
    v_mfma_f32_16x16x32_bf16 v[236:239], v[124:127], v[116:119], v[236:239]
    ds_read_b64_tr_b16 v[98:99], v5 offset:57344
    ds_read_b64_tr_b16 v[102:103], v6 offset:57344
    v_mfma_f32_16x16x32_bf16 v[232:235], v[124:127], v[112:115], v[232:235]
    ds_read_b64_tr_b16 v[162:163], v12 offset:57344
    ds_read_b64_tr_b16 v[166:167], v13 offset:57344
    v_mfma_f32_16x16x32_bf16 v[240:243], v[64:67], v[112:115], v[240:243]
    buffer_load_dwordx4 v[168:171], v9, s[40:43], s68 offen offset:1024 sc1
    buffer_load_dwordx4 v[172:175], v9, s[40:43], s68 offen offset:1280 sc1
    v_mfma_f32_16x16x32_bf16 v[244:247], v[64:67], v[116:119], v[244:247]
    v_mfma_f32_16x16x32_bf16 v[252:255], v[68:71], v[116:119], v[252:255]
    v_mfma_f32_16x16x32_bf16 v[248:251], v[68:71], v[112:115], v[248:251]
    s_waitcnt vmcnt(8)
    s_waitcnt lgkmcnt(15)
    v_mfma_f32_16x16x32_bf16 v[224:227], v[136:139], v[72:75], v[224:227]
    v_mov_b32 v4, 163744
    v_add_u32 v5, 0x8000, v5
    v_add_u32 v6, 0x8000, v6
    v_add_u32 v12, 0x8000, v12
    v_add_u32 v13, 0x8000, v13
    ds_read_b64_tr_b16 v[32:33], v5 offset:32768
    ds_read_b64_tr_b16 v[36:37], v6 offset:32768
    v_mfma_f32_16x16x32_bf16 v[228:231], v[136:139], v[76:79], v[228:231]
    ds_read_b64_tr_b16 v[176:177], v12 offset:32768
    ds_read_b64_tr_b16 v[180:181], v13 offset:32768
    v_mfma_f32_16x16x32_bf16 v[236:239], v[140:143], v[76:79], v[236:239]
    ds_read_b128 v[104:107], v4
    ds_read_b64_tr_b16 v[34:35], v5 offset:40960
    ds_read_b64_tr_b16 v[38:39], v6 offset:40960
    v_mfma_f32_16x16x32_bf16 v[232:235], v[140:143], v[72:75], v[232:235]
    ds_read_b64_tr_b16 v[178:179], v12 offset:40960
    ds_read_b64_tr_b16 v[182:183], v13 offset:40960
    v_mfma_f32_16x16x32_bf16 v[240:243], v[88:91], v[72:75], v[240:243]
    buffer_load_dwordx4 v[184:187], v9, s[40:43], s69 offen offset:1024 sc1
    buffer_load_dwordx4 v[188:191], v9, s[40:43], s69 offen offset:1280 sc1
    v_mfma_f32_16x16x32_bf16 v[244:247], v[88:91], v[76:79], v[244:247]
    v_mfma_f32_16x16x32_bf16 v[252:255], v[92:95], v[76:79], v[252:255]
    v_mfma_f32_16x16x32_bf16 v[248:251], v[92:95], v[72:75], v[248:251]
    s_waitcnt vmcnt(8)
    s_waitcnt lgkmcnt(15)
    v_mfma_f32_16x16x32_bf16 v[224:227], v[144:147], v[128:131], v[224:227]
    buffer_load_dwordx4 v[16:19], v9, s[40:43], s68 offen offset:2048 sc1
    buffer_load_dwordx4 v[20:23], v9, s[40:43], s68 offen offset:2304 sc1
    v_mfma_f32_16x16x32_bf16 v[228:231], v[144:147], v[132:135], v[228:231]
    v_mfma_f32_16x16x32_bf16 v[236:239], v[148:151], v[132:135], v[236:239]
    v_mfma_f32_16x16x32_bf16 v[232:235], v[148:151], v[128:131], v[232:235]
    v_mfma_f32_16x16x32_bf16 v[240:243], v[152:155], v[128:131], v[240:243]
    v_mfma_f32_16x16x32_bf16 v[244:247], v[152:155], v[132:135], v[244:247]
    v_mfma_f32_16x16x32_bf16 v[252:255], v[156:159], v[132:135], v[252:255]
    v_mfma_f32_16x16x32_bf16 v[248:251], v[156:159], v[128:131], v[248:251]
    s_waitcnt lgkmcnt(4)
    v_min3_u32 v104, v104, v105, v106
    v_min_u32 v104, v104, v107
    v_cmp_gt_u32 vcc, 30, v104
    s_cbranch_vccnz L_mds
L_mdr:
    s_waitcnt vmcnt(8)
    v_mfma_f32_16x16x32_bf16 v[224:227], v[96:99], v[48:51], v[224:227]
    buffer_load_dwordx4 v[40:43], v9, s[40:43], s69 offen offset:2048 sc1
    buffer_load_dwordx4 v[44:47], v9, s[40:43], s69 offen offset:2304 sc1
    v_mfma_f32_16x16x32_bf16 v[228:231], v[96:99], v[52:55], v[228:231]
    s_xor_b32 s50, s48, 0
    s_mul_i32 s50, s50, 12288
    s_add_u32 s50, s50, 0
    v_add_u32 v5, s50, v1
    v_mfma_f32_16x16x32_bf16 v[236:239], v[100:103], v[52:55], v[236:239]
    s_xor_b32 s50, s48, 1
    s_mul_i32 s50, s50, 12288
    s_add_u32 s50, s50, 0
    v_add_u32 v6, s50, v1
    v_mfma_f32_16x16x32_bf16 v[232:235], v[100:103], v[48:51], v[232:235]
    s_xor_b32 s50, s48, 2
    s_mul_i32 s50, s50, 12288
    s_add_u32 s50, s50, 0
    v_add_u32 v12, s50, v1
    v_mfma_f32_16x16x32_bf16 v[240:243], v[160:163], v[48:51], v[240:243]
    s_xor_b32 s50, s48, 3
    s_mul_i32 s50, s50, 12288
    s_add_u32 s50, s50, 0
    v_add_u32 v13, s50, v1
    v_mfma_f32_16x16x32_bf16 v[244:247], v[160:163], v[52:55], v[244:247]
    v_mfma_f32_16x16x32_bf16 v[252:255], v[164:167], v[52:55], v[252:255]
    v_mfma_f32_16x16x32_bf16 v[248:251], v[164:167], v[48:51], v[248:251]
    s_waitcnt vmcnt(8)
    s_waitcnt lgkmcnt(0)
    v_mfma_f32_16x16x32_bf16 v[224:227], v[32:35], v[56:59], v[224:227]
    v_mfma_f32_16x16x32_bf16 v[228:231], v[32:35], v[60:63], v[228:231]
    v_mfma_f32_16x16x32_bf16 v[236:239], v[36:39], v[60:63], v[236:239]
    v_mfma_f32_16x16x32_bf16 v[232:235], v[36:39], v[56:59], v[232:235]
    v_mfma_f32_16x16x32_bf16 v[240:243], v[176:179], v[56:59], v[240:243]
    v_mfma_f32_16x16x32_bf16 v[244:247], v[176:179], v[60:63], v[244:247]
    v_mfma_f32_16x16x32_bf16 v[252:255], v[180:183], v[60:63], v[252:255]
    v_mfma_f32_16x16x32_bf16 v[248:251], v[180:183], v[56:59], v[248:251]
    s_waitcnt vmcnt(6)
    v_mfma_f32_16x16x32_bf16 v[208:211], v[88:91], v[168:171], v[208:211]
    v_mfma_f32_16x16x32_bf16 v[212:215], v[88:91], v[172:175], v[212:215]
    ds_write_b128 v12, v[224:227] offset:4096
    v_mfma_f32_16x16x32_bf16 v[220:223], v[92:95], v[172:175], v[220:223]
    v_mfma_f32_16x16x32_bf16 v[216:219], v[92:95], v[168:171], v[216:219]
    ds_write_b128 v12, v[228:231] offset:5120
    s_waitcnt vmcnt(4)
    v_mfma_f32_16x16x32_bf16 v[208:211], v[152:155], v[184:187], v[208:211]
    v_mfma_f32_16x16x32_bf16 v[212:215], v[152:155], v[188:191], v[212:215]
    v_mfma_f32_16x16x32_bf16 v[220:223], v[156:159], v[188:191], v[220:223]
    ds_write_b128 v12, v[236:239] offset:7168
    v_mfma_f32_16x16x32_bf16 v[216:219], v[156:159], v[184:187], v[216:219]
    s_waitcnt vmcnt(2)
    v_mfma_f32_16x16x32_bf16 v[208:211], v[160:163], v[16:19], v[208:211]
    ds_write_b128 v12, v[232:235] offset:6144
    v_mfma_f32_16x16x32_bf16 v[212:215], v[160:163], v[20:23], v[212:215]
    v_mfma_f32_16x16x32_bf16 v[220:223], v[164:167], v[20:23], v[220:223]
    v_mfma_f32_16x16x32_bf16 v[216:219], v[164:167], v[16:19], v[216:219]
    ds_write_b128 v13, v[240:243] offset:8192
    s_waitcnt vmcnt(0)
    v_mfma_f32_16x16x32_bf16 v[208:211], v[176:179], v[40:43], v[208:211]
    v_mfma_f32_16x16x32_bf16 v[212:215], v[176:179], v[44:47], v[212:215]
    ds_write_b128 v13, v[244:247] offset:9216
    v_mfma_f32_16x16x32_bf16 v[220:223], v[180:183], v[44:47], v[220:223]
    v_mfma_f32_16x16x32_bf16 v[216:219], v[180:183], v[40:43], v[216:219]
    v_mfma_f32_16x16x32_bf16 v[192:195], v[136:139], v[168:171], v[192:195]
    ds_write_b128 v13, v[252:255] offset:11264
    v_mfma_f32_16x16x32_bf16 v[196:199], v[136:139], v[172:175], v[196:199]
    v_mfma_f32_16x16x32_bf16 v[204:207], v[140:143], v[172:175], v[204:207]
    ds_write_b128 v13, v[248:251] offset:10240
    v_mfma_f32_16x16x32_bf16 v[200:203], v[140:143], v[168:171], v[200:203]
    v_mfma_f32_16x16x32_bf16 v[192:195], v[144:147], v[184:187], v[192:195]
    ds_write_b128 v6, v[208:211] offset:0
    v_mfma_f32_16x16x32_bf16 v[196:199], v[144:147], v[188:191], v[196:199]
    v_mfma_f32_16x16x32_bf16 v[204:207], v[148:151], v[188:191], v[204:207]
    ds_write_b128 v6, v[212:215] offset:1024
    v_mfma_f32_16x16x32_bf16 v[200:203], v[148:151], v[184:187], v[200:203]
    v_mfma_f32_16x16x32_bf16 v[192:195], v[96:99], v[16:19], v[192:195]
    ds_write_b128 v6, v[220:223] offset:3072
    v_mfma_f32_16x16x32_bf16 v[196:199], v[96:99], v[20:23], v[196:199]
    v_mfma_f32_16x16x32_bf16 v[204:207], v[100:103], v[20:23], v[204:207]
    ds_write_b128 v6, v[216:219] offset:2048
    v_mfma_f32_16x16x32_bf16 v[200:203], v[100:103], v[16:19], v[200:203]
    v_mfma_f32_16x16x32_bf16 v[192:195], v[32:35], v[40:43], v[192:195]
    v_mfma_f32_16x16x32_bf16 v[196:199], v[32:35], v[44:47], v[196:199]
    v_mfma_f32_16x16x32_bf16 v[204:207], v[36:39], v[44:47], v[204:207]
    v_mfma_f32_16x16x32_bf16 v[200:203], v[36:39], v[40:43], v[200:203]
    s_waitcnt lgkmcnt(0)
    s_barrier
    ds_read_b128 v[208:211], v5 offset:0
    ds_read_b128 v[224:227], v5 offset:4096
    ds_read_b128 v[240:243], v5 offset:8192
    ds_read_b128 v[212:215], v5 offset:1024
    ds_read_b128 v[228:231], v5 offset:5120
    ds_read_b128 v[244:247], v5 offset:9216
    ds_read_b128 v[216:219], v5 offset:2048
    ds_read_b128 v[232:235], v5 offset:6144
    ds_read_b128 v[248:251], v5 offset:10240
    ds_read_b128 v[220:223], v5 offset:3072
    ds_read_b128 v[236:239], v5 offset:7168
    ds_read_b128 v[252:255], v5 offset:11264
    v_pk_add_f32 v[192:193], v[192:193], v[24:25]
    v_pk_add_f32 v[194:195], v[194:195], v[26:27]
    v_pk_add_f32 v[196:197], v[196:197], v[28:29]
    v_pk_add_f32 v[198:199], v[198:199], v[30:31]
    v_pk_add_f32 v[200:201], v[200:201], v[80:81]
    v_pk_add_f32 v[202:203], v[202:203], v[82:83]
    v_pk_add_f32 v[204:205], v[204:205], v[84:85]
    v_pk_add_f32 v[206:207], v[206:207], v[86:87]
    s_waitcnt lgkmcnt(9)
    v_pk_add_f32 v[192:193], v[192:193], v[208:209]
    v_pk_add_f32 v[224:225], v[224:225], v[240:241]
    v_pk_add_f32 v[194:195], v[194:195], v[210:211]
    v_pk_add_f32 v[226:227], v[226:227], v[242:243]
    v_pk_add_f32 v[192:193], v[192:193], v[224:225]
    v_pk_add_f32 v[194:195], v[194:195], v[226:227]
    v_cvt_pk_bf16_f32 v24, v192, v193
    v_cvt_pk_bf16_f32 v25, v194, v195
    s_waitcnt lgkmcnt(6)
    v_pk_add_f32 v[196:197], v[196:197], v[212:213]
    v_pk_add_f32 v[228:229], v[228:229], v[244:245]
    v_pk_add_f32 v[198:199], v[198:199], v[214:215]
    v_pk_add_f32 v[230:231], v[230:231], v[246:247]
    v_pk_add_f32 v[196:197], v[196:197], v[228:229]
    v_pk_add_f32 v[198:199], v[198:199], v[230:231]
    v_cvt_pk_bf16_f32 v26, v196, v197
    v_cvt_pk_bf16_f32 v27, v198, v199
    s_nop 1
    v_permlane16_swap_b32 v24, v26
    v_permlane16_swap_b32 v25, v27
    buffer_store_dwordx4 v[24:27], v14, s[32:35], s58 offen offset:0
    s_waitcnt lgkmcnt(3)
    v_pk_add_f32 v[200:201], v[200:201], v[216:217]
    v_pk_add_f32 v[232:233], v[232:233], v[248:249]
    v_pk_add_f32 v[202:203], v[202:203], v[218:219]
    v_pk_add_f32 v[234:235], v[234:235], v[250:251]
    v_pk_add_f32 v[200:201], v[200:201], v[232:233]
    v_pk_add_f32 v[202:203], v[202:203], v[234:235]
    v_cvt_pk_bf16_f32 v80, v200, v201
    v_cvt_pk_bf16_f32 v81, v202, v203
    s_waitcnt lgkmcnt(0)
    v_pk_add_f32 v[204:205], v[204:205], v[220:221]
    v_pk_add_f32 v[236:237], v[236:237], v[252:253]
    v_pk_add_f32 v[206:207], v[206:207], v[222:223]
    v_pk_add_f32 v[238:239], v[238:239], v[254:255]
    v_pk_add_f32 v[204:205], v[204:205], v[236:237]
    v_pk_add_f32 v[206:207], v[206:207], v[238:239]
    v_cvt_pk_bf16_f32 v82, v204, v205
    v_cvt_pk_bf16_f32 v83, v206, v207
    s_nop 1
    v_permlane16_swap_b32 v80, v82
    v_permlane16_swap_b32 v81, v83
    buffer_store_dwordx4 v[80:83], v14, s[32:35], s58 offen offset:32
L_end:
    s_endpgm
L_a2s:
    s_mov_b32 s54, 131072
L_a2l:
    buffer_load_dwordx4 v[48:51], v4, s[16:19], s70 offen offset:0 sc1
    buffer_load_dwordx4 v[52:55], v4, s[16:19], s70 offen offset:2048 sc1
    buffer_load_dwordx4 v[56:59], v4, s[16:19], s68 offen offset:128 sc1
    buffer_load_dwordx4 v[60:63], v4, s[16:19], s68 offen offset:2176 sc1
    buffer_load_dwordx4 v[64:67], v4, s[16:19], s70 offen offset:128 sc1
    buffer_load_dwordx4 v[68:71], v4, s[16:19], s70 offen offset:2176 sc1
    s_waitcnt vmcnt(0)
    v_max_u32 v13, v48, v52
    v_cmp_eq_u32 vcc, -1, v13
    s_cbranch_vccz L_a2r
    s_sub_u32 s54, s54, 1
    s_cbranch_scc0 L_a2l
    s_branch L_a2r
L_a4s:
    s_mov_b32 s54, 131072
L_a4l:
    buffer_load_dwordx4 v[56:59], v4, s[16:19], s68 offen offset:128 sc1
    buffer_load_dwordx4 v[60:63], v4, s[16:19], s68 offen offset:2176 sc1
    buffer_load_dwordx4 v[64:67], v4, s[16:19], s70 offen offset:128 sc1
    buffer_load_dwordx4 v[68:71], v4, s[16:19], s70 offen offset:2176 sc1
    s_waitcnt vmcnt(0)
    v_max3_u32 v13, v56, v60, v64
    v_max_u32 v13, v13, v68
    v_cmp_eq_u32 vcc, -1, v13
    s_cbranch_vccz L_a4r
    s_sub_u32 s54, s54, 1
    s_cbranch_scc0 L_a4l
    s_branch L_a4r
L_ld5s:
    s_mov_b32 s54, 2097152
L_ld5:
    ds_read_b128 v[20:23], v15
    s_waitcnt lgkmcnt(0)
    v_min3_u32 v20, v20, v21, v22
    v_min_u32 v20, v20, v23
    v_cmp_gt_u32 vcc, 5, v20
    s_cbranch_vccz L_ld5_ok
    s_sub_u32 s54, s54, 1
    s_cbranch_scc0 L_ld5
L_ld5_ok:
    s_branch L_ld5r
L_a8s:
    s_mov_b32 s54, 131072
L_a8l:
    buffer_load_dwordx4 v[72:75], v4, s[16:19], s68 offen offset:256 sc1
    buffer_load_dwordx4 v[76:79], v4, s[16:19], s68 offen offset:2304 sc1
    buffer_load_dwordx4 v[80:83], v4, s[16:19], s70 offen offset:256 sc1
    buffer_load_dwordx4 v[84:87], v4, s[16:19], s70 offen offset:2304 sc1
    buffer_load_dwordx4 v[88:91], v4, s[16:19], s68 offen offset:384 sc1
    buffer_load_dwordx4 v[92:95], v4, s[16:19], s68 offen offset:2432 sc1
    buffer_load_dwordx4 v[96:99], v4, s[16:19], s70 offen offset:384 sc1
    buffer_load_dwordx4 v[100:103], v4, s[16:19], s70 offen offset:2432 sc1
    s_waitcnt vmcnt(0)
    v_max3_u32 v13, v72, v76, v80
    v_max_u32 v13, v13, v84
    v_cmp_eq_u32 vcc, -1, v13
    s_cbranch_vccz L_a8r
    s_sub_u32 s54, s54, 1
    s_cbranch_scc0 L_a8l
    s_branch L_a8r
L_ld7s:
    s_mov_b32 s54, 2097152
L_ld7:
    ds_read_b128 v[20:23], v15
    s_waitcnt lgkmcnt(0)
    v_min3_u32 v20, v20, v21, v22
    v_min_u32 v20, v20, v23
    v_cmp_gt_u32 vcc, 7, v20
    s_cbranch_vccz L_ld7_ok
    s_sub_u32 s54, s54, 1
    s_cbranch_scc0 L_ld7
L_ld7_ok:
    s_branch L_ld7r
L_a12s:
    s_mov_b32 s54, 131072
L_a12l:
    buffer_load_dwordx4 v[88:91], v4, s[16:19], s68 offen offset:384 sc1
    buffer_load_dwordx4 v[92:95], v4, s[16:19], s68 offen offset:2432 sc1
    buffer_load_dwordx4 v[96:99], v4, s[16:19], s70 offen offset:384 sc1
    buffer_load_dwordx4 v[100:103], v4, s[16:19], s70 offen offset:2432 sc1
    s_waitcnt vmcnt(0)
    v_max3_u32 v13, v88, v92, v96
    v_max_u32 v13, v13, v100
    v_cmp_eq_u32 vcc, -1, v13
    s_cbranch_vccz L_a12r
    s_sub_u32 s54, s54, 1
    s_cbranch_scc0 L_a12l
    s_branch L_a12r
L_ld9s:
    s_mov_b32 s54, 2097152
L_ld9:
    ds_read_b128 v[20:23], v15
    s_waitcnt lgkmcnt(0)
    v_min3_u32 v20, v20, v21, v22
    v_min_u32 v20, v20, v23
    v_cmp_gt_u32 vcc, 9, v20
    s_cbranch_vccz L_ld9_ok
    s_sub_u32 s54, s54, 1
    s_cbranch_scc0 L_ld9
L_ld9_ok:
    s_branch L_ld9r
L_a16s:
    s_mov_b32 s54, 131072
L_a16l:
    buffer_load_dwordx4 v[104:107], v4, s[16:19], s68 offen offset:512 sc1
    buffer_load_dwordx4 v[108:111], v4, s[16:19], s68 offen offset:2560 sc1
    buffer_load_dwordx4 v[40:43], v4, s[16:19], s70 offen offset:512 sc1
    buffer_load_dwordx4 v[44:47], v4, s[16:19], s70 offen offset:2560 sc1
    buffer_load_dwordx4 v[48:51], v4, s[16:19], s68 offen offset:640 sc1
    buffer_load_dwordx4 v[52:55], v4, s[16:19], s68 offen offset:2688 sc1
    buffer_load_dwordx4 v[56:59], v4, s[16:19], s70 offen offset:640 sc1
    buffer_load_dwordx4 v[60:63], v4, s[16:19], s70 offen offset:2688 sc1
    s_waitcnt vmcnt(0)
    v_max3_u32 v13, v104, v108, v40
    v_max_u32 v13, v13, v44
    v_cmp_eq_u32 vcc, -1, v13
    s_cbranch_vccz L_a16r
    s_sub_u32 s54, s54, 1
    s_cbranch_scc0 L_a16l
    s_branch L_a16r
L_a20s:
    s_mov_b32 s54, 131072
L_a20l:
    buffer_load_dwordx4 v[48:51], v4, s[16:19], s68 offen offset:640 sc1
    buffer_load_dwordx4 v[52:55], v4, s[16:19], s68 offen offset:2688 sc1
    buffer_load_dwordx4 v[56:59], v4, s[16:19], s70 offen offset:640 sc1
    buffer_load_dwordx4 v[60:63], v4, s[16:19], s70 offen offset:2688 sc1
    s_waitcnt vmcnt(0)
    v_max3_u32 v13, v48, v52, v56
    v_max_u32 v13, v13, v60
    v_cmp_eq_u32 vcc, -1, v13
    s_cbranch_vccz L_a20r
    s_sub_u32 s54, s54, 1
    s_cbranch_scc0 L_a20l
    s_branch L_a20r
L_a24s:
    s_mov_b32 s54, 131072
L_a24l:
    buffer_load_dwordx4 v[64:67], v4, s[16:19], s68 offen offset:768 sc1
    buffer_load_dwordx4 v[68:71], v4, s[16:19], s68 offen offset:2816 sc1
    buffer_load_dwordx4 v[72:75], v4, s[16:19], s70 offen offset:768 sc1
    buffer_load_dwordx4 v[76:79], v4, s[16:19], s70 offen offset:2816 sc1
    buffer_load_dwordx4 v[80:83], v4, s[16:19], s68 offen offset:896 sc1
    buffer_load_dwordx4 v[84:87], v4, s[16:19], s68 offen offset:2944 sc1
    buffer_load_dwordx4 v[88:91], v4, s[16:19], s70 offen offset:896 sc1
    buffer_load_dwordx4 v[92:95], v4, s[16:19], s70 offen offset:2944 sc1
    s_waitcnt vmcnt(0)
    v_max3_u32 v13, v64, v68, v72
    v_max_u32 v13, v13, v76
    v_cmp_eq_u32 vcc, -1, v13
    s_cbranch_vccz L_a24r
    s_sub_u32 s54, s54, 1
    s_cbranch_scc0 L_a24l
    s_branch L_a24r
L_sts:
    s_mov_b32 s54, 131072
L_stl:
    buffer_load_dwordx4 v[28:31], v5, s[40:43], s25 offen offset:512 sc1
    buffer_load_dwordx4 v[32:35], v5, s[40:43], s25 offen offset:768 sc1
    s_waitcnt vmcnt(0)
    v_max3_u32 v36, v28, v29, v30
    v_max3_u32 v36, v36, v31, v32
    v_max3_u32 v36, v36, v33, v34
    v_max_u32 v36, v36, v35
    v_cmp_eq_u32 vcc, -1, v36
    s_cbranch_vccz L_str
    s_sub_u32 s54, s54, 1
    s_cbranch_scc0 L_stl
    s_branch L_str
L_a28s:
    s_mov_b32 s54, 131072
L_a28l:
    buffer_load_dwordx4 v[80:83], v4, s[16:19], s68 offen offset:896 sc1
    buffer_load_dwordx4 v[84:87], v4, s[16:19], s68 offen offset:2944 sc1
    buffer_load_dwordx4 v[88:91], v4, s[16:19], s70 offen offset:896 sc1
    buffer_load_dwordx4 v[92:95], v4, s[16:19], s70 offen offset:2944 sc1
    s_waitcnt vmcnt(0)
    v_max3_u32 v13, v80, v84, v88
    v_max_u32 v13, v13, v92
    v_cmp_eq_u32 vcc, -1, v13
    s_cbranch_vccz L_a28r
    s_sub_u32 s54, s54, 1
    s_cbranch_scc0 L_a28l
    s_branch L_a28r
L_ld16s:
    s_mov_b32 s54, 2097152
L_ld16:
    ds_read_b128 v[20:23], v15
    s_waitcnt lgkmcnt(0)
    v_min3_u32 v20, v20, v21, v22
    v_min_u32 v20, v20, v23
    v_cmp_gt_u32 vcc, 16, v20
    s_cbranch_vccz L_ld16_ok
    s_sub_u32 s54, s54, 1
    s_cbranch_scc0 L_ld16
L_ld16_ok:
    s_branch L_ld16r
L_x4s3:
    s_mov_b32 s54, 131072
    s_bfm_b64 exec, 8, 0
L_x4p3:
    buffer_load_dword v3, v2, s[40:43], s56 offen sc1
    s_waitcnt vmcnt(0)
    v_subrev_u32 v3, s36, v3
    v_subrev_u32 v3, 4, v3
    v_cmp_lt_u32 vcc, 11, v3
    s_cbranch_vccz L_x4p3_ok
    s_sub_u32 s54, s54, 1
    s_cbranch_scc0 L_x4p3
L_x4p3_ok:
    s_mov_b64 exec, -1
    s_branch L_x4r3
L_x4s6:
    s_mov_b32 s54, 131072
    s_bfm_b64 exec, 8, 0
L_x4p6:
    buffer_load_dword v3, v2, s[40:43], s56 offen sc1
    s_waitcnt vmcnt(0)
    v_subrev_u32 v3, s36, v3
    v_subrev_u32 v3, 7, v3
    v_cmp_lt_u32 vcc, 8, v3
    s_cbranch_vccz L_x4p6_ok
    s_sub_u32 s54, s54, 1
    s_cbranch_scc0 L_x4p6
L_x4p6_ok:
    s_mov_b64 exec, -1
    s_branch L_x4r6
L_hrs:
    s_mov_b32 s54, 131072
L_hrl:
    buffer_load_dwordx4 v[16:19], v4, s[32:35], s57 offen sc1
    buffer_load_dwordx4 v[20:23], v4, s[32:35], s49 offen sc1
    buffer_load_dword v15, v11, s[40:43], s63 offen sc1
    s_waitcnt vmcnt(0)
    v_max3_u32 v24, v16, v20, v15
    v_cmp_eq_u32 vcc, -1, v24
    s_cbranch_vccz L_hrr
    s_sub_u32 s54, s54, 1
    s_cbranch_scc0 L_hrl
    s_branch L_hrr
L_mds:
    s_mov_b32 s54, 2097152
L_md:
    ds_read_b128 v[104:107], v4
    s_waitcnt lgkmcnt(0)
    v_min3_u32 v104, v104, v105, v106
    v_min_u32 v104, v104, v107
    v_cmp_gt_u32 vcc, 30, v104
    s_cbranch_vccz L_md_ok
    s_sub_u32 s54, s54, 1
    s_cbranch_scc0 L_md
L_md_ok:
    s_branch L_mdr
.p2align 12
L_main:
    s_setprio 1
    s_load_dwordx2 s[8:9], s[0:1], 8
    s_load_dwordx2 s[16:17], s[0:1], 72
    v_and_b32 v12, 15, v0
    v_lshlrev_b32 v12, 2, v12
    v_add_u32 v12, 163744, v12
    v_mov_b32 v13, 0
    ds_write_b32 v12, v13
    s_mov_b32 s10, 524288
    s_mov_b32 s11, 0x20000
    s_mov_b32 s14, 16384
    s_mov_b32 s15, 0x20000
    s_mov_b32 s42, 12582912
    s_mov_b32 s43, 0x20000
    s_mov_b32 s60, 0x3f803f80
    v_lshrrev_b32 v10, 2, v0
    v_lshlrev_b32 v10, 10, v10
    v_and_b32 v11, 3, v0
    v_lshlrev_b32 v17, 7, v0
    v_lshlrev_b32 v11, 4, v11
    s_lshl_b32 s50, s47, 8
    s_lshl_b32 s51, s48, 6
    s_add_u32 s50, s50, s51
    v_add3_u32 v2, v10, v11, s50
    v_lshlrev_b32 v7, 4, v0
    s_mul_i32 s55, s48, 23552
    s_add_u32 s55, s55, 67072
    s_lshr_b32 s56, s45, 2
    s_lshl_b32 s57, s56, 16
    s_lshl_b32 s50, s56, 1
    s_and_b32 s51, s47, 1
    s_add_u32 s50, s50, s51
    s_lshl_b32 s50, s50, 2
    s_add_u32 s50, s50, s48
    s_lshl_b32 s50, s50, 8
    s_lshl_b32 s51, s45, 2
    s_add_u32 s51, s51, s48
    s_lshl_b32 s52, s51, 7
    s_mul_i32 s51, s51, 4096
    s_lshl_b32 s53, s44, 14
    s_add_u32 s52, s52, s53
    s_add_u32 s52, s52, 131072
    s_lshl_b32 s53, s44, 7
    s_add_u32 s53, s53, 294912
    s_waitcnt lgkmcnt(0)
    s_load_dword s36, s[40:41], 295936
    s_barrier
    s_mov_b64 exec, 3
    buffer_load_dword v254, v17, s[12:15], s50 offen
    s_mov_b64 exec, 1
    buffer_load_dword v253, off, s[40:43], s52 sc1
    buffer_load_dword v252, off, s[40:43], s53 sc1
    s_bfm_b64 exec, 8, 0
    buffer_load_dword v248, v17, s[8:11], s51 offen
    s_mov_b64 exec, -1
    v_lshrrev_b32 v10, 5, v0
    v_lshlrev_b32 v11, 9, v10
    v_bfe_u32 v13, v0, 2, 2
    v_lshl_add_u32 v11, v13, 6, v11
    v_bfe_u32 v13, v0, 4, 1
    v_lshl_add_u32 v11, v13, 5, v11
    v_and_b32 v13, 3, v0
    v_lshl_add_u32 v11, v13, 3, v11
    v_add_u32 v3, s55, v11
    v_mul_u32_u24 v11, 528, v10
    v_and_b32 v13, 31, v0
    v_lshl_add_u32 v11, v13, 4, v11
    v_add_u32 v4, 33280, v11
    v_mov_b32 v18, 163776
    v_lshlrev_b32 v16, 2, v0
    v_lshrrev_b32 v20, 4, v0
    v_and_b32 v13, 15, v0
    v_lshlrev_b32 v14, 8, v20
    v_lshl_add_u32 v249, v13, 3, v14
    s_and_b32 s50, s47, 1
    s_lshl_b32 s51, s50, 8
    s_add_u32 s52, s51, 33280
    v_mul_u32_u24 v15, 528, v20
    v_lshl_add_u32 v15, v13, 4, v15
    v_add_u32 v250, s52, v15
    s_lshl_b32 s52, s50, 9
    s_add_u32 s52, s52, 1024
    s_cmp_ge_u32 s47, 2
    s_cselect_b32 s51, s52, s51
    s_cselect_b32 s52, 31, 9
    s_cselect_b32 s53, 8, 31
    v_and_b32 v14, 1, v20
    v_lshlrev_b32 v14, s52, v14
    v_lshrrev_b32 v15, 1, v20
    v_lshlrev_b32 v15, s53, v15
    v_lshl_add_u32 v14, v13, 4, v14
    v_add3_u32 v251, v14, v15, s51
    s_lshl_b32 s31, s46, 11
    s_add_u32 s32, s31, 131072
    s_add_u32 s31, s31, 0
    s_lshl_b32 s50, s44, 5
    s_add_u32 s50, s50, s45
    s_lshl_b32 s34, s50, 2
    s_add_u32 s34, s34, 294912
    s_lshl_b32 s33, s50, 7
    s_add_u32 s33, s33, 262144
    s_lshl_b32 s50, s46, 4
    s_lshl_b32 s51, s47, 2
    s_add_u32 s50, s50, s51
    s_add_u32 s52, s50, s48
    s_lshl_b32 s20, s52, 11
    s_xor_b32 s20, s20, 2048
    s_add_u32 s20, s20, 1048576
    s_lshl_b32 s21, s52, 8
    s_add_u32 s21, s21, 786432
    s_lshr_b32 s50, s45, 4
    s_lshl_b32 s51, s44, 1
    s_add_u32 s51, s51, s50
    s_lshl_b32 s51, s51, 2
    s_add_u32 s28, s51, s48
    s_lshl_b32 s51, s28, 15
    s_add_u32 s68, s51, 0
    s_add_u32 s69, s51, 8192
    s_add_u32 s70, s51, 16384
    s_add_u32 s71, s51, 24576
    s_mov_b32 s18, 2097152
    s_mov_b32 s19, 0x20000
    s_lshl_b32 s25, s28, 12
    s_add_u32 s25, s25, 393216
    s_and_b32 s50, s45, 15
    s_mul_i32 s26, s28, 114688
    s_mul_i32 s51, s50, 7168
    s_add_u32 s26, s26, s51
    s_add_u32 s26, s26, 5242880
    s_add_u32 s27, s26, 4096
    s_and_b32 s30, s48, 1
    s_mul_i32 s30, s30, 2080
    s_lshl_b32 s51, s28, 7
    s_lshl_b32 s50, s50, 2
    s_add_u32 s24, s51, s50
    s_add_u32 s24, s24, 344064
    s_mov_b32 s29, 0
    s_xor_b32 s59, s48, 1
    s_lshl_b32 s58, s59, 11
    s_lshl_b32 s59, s59, 7
    s_add_u32 s59, s59, 163072
    s_lshl_b32 s22, s48, 2
    s_add_u32 s22, s22, 156160
    v_cmp_eq_u32 vcc, 0, v0
    v_mov_b32 v160, 0x80000000
    v_add_u32 v162, s58, v7
    v_cndmask_b32_e64 v160, v160, 0, vcc
    v_lshrrev_b32 v13, 5, v0
    v_lshlrev_b32 v14, 6, v13
    v_add_u32 v163, s59, v14
    v_lshlrev_b32 v164, 2, v0
    v_add_u32 v165, s22, v7
    v_xor_b32 v167, 2048, v162
    v_mov_b32 v6, 0xdddddddd
    v_and_b32 v12, 31, v0
    v_lshrrev_b32 v13, 5, v0
    v_lshl_add_u32 v13, v13, 4, v12
    v_lshlrev_b32 v13, 4, v13
    v_and_b32 v14, 27, v0
    v_cmp_eq_u32 vcc, 16, v14
    v_mov_b32 v14, 2064
    v_mov_b32 v15, 2048
    v_cndmask_b32 v14, v14, v15, vcc
    v_cmp_gt_u32 vcc, 16, v12
    v_add_u32 v15, 1024, v13
    v_add_u32 v13, 1536, v13
    v_cndmask_b32 v8, v14, v15, vcc
    v_cndmask_b32 v9, v14, v13, vcc
    v_add_u32 v8, s30, v8
    v_add_u32 v9, s30, v9
    v_add_u32 v166, s30, v7
    v_mov_b32 v10, 163584
    v_mov_b32 v40, 0
    v_mov_b32 v41, 0
    v_mov_b32 v42, 0
    v_mov_b32 v43, 0
    v_mov_b32 v44, 0
    v_mov_b32 v45, 0
    v_mov_b32 v46, 0
    v_mov_b32 v47, 0
    v_mov_b32 v48, 0
    v_mov_b32 v49, 0
    v_mov_b32 v50, 0
    v_mov_b32 v51, 0
    v_mov_b32 v52, 0
    v_mov_b32 v53, 0
    v_mov_b32 v54, 0
    v_mov_b32 v55, 0
    v_mov_b32 v56, 0
    v_mov_b32 v57, 0
    v_mov_b32 v58, 0
    v_mov_b32 v59, 0
    v_mov_b32 v60, 0
    v_mov_b32 v61, 0
    v_mov_b32 v62, 0
    v_mov_b32 v63, 0
    v_mov_b32 v64, 0
    v_mov_b32 v65, 0
    v_mov_b32 v66, 0
    v_mov_b32 v67, 0
    v_mov_b32 v68, 0
    v_mov_b32 v69, 0
    v_mov_b32 v70, 0
    v_mov_b32 v71, 0
    v_mov_b32 v72, 0
    v_mov_b32 v73, 0
    v_mov_b32 v74, 0
    v_mov_b32 v75, 0
    v_mov_b32 v76, 0
    v_mov_b32 v77, 0
    v_mov_b32 v78, 0
    v_mov_b32 v79, 0
    v_mov_b32 v80, 0
    v_mov_b32 v81, 0
    v_mov_b32 v82, 0
    v_mov_b32 v83, 0
    v_mov_b32 v84, 0
    v_mov_b32 v85, 0
    v_mov_b32 v86, 0
    v_mov_b32 v87, 0
    v_mov_b32 v88, 0
    v_mov_b32 v89, 0
    v_mov_b32 v90, 0
    v_mov_b32 v91, 0
    v_mov_b32 v92, 0
    v_mov_b32 v93, 0
    v_mov_b32 v94, 0
    v_mov_b32 v95, 0
    v_mov_b32 v96, 0
    v_mov_b32 v97, 0
    v_mov_b32 v98, 0
    v_mov_b32 v99, 0
    v_mov_b32 v100, 0
    v_mov_b32 v101, 0
    v_mov_b32 v102, 0
    v_mov_b32 v103, 0
    s_waitcnt lgkmcnt(0)
    s_and_b32 s36, s36, 0xfffffff0
    s_add_u32 s36, s36, 0x9e3779b0
    s_add_u32 s37, s36, 1
    s_getreg_b32 s49, hwreg(HW_REG_XCC_ID, 0, 4)
    s_add_u32 s49, s49, s36
    s_barrier
    s_add_u32 m0, s55, 0
    s_xor_b32 s51, s57, 0
    buffer_load_dwordx4 v2, s[8:11], s51 offen lds
    s_add_u32 m0, s55, 1024
    s_xor_b32 s51, s57, 16384
    buffer_load_dwordx4 v2, s[8:11], s51 offen lds
    s_add_u32 m0, s55, 2048
    s_xor_b32 s51, s57, 32768
    buffer_load_dwordx4 v2, s[8:11], s51 offen lds
    s_add_u32 m0, s55, 3072
    s_xor_b32 s51, s57, 49152
    buffer_load_dwordx4 v2, s[8:11], s51 offen lds
    s_add_u32 m0, s55, 4096
    s_xor_b32 s51, s57, 65536
    buffer_load_dwordx4 v2, s[8:11], s51 offen lds
    s_add_u32 m0, s55, 5120
    s_xor_b32 s51, s57, 81920
    buffer_load_dwordx4 v2, s[8:11], s51 offen lds
    s_cmp_gt_u32 s48, 0
    s_cbranch_scc1 L_nokv
    s_mov_b32 s54, 2097152
L_wc0:
    ds_read_b128 v[20:23], v18
    s_waitcnt lgkmcnt(0)
    v_min3_u32 v20, v20, v21, v22
    v_min_u32 v20, v20, v23
    v_cmp_gt_u32 vcc, 1, v20
    s_cbranch_vccz L_wc0_ok
    s_sub_u32 s54, s54, 1
    s_cbranch_scc0 L_wc0
L_wc0_ok:
    ds_read_b64_tr_b16 v[168:169], v249 offset:16640
    ds_read_b64_tr_b16 v[170:171], v249 offset:16768
    ds_read_b64_tr_b16 v[172:173], v249 offset:17664
    ds_read_b64_tr_b16 v[174:175], v249 offset:17792
    ds_read_b64_tr_b16 v[176:177], v249 offset:18688
    ds_read_b64_tr_b16 v[178:179], v249 offset:18816
    ds_read_b64_tr_b16 v[180:181], v249 offset:19712
    ds_read_b64_tr_b16 v[182:183], v249 offset:19840
    ds_read_b64_tr_b16 v[184:185], v249 offset:20736
    ds_read_b64_tr_b16 v[186:187], v249 offset:20864
    ds_read_b64_tr_b16 v[188:189], v249 offset:21760
    ds_read_b64_tr_b16 v[190:191], v249 offset:21888
    ds_read_b64_tr_b16 v[192:193], v249 offset:22784
    ds_read_b64_tr_b16 v[194:195], v249 offset:22912
    ds_read_b64_tr_b16 v[196:197], v249 offset:23808
    ds_read_b64_tr_b16 v[198:199], v249 offset:23936
    ds_read_b64_tr_b16 v[200:201], v249 offset:24832
    ds_read_b64_tr_b16 v[202:203], v249 offset:24960
    ds_read_b64_tr_b16 v[204:205], v249 offset:25856
    ds_read_b64_tr_b16 v[206:207], v249 offset:25984
    ds_read_b64_tr_b16 v[208:209], v249 offset:26880
    ds_read_b64_tr_b16 v[210:211], v249 offset:27008
    ds_read_b64_tr_b16 v[212:213], v249 offset:27904
    ds_read_b64_tr_b16 v[214:215], v249 offset:28032
    ds_read_b64_tr_b16 v[216:217], v249 offset:28928
    ds_read_b64_tr_b16 v[218:219], v249 offset:29056
    ds_read_b64_tr_b16 v[220:221], v249 offset:29952
    ds_read_b64_tr_b16 v[222:223], v249 offset:30080
    ds_read_b64_tr_b16 v[224:225], v249 offset:30976
    ds_read_b64_tr_b16 v[226:227], v249 offset:31104
    ds_read_b64_tr_b16 v[228:229], v249 offset:32000
    ds_read_b64_tr_b16 v[230:231], v249 offset:32128
    s_mov_b32 s54, 2097152
L_xc0:
    ds_read_b128 v[20:23], v18
    s_waitcnt lgkmcnt(0)
    v_min3_u32 v20, v20, v21, v22
    v_min_u32 v20, v20, v23
    v_cmp_gt_u32 vcc, 2, v20
    s_cbranch_vccz L_xc0_ok
    s_sub_u32 s54, s54, 1
    s_cbranch_scc0 L_xc0
L_xc0_ok:
    s_setprio 3
    ds_read_b128 v[112:115], v250 offset:0
    ds_read_b128 v[116:119], v250 offset:2112
    ds_read_b128 v[120:123], v250 offset:4224
    ds_read_b128 v[124:127], v250 offset:6336
    ds_read_b128 v[128:131], v250 offset:8448
    ds_read_b128 v[132:135], v250 offset:10560
    ds_read_b128 v[136:139], v250 offset:12672
    ds_read_b128 v[140:143], v250 offset:14784
    s_cmp_ge_u32 s47, 2
    s_cbranch_scc1 L_vjob
    ds_read_b128 v[232:235], v250 offset:16896
    ds_read_b128 v[236:239], v250 offset:19008
    s_waitcnt lgkmcnt(9)
    v_mfma_f32_16x16x32_bf16 v[144:147], v[168:171], v[112:115], 0
    ds_read_b128 v[240:243], v250 offset:21120
    ds_read_b128 v[244:247], v250 offset:23232
    s_waitcnt lgkmcnt(10)
    v_mfma_f32_16x16x32_bf16 v[144:147], v[172:175], v[116:119], v[144:147]
    ds_read_b128 v[24:27], v250 offset:25344
    ds_read_b128 v[28:31], v250 offset:27456
    s_waitcnt lgkmcnt(11)
    v_mfma_f32_16x16x32_bf16 v[144:147], v[176:179], v[120:123], v[144:147]
    ds_read_b128 v[32:35], v250 offset:29568
    ds_read_b128 v[36:39], v250 offset:31680
    s_waitcnt lgkmcnt(12)
    v_mfma_f32_16x16x32_bf16 v[144:147], v[180:183], v[124:127], v[144:147]
    s_waitcnt lgkmcnt(11)
    v_mfma_f32_16x16x32_bf16 v[144:147], v[184:187], v[128:131], v[144:147]
    s_waitcnt lgkmcnt(10)
    v_mfma_f32_16x16x32_bf16 v[144:147], v[188:191], v[132:135], v[144:147]
    s_waitcnt lgkmcnt(9)
    v_mfma_f32_16x16x32_bf16 v[144:147], v[192:195], v[136:139], v[144:147]
    s_waitcnt lgkmcnt(8)
    v_mfma_f32_16x16x32_bf16 v[144:147], v[196:199], v[140:143], v[144:147]
    s_waitcnt lgkmcnt(7)
    v_mfma_f32_16x16x32_bf16 v[144:147], v[200:203], v[232:235], v[144:147]
    s_waitcnt lgkmcnt(6)
    v_mfma_f32_16x16x32_bf16 v[144:147], v[204:207], v[236:239], v[144:147]
    s_waitcnt lgkmcnt(5)
    v_mfma_f32_16x16x32_bf16 v[144:147], v[208:211], v[240:243], v[144:147]
    s_waitcnt lgkmcnt(4)
    v_mfma_f32_16x16x32_bf16 v[144:147], v[212:215], v[244:247], v[144:147]
    s_waitcnt lgkmcnt(3)
    v_mfma_f32_16x16x32_bf16 v[144:147], v[216:219], v[24:27], v[144:147]
    s_waitcnt lgkmcnt(2)
    v_mfma_f32_16x16x32_bf16 v[144:147], v[220:223], v[28:31], v[144:147]
    s_waitcnt lgkmcnt(1)
    v_mfma_f32_16x16x32_bf16 v[144:147], v[224:227], v[32:35], v[144:147]
    s_waitcnt lgkmcnt(0)
    v_mfma_f32_16x16x32_bf16 v[144:147], v[228:231], v[36:39], v[144:147]
    s_nop 7
    v_mul_f32 v144, 0x3eb8aa3b, v144
    v_mul_f32 v145, 0x3eb8aa3b, v145
    v_mul_f32 v146, 0x3eb8aa3b, v146
    v_mul_f32 v147, 0x3eb8aa3b, v147
    v_cvt_pk_bf16_f32 v148, v144, v145
    v_cvt_pk_bf16_f32 v149, v146, v147
    v_cvt_pk_bf16_f32 v150, v144, v145
    v_cvt_pk_bf16_f32 v151, v146, v147
    s_nop 0
    v_permlane32_swap_b32 v148, v150
    v_permlane32_swap_b32 v149, v151
    s_branch L_kvst
L_vjob:
    ds_read_b128 v[232:235], v250 offset:16896
    ds_read_b128 v[236:239], v250 offset:19008
    s_waitcnt lgkmcnt(9)
    v_mfma_f32_16x16x32_bf16 v[144:147], v[112:115], v[168:171], 0
    ds_read_b128 v[240:243], v250 offset:21120
    ds_read_b128 v[244:247], v250 offset:23232
    s_waitcnt lgkmcnt(10)
    v_mfma_f32_16x16x32_bf16 v[144:147], v[116:119], v[172:175], v[144:147]
    ds_read_b128 v[24:27], v250 offset:25344
    ds_read_b128 v[28:31], v250 offset:27456
    s_waitcnt lgkmcnt(11)
    v_mfma_f32_16x16x32_bf16 v[144:147], v[120:123], v[176:179], v[144:147]
    ds_read_b128 v[32:35], v250 offset:29568
    ds_read_b128 v[36:39], v250 offset:31680
    s_waitcnt lgkmcnt(12)
    v_mfma_f32_16x16x32_bf16 v[144:147], v[124:127], v[180:183], v[144:147]
    s_waitcnt lgkmcnt(11)
    v_mfma_f32_16x16x32_bf16 v[144:147], v[128:131], v[184:187], v[144:147]
    s_waitcnt lgkmcnt(10)
    v_mfma_f32_16x16x32_bf16 v[144:147], v[132:135], v[188:191], v[144:147]
    s_waitcnt lgkmcnt(9)
    v_mfma_f32_16x16x32_bf16 v[144:147], v[136:139], v[192:195], v[144:147]
    s_waitcnt lgkmcnt(8)
    v_mfma_f32_16x16x32_bf16 v[144:147], v[140:143], v[196:199], v[144:147]
    s_waitcnt lgkmcnt(7)
    v_mfma_f32_16x16x32_bf16 v[144:147], v[232:235], v[200:203], v[144:147]
    s_waitcnt lgkmcnt(6)
    v_mfma_f32_16x16x32_bf16 v[144:147], v[236:239], v[204:207], v[144:147]
    s_waitcnt lgkmcnt(5)
    v_mfma_f32_16x16x32_bf16 v[144:147], v[240:243], v[208:211], v[144:147]
    s_waitcnt lgkmcnt(4)
    v_mfma_f32_16x16x32_bf16 v[144:147], v[244:247], v[212:215], v[144:147]
    s_waitcnt lgkmcnt(3)
    v_mfma_f32_16x16x32_bf16 v[144:147], v[24:27], v[216:219], v[144:147]
    s_waitcnt lgkmcnt(2)
    v_mfma_f32_16x16x32_bf16 v[144:147], v[28:31], v[220:223], v[144:147]
    s_waitcnt lgkmcnt(1)
    v_mfma_f32_16x16x32_bf16 v[144:147], v[32:35], v[224:227], v[144:147]
    s_waitcnt lgkmcnt(0)
    v_mfma_f32_16x16x32_bf16 v[144:147], v[36:39], v[228:231], v[144:147]
    s_nop 7
    v_cvt_pk_bf16_f32 v148, v144, v145
    v_cvt_pk_bf16_f32 v149, v146, v147
    v_cvt_pk_bf16_f32 v150, v144, v145
    v_cvt_pk_bf16_f32 v151, v146, v147
    s_nop 0
    v_permlane16_swap_b32 v148, v150
    v_permlane16_swap_b32 v149, v151
L_kvst:
    buffer_store_dwordx4 v[148:151], v251, s[40:43], s32 offen
    buffer_store_dwordx4 v[148:151], v251, s[40:43], s31 offen sc1
L_kvx:
    s_setprio 1
L_nokv:
    s_waitcnt vmcnt(5)
    ds_read_b64_tr_b16 v[168:169], v3 offset:0
    ds_read_b64_tr_b16 v[170:171], v3 offset:256
    s_add_u32 m0, s55, 6144
    s_xor_b32 s51, s57, 98304
    buffer_load_dwordx4 v2, s[8:11], s51 offen lds
    s_waitcnt vmcnt(5)
    ds_read_b64_tr_b16 v[172:173], v3 offset:1024
    ds_read_b64_tr_b16 v[174:175], v3 offset:1280
    s_add_u32 m0, s55, 7168
    s_xor_b32 s51, s57, 114688
    buffer_load_dwordx4 v2, s[8:11], s51 offen lds
    s_waitcnt vmcnt(5)
    ds_read_b64_tr_b16 v[176:177], v3 offset:2048
    ds_read_b64_tr_b16 v[178:179], v3 offset:2304
    s_add_u32 m0, s55, 8192
    s_xor_b32 s51, s57, 131072
    buffer_load_dwordx4 v2, s[8:11], s51 offen lds
    s_waitcnt vmcnt(5)
    ds_read_b64_tr_b16 v[180:181], v3 offset:3072
    ds_read_b64_tr_b16 v[182:183], v3 offset:3328
    s_add_u32 m0, s55, 9216
    s_xor_b32 s51, s57, 147456
    buffer_load_dwordx4 v2, s[8:11], s51 offen lds
    s_cmp_lg_u32 s48, 0
    s_cbranch_scc1 L_nofl0
    v_mov_b32 v19, s49
    s_bfm_b64 exec, 1, 0
    s_waitcnt vmcnt(5)
    buffer_store_dword v19, v16, s[40:43], s34 offen
    s_mov_b64 exec, -1
L_nofl0:
    s_waitcnt vmcnt(5)
    ds_read_b64_tr_b16 v[184:185], v3 offset:4096
    ds_read_b64_tr_b16 v[186:187], v3 offset:4352
    s_add_u32 m0, s55, 10240
    s_xor_b32 s51, s57, 163840
    buffer_load_dwordx4 v2, s[8:11], s51 offen lds
    s_cmp_lg_u32 s48, 0
    s_cbranch_scc1 L_nofl1
    v_mov_b32 v19, s37
    s_bfm_b64 exec, 32, 0
    s_waitcnt vmcnt(6)
    buffer_store_dword v19, v16, s[40:43], s33 offen sc1
    s_mov_b64 exec, -1
L_nofl1:
    s_waitcnt vmcnt(5)
    ds_read_b64_tr_b16 v[188:189], v3 offset:5120
    ds_read_b64_tr_b16 v[190:191], v3 offset:5376
    s_add_u32 m0, s55, 11264
    s_xor_b32 s51, s57, 180224
    buffer_load_dwordx4 v2, s[8:11], s51 offen lds
    s_add_u32 m0, s55, 12288
    s_xor_b32 s51, s57, 196608
    buffer_load_dwordx4 v2, s[8:11], s51 offen lds
    s_waitcnt vmcnt(6)
    ds_read_b64_tr_b16 v[192:193], v3 offset:6144
    ds_read_b64_tr_b16 v[194:195], v3 offset:6400
    s_add_u32 m0, s55, 13312
    s_xor_b32 s51, s57, 212992
    buffer_load_dwordx4 v2, s[8:11], s51 offen lds
    s_add_u32 m0, s55, 14336
    s_xor_b32 s51, s57, 229376
    buffer_load_dwordx4 v2, s[8:11], s51 offen lds
    s_waitcnt vmcnt(7)
    ds_read_b64_tr_b16 v[196:197], v3 offset:7168
    ds_read_b64_tr_b16 v[198:199], v3 offset:7424
    s_add_u32 m0, s55, 15360
    s_xor_b32 s51, s57, 245760
    buffer_load_dwordx4 v2, s[8:11], s51 offen lds
    s_add_u32 m0, s55, 16384
    s_xor_b32 s51, s57, 262144
    buffer_load_dwordx4 v2, s[8:11], s51 offen lds
    s_mov_b32 s54, 2097152
L_xc:
    ds_read_b128 v[20:23], v18
    s_waitcnt lgkmcnt(0)
    v_min3_u32 v20, v20, v21, v22
    v_min_u32 v20, v20, v23
    v_cmp_gt_u32 vcc, 3, v20
    s_cbranch_vccz L_xc_ok
    s_sub_u32 s54, s54, 1
    s_cbranch_scc0 L_xc
L_xc_ok:
    s_xor_b32 s51, s56, 0
    s_mul_i32 s51, s51, 4224
    v_add_u32 v5, s51, v4
    ds_read_b128 v[112:115], v5 offset:0
    ds_read_b128 v[116:119], v5 offset:1056
    ds_read_b128 v[120:123], v5 offset:2112
    ds_read_b128 v[124:127], v5 offset:3168
    s_waitcnt vmcnt(8)
    ds_read_b64_tr_b16 v[200:201], v3 offset:8192
    ds_read_b64_tr_b16 v[202:203], v3 offset:8448
    s_add_u32 m0, s55, 17408
    s_xor_b32 s51, s57, 278528
    buffer_load_dwordx4 v2, s[8:11], s51 offen lds
    s_add_u32 m0, s55, 18432
    s_xor_b32 s51, s57, 294912
    buffer_load_dwordx4 v2, s[8:11], s51 offen lds
    s_waitcnt lgkmcnt(5)
    v_mfma_f32_32x32x16_bf16 v[144:159], v[168:171], v[112:115], 0
    s_xor_b32 s51, s56, 1
    s_mul_i32 s51, s51, 4224
    v_add_u32 v5, s51, v4
    ds_read_b128 v[128:131], v5 offset:0
    v_mov_b32 v161, s37
    s_waitcnt lgkmcnt(5)
    v_mfma_f32_32x32x16_bf16 v[144:159], v[172:175], v[116:119], v[144:159]
    ds_read_b128 v[132:135], v5 offset:1056
    s_waitcnt vmcnt(9)
    ds_read_b64_tr_b16 v[204:205], v3 offset:9216
    ds_read_b64_tr_b16 v[206:207], v3 offset:9472
    s_add_u32 m0, s55, 19456
    s_xor_b32 s51, s57, 311296
    buffer_load_dwordx4 v2, s[8:11], s51 offen lds
    s_add_u32 m0, s55, 20480
    s_xor_b32 s51, s57, 327680
    buffer_load_dwordx4 v2, s[8:11], s51 offen lds
    s_waitcnt lgkmcnt(7)
    v_mfma_f32_32x32x16_bf16 v[144:159], v[176:179], v[120:123], v[144:159]
    ds_read_b128 v[136:139], v5 offset:2112
    s_waitcnt lgkmcnt(7)
    v_mfma_f32_32x32x16_bf16 v[144:159], v[180:183], v[124:127], v[144:159]
    ds_read_b128 v[140:143], v5 offset:3168
    s_waitcnt vmcnt(10)
    ds_read_b64_tr_b16 v[208:209], v3 offset:10240
    ds_read_b64_tr_b16 v[210:211], v3 offset:10496
    s_add_u32 m0, s55, 21504
    s_xor_b32 s51, s57, 344064
    buffer_load_dwordx4 v2, s[8:11], s51 offen lds
    s_waitcnt lgkmcnt(7)
    v_mfma_f32_32x32x16_bf16 v[144:159], v[184:187], v[128:131], v[144:159]
    s_xor_b32 s51, s56, 2
    s_mul_i32 s51, s51, 4224
    v_add_u32 v5, s51, v4
    ds_read_b128 v[112:115], v5 offset:0
    s_waitcnt lgkmcnt(7)
    v_mfma_f32_32x32x16_bf16 v[144:159], v[188:191], v[132:135], v[144:159]
    ds_read_b128 v[116:119], v5 offset:1056
    s_waitcnt vmcnt(10)
    ds_read_b64_tr_b16 v[212:213], v3 offset:11264
    ds_read_b64_tr_b16 v[214:215], v3 offset:11520
    s_add_u32 m0, s55, 22528
    s_xor_b32 s51, s57, 360448
    buffer_load_dwordx4 v2, s[8:11], s51 offen lds
    s_waitcnt lgkmcnt(7)
    v_mfma_f32_32x32x16_bf16 v[144:159], v[192:195], v[136:139], v[144:159]
    ds_read_b128 v[120:123], v5 offset:2112
    s_waitcnt lgkmcnt(7)
    v_mfma_f32_32x32x16_bf16 v[144:159], v[196:199], v[140:143], v[144:159]
    ds_read_b128 v[124:127], v5 offset:3168
    s_waitcnt vmcnt(10)
    ds_read_b64_tr_b16 v[216:217], v3 offset:12288
    ds_read_b64_tr_b16 v[218:219], v3 offset:12544
    s_add_u32 m0, s55, 0
    s_xor_b32 s51, s57, 376832
    buffer_load_dwordx4 v2, s[8:11], s51 offen lds
    s_waitcnt lgkmcnt(7)
    v_mfma_f32_32x32x16_bf16 v[144:159], v[200:203], v[112:115], v[144:159]
    s_xor_b32 s51, s56, 3
    s_mul_i32 s51, s51, 4224
    v_add_u32 v5, s51, v4
    ds_read_b128 v[128:131], v5 offset:0
    s_waitcnt lgkmcnt(7)
    v_mfma_f32_32x32x16_bf16 v[144:159], v[204:207], v[116:119], v[144:159]
    ds_read_b128 v[132:135], v5 offset:1056
    s_waitcnt vmcnt(10)
    ds_read_b64_tr_b16 v[220:221], v3 offset:13312
    ds_read_b64_tr_b16 v[222:223], v3 offset:13568
    s_add_u32 m0, s55, 1024
    s_xor_b32 s51, s57, 393216
    buffer_load_dwordx4 v2, s[8:11], s51 offen lds
    s_waitcnt lgkmcnt(7)
    v_mfma_f32_32x32x16_bf16 v[144:159], v[208:211], v[120:123], v[144:159]
    ds_read_b128 v[136:139], v5 offset:2112
    s_waitcnt lgkmcnt(7)
    v_mfma_f32_32x32x16_bf16 v[144:159], v[212:215], v[124:127], v[144:159]
    ds_read_b128 v[140:143], v5 offset:3168
    s_waitcnt vmcnt(10)
    ds_read_b64_tr_b16 v[224:225], v3 offset:14336
    ds_read_b64_tr_b16 v[226:227], v3 offset:14592
    s_add_u32 m0, s55, 2048
    s_xor_b32 s51, s57, 409600
    buffer_load_dwordx4 v2, s[8:11], s51 offen lds
    s_waitcnt lgkmcnt(7)
    v_mfma_f32_32x32x16_bf16 v[144:159], v[216:219], v[128:131], v[144:159]
    s_xor_b32 s51, s56, 4
    s_mul_i32 s51, s51, 4224
    v_add_u32 v5, s51, v4
    ds_read_b128 v[112:115], v5 offset:0
    s_waitcnt vmcnt(10)
    ds_read_b64_tr_b16 v[228:229], v3 offset:15360
    ds_read_b64_tr_b16 v[230:231], v3 offset:15616
    s_add_u32 m0, s55, 3072
    s_xor_b32 s51, s57, 425984
    buffer_load_dwordx4 v2, s[8:11], s51 offen lds
    s_waitcnt lgkmcnt(9)
    s_waitcnt lgkmcnt(7)
    v_mfma_f32_32x32x16_bf16 v[144:159], v[220:223], v[132:135], v[144:159]
    ds_read_b128 v[116:119], v5 offset:1056
    s_waitcnt vmcnt(10)
    ds_read_b64_tr_b16 v[232:233], v3 offset:16384
    ds_read_b64_tr_b16 v[234:235], v3 offset:16640
    s_add_u32 m0, s55, 4096
    s_xor_b32 s51, s57, 442368
    buffer_load_dwordx4 v2, s[8:11], s51 offen lds
    s_waitcnt lgkmcnt(9)
    s_waitcnt lgkmcnt(6)
    v_mfma_f32_32x32x16_bf16 v[144:159], v[224:227], v[136:139], v[144:159]
    ds_read_b128 v[120:123], v5 offset:2112
    s_waitcnt vmcnt(10)
    ds_read_b64_tr_b16 v[236:237], v3 offset:17408
    ds_read_b64_tr_b16 v[238:239], v3 offset:17664
    s_add_u32 m0, s55, 5120
    s_xor_b32 s51, s57, 458752
    buffer_load_dwordx4 v2, s[8:11], s51 offen lds
    s_waitcnt lgkmcnt(6)
    v_mfma_f32_32x32x16_bf16 v[144:159], v[228:231], v[140:143], v[144:159]
    ds_read_b128 v[124:127], v5 offset:3168
    s_waitcnt vmcnt(10)
    ds_read_b64_tr_b16 v[240:241], v3 offset:18432
    ds_read_b64_tr_b16 v[242:243], v3 offset:18688
    s_add_u32 m0, s55, 6144
    s_xor_b32 s51, s57, 475136
    buffer_load_dwordx4 v2, s[8:11], s51 offen lds
    s_waitcnt lgkmcnt(6)
    v_mfma_f32_32x32x16_bf16 v[144:159], v[232:235], v[112:115], v[144:159]
    s_xor_b32 s51, s56, 5
    s_mul_i32 s51, s51, 4224
    v_add_u32 v5, s51, v4
    ds_read_b128 v[128:131], v5 offset:0
    s_waitcnt vmcnt(10)
    ds_read_b64_tr_b16 v[244:245], v3 offset:19456
    ds_read_b64_tr_b16 v[246:247], v3 offset:19712
    s_add_u32 m0, s55, 7168
    s_xor_b32 s51, s57, 491520
    buffer_load_dwordx4 v2, s[8:11], s51 offen lds
    s_waitcnt lgkmcnt(6)
    v_mfma_f32_32x32x16_bf16 v[144:159], v[236:239], v[116:119], v[144:159]
    ds_read_b128 v[132:135], v5 offset:1056
    s_waitcnt vmcnt(10)
    ds_read_b64_tr_b16 v[168:169], v3 offset:20480
    ds_read_b64_tr_b16 v[170:171], v3 offset:20736
    s_add_u32 m0, s55, 8192
    s_xor_b32 s51, s57, 507904
    buffer_load_dwordx4 v2, s[8:11], s51 offen lds
    s_waitcnt lgkmcnt(6)
    v_mfma_f32_32x32x16_bf16 v[144:159], v[240:243], v[120:123], v[144:159]
    ds_read_b128 v[136:139], v5 offset:2112
    s_waitcnt vmcnt(10)
    ds_read_b64_tr_b16 v[172:173], v3 offset:21504
    ds_read_b64_tr_b16 v[174:175], v3 offset:21760
    s_waitcnt lgkmcnt(6)
    v_mfma_f32_32x32x16_bf16 v[144:159], v[244:247], v[124:127], v[144:159]
    ds_read_b128 v[140:143], v5 offset:3168
    s_waitcnt vmcnt(9)
    ds_read_b64_tr_b16 v[176:177], v3 offset:22528
    ds_read_b64_tr_b16 v[178:179], v3 offset:22784
    s_waitcnt lgkmcnt(6)
    v_mfma_f32_32x32x16_bf16 v[144:159], v[168:171], v[128:131], v[144:159]
    s_xor_b32 s51, s56, 6
    s_mul_i32 s51, s51, 4224
    v_add_u32 v5, s51, v4
    ds_read_b128 v[112:115], v5 offset:0
    s_waitcnt vmcnt(8)
    ds_read_b64_tr_b16 v[180:181], v3 offset:0
    ds_read_b64_tr_b16 v[182:183], v3 offset:256
    s_waitcnt lgkmcnt(6)
    v_mfma_f32_32x32x16_bf16 v[144:159], v[172:175], v[132:135], v[144:159]
    ds_read_b128 v[116:119], v5 offset:1056
    s_waitcnt vmcnt(7)
    ds_read_b64_tr_b16 v[184:185], v3 offset:1024
    ds_read_b64_tr_b16 v[186:187], v3 offset:1280
    s_waitcnt lgkmcnt(6)
    v_mfma_f32_32x32x16_bf16 v[144:159], v[176:179], v[136:139], v[144:159]
    ds_read_b128 v[120:123], v5 offset:2112
    s_waitcnt vmcnt(6)
    ds_read_b64_tr_b16 v[188:189], v3 offset:2048
    ds_read_b64_tr_b16 v[190:191], v3 offset:2304
    s_waitcnt lgkmcnt(6)
    v_mfma_f32_32x32x16_bf16 v[144:159], v[180:183], v[140:143], v[144:159]
    ds_read_b128 v[124:127], v5 offset:3168
    s_waitcnt vmcnt(5)
    ds_read_b64_tr_b16 v[192:193], v3 offset:3072
    ds_read_b64_tr_b16 v[194:195], v3 offset:3328
    s_waitcnt lgkmcnt(6)
    v_mfma_f32_32x32x16_bf16 v[144:159], v[184:187], v[112:115], v[144:159]
    s_xor_b32 s51, s56, 7
    s_mul_i32 s51, s51, 4224
    v_add_u32 v5, s51, v4
    ds_read_b128 v[128:131], v5 offset:0
    s_waitcnt vmcnt(4)
    ds_read_b64_tr_b16 v[196:197], v3 offset:4096
    ds_read_b64_tr_b16 v[198:199], v3 offset:4352
    s_waitcnt lgkmcnt(6)
    v_mfma_f32_32x32x16_bf16 v[144:159], v[188:191], v[116:119], v[144:159]
    ds_read_b128 v[132:135], v5 offset:1056
    s_waitcnt vmcnt(3)
    ds_read_b64_tr_b16 v[200:201], v3 offset:5120
    ds_read_b64_tr_b16 v[202:203], v3 offset:5376
    s_waitcnt lgkmcnt(6)
    v_mfma_f32_32x32x16_bf16 v[144:159], v[192:195], v[120:123], v[144:159]
    ds_read_b128 v[136:139], v5 offset:2112
    s_waitcnt vmcnt(2)
    ds_read_b64_tr_b16 v[204:205], v3 offset:6144
    ds_read_b64_tr_b16 v[206:207], v3 offset:6400
    s_waitcnt lgkmcnt(6)
    v_mfma_f32_32x32x16_bf16 v[144:159], v[196:199], v[124:127], v[144:159]
    ds_read_b128 v[140:143], v5 offset:3168
    s_waitcnt vmcnt(1)
    ds_read_b64_tr_b16 v[208:209], v3 offset:7168
    ds_read_b64_tr_b16 v[210:211], v3 offset:7424
    s_waitcnt lgkmcnt(6)
    v_mfma_f32_32x32x16_bf16 v[144:159], v[200:203], v[128:131], v[144:159]
    s_waitcnt vmcnt(0)
    ds_read_b64_tr_b16 v[212:213], v3 offset:8192
    ds_read_b64_tr_b16 v[214:215], v3 offset:8448
    s_waitcnt lgkmcnt(5)
    v_mfma_f32_32x32x16_bf16 v[144:159], v[204:207], v[132:135], v[144:159]
    s_waitcnt lgkmcnt(2)
    v_mfma_f32_32x32x16_bf16 v[144:159], v[208:211], v[136:139], v[144:159]
    s_waitcnt lgkmcnt(0)
    v_mfma_f32_32x32x16_bf16 v[144:159], v[212:215], v[140:143], v[144:159]
    s_barrier
    ds_read_b128 v[24:27], v166 offset:0
    ds_read_b64 v[12:13], v10
    ds_read_b128 v[28:31], v8 offset:0
    ds_read_b128 v[32:35], v9 offset:0
    s_mov_b32 s55, 3
    s_nop 5
    v_cvt_pk_bf16_f32 v16, v144, v145
    v_cvt_pk_bf16_f32 v17, v146, v147
    v_cvt_pk_bf16_f32 v18, v148, v149
    v_cvt_pk_bf16_f32 v19, v150, v151
    v_cvt_pk_bf16_f32 v20, v152, v153
    s_waitcnt lgkmcnt(2)
    v_mfma_f32_32x32x16_bf16 v[112:127], v[24:27], v[16:19], 0
    ds_write_b128 v167, v[16:19] offset:57856
    v_cvt_pk_bf16_f32 v21, v154, v155
    v_cvt_pk_bf16_f32 v22, v156, v157
    v_cvt_pk_bf16_f32 v23, v158, v159
    ds_write_b128 v167, v[20:23] offset:58880
    v_and_b32 v12, v12, v13
    s_nop 0
    v_readfirstlane_b32 s3, v12
    s_nop 3
    v_exp_f32 v112, v112
    v_exp_f32 v113, v113
    v_exp_f32 v114, v114
    v_exp_f32 v115, v115
    v_exp_f32 v116, v116
    v_mfma_f32_32x32x16_bf16 v[128:143], v[24:27], v[20:23], 0
    s_waitcnt lgkmcnt(0)
    s_barrier
    v_exp_f32 v117, v117
    v_exp_f32 v118, v118
    v_exp_f32 v119, v119
    v_exp_f32 v120, v120
    v_exp_f32 v121, v121
    v_exp_f32 v122, v122
    v_smfmac_f32_32x32x32_bf16 v[40:55], v[28:31], v[112:119], v6
    ds_read_b128 v[104:107], v162 offset:57856
    ds_read_b128 v[108:111], v162 offset:58880
    v_exp_f32 v123, v123
    v_exp_f32 v124, v124
    v_exp_f32 v125, v125
    v_exp_f32 v126, v126
    v_exp_f32 v127, v127
    v_exp_f32 v128, v128
    v_exp_f32 v129, v129
    v_smfmac_f32_32x32x32_bf16 v[40:55], v[32:35], v[120:127], v6
    s_waitcnt lgkmcnt(0)
    v_exp_f32 v130, v130
    v_exp_f32 v131, v131
    v_exp_f32 v132, v132
    v_mfma_f32_32x32x16_bf16 v[112:127], v[24:27], v[104:107], 0
L_attn:
    v_exp_f32 v133, v133
    v_exp_f32 v134, v134
    v_exp_f32 v135, v135
    v_exp_f32 v136, v136
    v_exp_f32 v137, v137
    v_exp_f32 v138, v138
    v_smfmac_f32_32x32x32_bf16 v[56:71], v[28:31], v[128:135], v6
    v_exp_f32 v139, v139
    v_exp_f32 v140, v140
    v_exp_f32 v141, v141
    v_exp_f32 v142, v142
    v_exp_f32 v143, v143
    v_exp_f32 v112, v112
    v_exp_f32 v113, v113
    v_smfmac_f32_32x32x32_bf16 v[56:71], v[32:35], v[136:143], v6
    ds_read_b128 v[168:171], v166 offset:4160
    v_exp_f32 v114, v114
    v_exp_f32 v115, v115
    v_exp_f32 v116, v116
    v_mfma_f32_32x32x16_bf16 v[128:143], v[24:27], v[108:111], 0
    ds_read_b128 v[172:175], v8 offset:4160
    v_exp_f32 v117, v117
    v_exp_f32 v118, v118
    v_exp_f32 v119, v119
    v_exp_f32 v120, v120
    v_exp_f32 v121, v121
    v_exp_f32 v122, v122
    v_smfmac_f32_32x32x32_bf16 v[72:87], v[28:31], v[112:119], v6
    ds_read_b128 v[176:179], v9 offset:4160
    v_exp_f32 v123, v123
    v_exp_f32 v124, v124
    v_exp_f32 v125, v125
    v_exp_f32 v126, v126
    v_exp_f32 v127, v127
    v_exp_f32 v128, v128
    v_exp_f32 v129, v129
    v_smfmac_f32_32x32x32_bf16 v[72:87], v[32:35], v[120:127], v6
    s_waitcnt lgkmcnt(2)
    v_exp_f32 v130, v130
    v_exp_f32 v131, v131
    v_exp_f32 v132, v132
    v_mfma_f32_32x32x16_bf16 v[112:127], v[168:171], v[16:19], 0
    v_exp_f32 v133, v133
    v_exp_f32 v134, v134
    v_exp_f32 v135, v135
    v_exp_f32 v136, v136
    v_exp_f32 v137, v137
    v_exp_f32 v138, v138
    v_smfmac_f32_32x32x32_bf16 v[88:103], v[28:31], v[128:135], v6
    s_waitcnt lgkmcnt(0)
    v_exp_f32 v139, v139
    v_exp_f32 v140, v140
    v_exp_f32 v141, v141
    v_exp_f32 v142, v142
    v_exp_f32 v143, v143
    v_exp_f32 v112, v112
    v_exp_f32 v113, v113
    v_smfmac_f32_32x32x32_bf16 v[88:103], v[32:35], v[136:143], v6
    v_exp_f32 v114, v114
    v_exp_f32 v115, v115
    v_exp_f32 v116, v116
    v_mfma_f32_32x32x16_bf16 v[128:143], v[168:171], v[20:23], 0
    v_exp_f32 v117, v117
    v_exp_f32 v118, v118
    v_exp_f32 v119, v119
    v_exp_f32 v120, v120
    v_exp_f32 v121, v121
    v_exp_f32 v122, v122
    v_smfmac_f32_32x32x32_bf16 v[40:55], v[172:175], v[112:119], v6
    v_exp_f32 v123, v123
    v_exp_f32 v124, v124
    v_exp_f32 v125, v125
    v_exp_f32 v126, v126
    v_exp_f32 v127, v127
    v_exp_f32 v128, v128
    v_exp_f32 v129, v129
    v_smfmac_f32_32x32x32_bf16 v[40:55], v[176:179], v[120:127], v6
    v_exp_f32 v130, v130
    v_exp_f32 v131, v131
    v_exp_f32 v132, v132
    v_mfma_f32_32x32x16_bf16 v[112:127], v[168:171], v[104:107], 0
    v_exp_f32 v133, v133
    v_exp_f32 v134, v134
    v_exp_f32 v135, v135
    v_exp_f32 v136, v136
    v_exp_f32 v137, v137
    v_exp_f32 v138, v138
    v_smfmac_f32_32x32x32_bf16 v[56:71], v[172:175], v[128:135], v6
    v_exp_f32 v139, v139
    v_exp_f32 v140, v140
    v_exp_f32 v141, v141
    v_exp_f32 v142, v142
    v_exp_f32 v143, v143
    v_exp_f32 v112, v112
    v_exp_f32 v113, v113
    v_smfmac_f32_32x32x32_bf16 v[56:71], v[176:179], v[136:143], v6
    ds_read_b128 v[24:27], v166 offset:8320
    v_exp_f32 v114, v114
    v_exp_f32 v115, v115
    v_exp_f32 v116, v116
    v_mfma_f32_32x32x16_bf16 v[128:143], v[168:171], v[108:111], 0
    ds_read_b128 v[28:31], v8 offset:8320
    v_exp_f32 v117, v117
    v_exp_f32 v118, v118
    v_exp_f32 v119, v119
    v_exp_f32 v120, v120
    v_exp_f32 v121, v121
    v_exp_f32 v122, v122
    v_smfmac_f32_32x32x32_bf16 v[72:87], v[172:175], v[112:119], v6
    ds_read_b128 v[32:35], v9 offset:8320
    v_exp_f32 v123, v123
    v_exp_f32 v124, v124
    v_exp_f32 v125, v125
    v_exp_f32 v126, v126
    v_exp_f32 v127, v127
    v_exp_f32 v128, v128
    v_exp_f32 v129, v129
    v_smfmac_f32_32x32x32_bf16 v[72:87], v[176:179], v[120:127], v6
    s_waitcnt lgkmcnt(2)
    v_exp_f32 v130, v130
    v_exp_f32 v131, v131
    v_exp_f32 v132, v132
    v_mfma_f32_32x32x16_bf16 v[112:127], v[24:27], v[16:19], 0
    v_exp_f32 v133, v133
    v_exp_f32 v134, v134
    v_exp_f32 v135, v135
    v_exp_f32 v136, v136
    v_exp_f32 v137, v137
    v_exp_f32 v138, v138
    v_smfmac_f32_32x32x32_bf16 v[88:103], v[172:175], v[128:135], v6
    s_waitcnt lgkmcnt(0)
    v_exp_f32 v139, v139
    v_exp_f32 v140, v140
    v_exp_f32 v141, v141
    v_exp_f32 v142, v142
    v_exp_f32 v143, v143
    v_exp_f32 v112, v112
    v_exp_f32 v113, v113
    v_smfmac_f32_32x32x32_bf16 v[88:103], v[176:179], v[136:143], v6
    v_exp_f32 v114, v114
    v_exp_f32 v115, v115
    v_exp_f32 v116, v116
    v_mfma_f32_32x32x16_bf16 v[128:143], v[24:27], v[20:23], 0
    v_exp_f32 v117, v117
    v_exp_f32 v118, v118
    v_exp_f32 v119, v119
    v_exp_f32 v120, v120
    v_exp_f32 v121, v121
    v_exp_f32 v122, v122
    v_smfmac_f32_32x32x32_bf16 v[40:55], v[28:31], v[112:119], v6
    v_exp_f32 v123, v123
    v_exp_f32 v124, v124
    v_exp_f32 v125, v125
    v_exp_f32 v126, v126
    v_exp_f32 v127, v127
    v_exp_f32 v128, v128
    v_exp_f32 v129, v129
    v_smfmac_f32_32x32x32_bf16 v[40:55], v[32:35], v[120:127], v6
    v_exp_f32 v130, v130
    v_exp_f32 v131, v131
    v_exp_f32 v132, v132
    v_mfma_f32_32x32x16_bf16 v[112:127], v[24:27], v[104:107], 0
    v_exp_f32 v133, v133
    v_exp_f32 v134, v134
    v_exp_f32 v135, v135
    v_exp_f32 v136, v136
    v_exp_f32 v137, v137
    v_exp_f32 v138, v138
    v_smfmac_f32_32x32x32_bf16 v[56:71], v[28:31], v[128:135], v6
    v_exp_f32 v139, v139
    v_exp_f32 v140, v140
    v_exp_f32 v141, v141
    v_exp_f32 v142, v142
    v_exp_f32 v143, v143
    v_exp_f32 v112, v112
    v_exp_f32 v113, v113
    v_smfmac_f32_32x32x32_bf16 v[56:71], v[32:35], v[136:143], v6
    ds_read_b128 v[168:171], v166 offset:12480
    v_exp_f32 v114, v114
    v_exp_f32 v115, v115
    v_exp_f32 v116, v116
    v_mfma_f32_32x32x16_bf16 v[128:143], v[24:27], v[108:111], 0
    ds_read_b128 v[172:175], v8 offset:12480
    v_exp_f32 v117, v117
    v_exp_f32 v118, v118
    v_exp_f32 v119, v119
    v_exp_f32 v120, v120
    v_exp_f32 v121, v121
    v_exp_f32 v122, v122
    v_smfmac_f32_32x32x32_bf16 v[72:87], v[28:31], v[112:119], v6
    ds_read_b128 v[176:179], v9 offset:12480
    v_exp_f32 v123, v123
    v_exp_f32 v124, v124
    v_exp_f32 v125, v125
    v_exp_f32 v126, v126
    v_exp_f32 v127, v127
    v_exp_f32 v128, v128
    v_exp_f32 v129, v129
    v_smfmac_f32_32x32x32_bf16 v[72:87], v[32:35], v[120:127], v6
    s_waitcnt lgkmcnt(2)
    v_exp_f32 v130, v130
    v_exp_f32 v131, v131
    v_exp_f32 v132, v132
    v_mfma_f32_32x32x16_bf16 v[112:127], v[168:171], v[16:19], 0
    v_exp_f32 v133, v133
    v_exp_f32 v134, v134
    v_exp_f32 v135, v135
    v_exp_f32 v136, v136
    v_exp_f32 v137, v137
    v_exp_f32 v138, v138
    v_smfmac_f32_32x32x32_bf16 v[88:103], v[28:31], v[128:135], v6
    s_waitcnt lgkmcnt(0)
    v_exp_f32 v139, v139
    v_exp_f32 v140, v140
    v_exp_f32 v141, v141
    v_exp_f32 v142, v142
    v_exp_f32 v143, v143
    v_exp_f32 v112, v112
    v_exp_f32 v113, v113
    v_smfmac_f32_32x32x32_bf16 v[88:103], v[32:35], v[136:143], v6
    v_exp_f32 v114, v114
    v_exp_f32 v115, v115
    v_exp_f32 v116, v116
    v_mfma_f32_32x32x16_bf16 v[128:143], v[168:171], v[20:23], 0
    v_exp_f32 v117, v117
    v_exp_f32 v118, v118
    v_exp_f32 v119, v119
    v_exp_f32 v120, v120
    v_exp_f32 v121, v121
    v_exp_f32 v122, v122
    v_smfmac_f32_32x32x32_bf16 v[40:55], v[172:175], v[112:119], v6
    v_exp_f32 v123, v123
    v_exp_f32 v124, v124
    v_exp_f32 v125, v125
    v_exp_f32 v126, v126
    v_exp_f32 v127, v127
    v_exp_f32 v128, v128
    v_exp_f32 v129, v129
    v_smfmac_f32_32x32x32_bf16 v[40:55], v[176:179], v[120:127], v6
    s_barrier
    v_exp_f32 v130, v130
    v_exp_f32 v131, v131
    v_exp_f32 v132, v132
    v_mfma_f32_32x32x16_bf16 v[112:127], v[168:171], v[104:107], 0
    v_exp_f32 v133, v133
    v_exp_f32 v134, v134
    v_exp_f32 v135, v135
    v_exp_f32 v136, v136
    v_exp_f32 v137, v137
    v_exp_f32 v138, v138
    v_smfmac_f32_32x32x32_bf16 v[56:71], v[172:175], v[128:135], v6
    v_exp_f32 v139, v139
    v_exp_f32 v140, v140
    v_exp_f32 v141, v141
    v_exp_f32 v142, v142
    v_exp_f32 v143, v143
    v_exp_f32 v112, v112
    v_exp_f32 v113, v113
    v_smfmac_f32_32x32x32_bf16 v[56:71], v[176:179], v[136:143], v6
    ds_read_b128 v[24:27], v166 offset:16640
    v_exp_f32 v114, v114
    v_exp_f32 v115, v115
    v_exp_f32 v116, v116
    v_mfma_f32_32x32x16_bf16 v[128:143], v[168:171], v[108:111], 0
    ds_read_b128 v[28:31], v8 offset:16640
    v_exp_f32 v117, v117
    v_exp_f32 v118, v118
    v_exp_f32 v119, v119
    v_exp_f32 v120, v120
    v_exp_f32 v121, v121
    v_exp_f32 v122, v122
    v_smfmac_f32_32x32x32_bf16 v[72:87], v[172:175], v[112:119], v6
    ds_read_b128 v[32:35], v9 offset:16640
    v_exp_f32 v123, v123
    v_exp_f32 v124, v124
    v_exp_f32 v125, v125
    v_exp_f32 v126, v126
    v_exp_f32 v127, v127
    v_exp_f32 v128, v128
    v_exp_f32 v129, v129
    v_smfmac_f32_32x32x32_bf16 v[72:87], v[176:179], v[120:127], v6
    s_waitcnt lgkmcnt(2)
    v_exp_f32 v130, v130
    v_exp_f32 v131, v131
    v_exp_f32 v132, v132
    v_mfma_f32_32x32x16_bf16 v[112:127], v[24:27], v[16:19], 0
    v_exp_f32 v133, v133
    v_exp_f32 v134, v134
    v_exp_f32 v135, v135
    v_exp_f32 v136, v136
    v_exp_f32 v137, v137
    v_exp_f32 v138, v138
    v_smfmac_f32_32x32x32_bf16 v[88:103], v[172:175], v[128:135], v6
    s_waitcnt lgkmcnt(0)
    v_exp_f32 v139, v139
    v_exp_f32 v140, v140
    v_exp_f32 v141, v141
    v_exp_f32 v142, v142
    v_exp_f32 v143, v143
    v_exp_f32 v112, v112
    v_exp_f32 v113, v113
    v_smfmac_f32_32x32x32_bf16 v[88:103], v[176:179], v[136:143], v6
    v_exp_f32 v114, v114
    v_exp_f32 v115, v115
    v_exp_f32 v116, v116
    v_mfma_f32_32x32x16_bf16 v[128:143], v[24:27], v[20:23], 0
    v_exp_f32 v117, v117
    v_exp_f32 v118, v118
    v_exp_f32 v119, v119
    v_exp_f32 v120, v120
    v_exp_f32 v121, v121
    v_exp_f32 v122, v122
    v_smfmac_f32_32x32x32_bf16 v[40:55], v[28:31], v[112:119], v6
    v_exp_f32 v123, v123
    v_exp_f32 v124, v124
    v_exp_f32 v125, v125
    v_exp_f32 v126, v126
    v_exp_f32 v127, v127
    v_exp_f32 v128, v128
    v_exp_f32 v129, v129
    v_smfmac_f32_32x32x32_bf16 v[40:55], v[32:35], v[120:127], v6
    v_exp_f32 v130, v130
    v_exp_f32 v131, v131
    v_exp_f32 v132, v132
    v_mfma_f32_32x32x16_bf16 v[112:127], v[24:27], v[104:107], 0
    v_exp_f32 v133, v133
    v_exp_f32 v134, v134
    v_exp_f32 v135, v135
    v_exp_f32 v136, v136
    v_exp_f32 v137, v137
    v_exp_f32 v138, v138
    v_smfmac_f32_32x32x32_bf16 v[56:71], v[28:31], v[128:135], v6
    v_exp_f32 v139, v139
    v_exp_f32 v140, v140
    v_exp_f32 v141, v141
    v_exp_f32 v142, v142
    v_exp_f32 v143, v143
    v_exp_f32 v112, v112
    v_exp_f32 v113, v113
    v_smfmac_f32_32x32x32_bf16 v[56:71], v[32:35], v[136:143], v6
    ds_read_b128 v[168:171], v166 offset:20800
    v_exp_f32 v114, v114
    v_exp_f32 v115, v115
    v_exp_f32 v116, v116
    v_mfma_f32_32x32x16_bf16 v[128:143], v[24:27], v[108:111], 0
    ds_read_b128 v[172:175], v8 offset:20800
    v_exp_f32 v117, v117
    v_exp_f32 v118, v118
    v_exp_f32 v119, v119
    v_exp_f32 v120, v120
    v_exp_f32 v121, v121
    v_exp_f32 v122, v122
    v_smfmac_f32_32x32x32_bf16 v[72:87], v[28:31], v[112:119], v6
    ds_read_b128 v[176:179], v9 offset:20800
    v_exp_f32 v123, v123
    v_exp_f32 v124, v124
    v_exp_f32 v125, v125
    v_exp_f32 v126, v126
    v_exp_f32 v127, v127
    v_exp_f32 v128, v128
    v_exp_f32 v129, v129
    v_smfmac_f32_32x32x32_bf16 v[72:87], v[32:35], v[120:127], v6
    s_waitcnt lgkmcnt(2)
    v_exp_f32 v130, v130
    v_exp_f32 v131, v131
    v_exp_f32 v132, v132
    v_mfma_f32_32x32x16_bf16 v[112:127], v[168:171], v[16:19], 0
    v_exp_f32 v133, v133
    v_exp_f32 v134, v134
    v_exp_f32 v135, v135
    v_exp_f32 v136, v136
    v_exp_f32 v137, v137
    v_exp_f32 v138, v138
    v_smfmac_f32_32x32x32_bf16 v[88:103], v[28:31], v[128:135], v6
    s_waitcnt lgkmcnt(0)
    v_exp_f32 v139, v139
    v_exp_f32 v140, v140
    v_exp_f32 v141, v141
    v_exp_f32 v142, v142
    v_exp_f32 v143, v143
    v_exp_f32 v112, v112
    v_exp_f32 v113, v113
    v_smfmac_f32_32x32x32_bf16 v[88:103], v[32:35], v[136:143], v6
    v_exp_f32 v114, v114
    v_exp_f32 v115, v115
    v_exp_f32 v116, v116
    v_mfma_f32_32x32x16_bf16 v[128:143], v[168:171], v[20:23], 0
    v_exp_f32 v117, v117
    v_exp_f32 v118, v118
    v_exp_f32 v119, v119
    v_exp_f32 v120, v120
    v_exp_f32 v121, v121
    v_exp_f32 v122, v122
    v_smfmac_f32_32x32x32_bf16 v[40:55], v[172:175], v[112:119], v6
    v_exp_f32 v123, v123
    v_exp_f32 v124, v124
    v_exp_f32 v125, v125
    v_exp_f32 v126, v126
    v_exp_f32 v127, v127
    v_exp_f32 v128, v128
    v_exp_f32 v129, v129
    v_smfmac_f32_32x32x32_bf16 v[40:55], v[176:179], v[120:127], v6
    v_exp_f32 v130, v130
    v_exp_f32 v131, v131
    v_exp_f32 v132, v132
    v_mfma_f32_32x32x16_bf16 v[112:127], v[168:171], v[104:107], 0
    v_exp_f32 v133, v133
    v_exp_f32 v134, v134
    v_exp_f32 v135, v135
    v_exp_f32 v136, v136
    v_exp_f32 v137, v137
    v_exp_f32 v138, v138
    v_smfmac_f32_32x32x32_bf16 v[56:71], v[172:175], v[128:135], v6
    v_exp_f32 v139, v139
    v_exp_f32 v140, v140
    v_exp_f32 v141, v141
    v_exp_f32 v142, v142
    v_exp_f32 v143, v143
    v_exp_f32 v112, v112
    v_exp_f32 v113, v113
    v_smfmac_f32_32x32x32_bf16 v[56:71], v[176:179], v[136:143], v6
    ds_read_b128 v[24:27], v166 offset:24960
    v_exp_f32 v114, v114
    v_exp_f32 v115, v115
    v_exp_f32 v116, v116
    v_mfma_f32_32x32x16_bf16 v[128:143], v[168:171], v[108:111], 0
    ds_read_b128 v[28:31], v8 offset:24960
    v_exp_f32 v117, v117
    v_exp_f32 v118, v118
    v_exp_f32 v119, v119
    v_exp_f32 v120, v120
    v_exp_f32 v121, v121
    v_exp_f32 v122, v122
    v_smfmac_f32_32x32x32_bf16 v[72:87], v[172:175], v[112:119], v6
    ds_read_b128 v[32:35], v9 offset:24960
    v_exp_f32 v123, v123
    v_exp_f32 v124, v124
    v_exp_f32 v125, v125
    v_exp_f32 v126, v126
    v_exp_f32 v127, v127
    v_exp_f32 v128, v128
    v_exp_f32 v129, v129
    v_smfmac_f32_32x32x32_bf16 v[72:87], v[176:179], v[120:127], v6
    s_waitcnt lgkmcnt(2)
    v_exp_f32 v130, v130
    v_exp_f32 v131, v131
    v_exp_f32 v132, v132
    v_mfma_f32_32x32x16_bf16 v[112:127], v[24:27], v[16:19], 0
    v_exp_f32 v133, v133
    v_exp_f32 v134, v134
    v_exp_f32 v135, v135
    v_exp_f32 v136, v136
    v_exp_f32 v137, v137
    v_exp_f32 v138, v138
    v_smfmac_f32_32x32x32_bf16 v[88:103], v[172:175], v[128:135], v6
    s_waitcnt lgkmcnt(0)
    v_exp_f32 v139, v139
    v_exp_f32 v140, v140
    v_exp_f32 v141, v141
    v_exp_f32 v142, v142
    v_exp_f32 v143, v143
    v_exp_f32 v112, v112
    v_exp_f32 v113, v113
    v_smfmac_f32_32x32x32_bf16 v[88:103], v[176:179], v[136:143], v6
    s_sub_u32 s55, s55, 1
    v_exp_f32 v114, v114
    v_exp_f32 v115, v115
    v_exp_f32 v116, v116
    v_mfma_f32_32x32x16_bf16 v[128:143], v[24:27], v[20:23], 0
    s_cbranch_scc1 L_exit
    v_exp_f32 v117, v117
    v_exp_f32 v118, v118
    v_exp_f32 v119, v119
    v_exp_f32 v120, v120
    v_exp_f32 v121, v121
    v_exp_f32 v122, v122
    v_smfmac_f32_32x32x32_bf16 v[40:55], v[28:31], v[112:119], v6
    v_exp_f32 v123, v123
    v_exp_f32 v124, v124
    v_exp_f32 v125, v125
    v_exp_f32 v126, v126
    v_exp_f32 v127, v127
    v_exp_f32 v128, v128
    v_exp_f32 v129, v129
    v_smfmac_f32_32x32x32_bf16 v[40:55], v[32:35], v[120:127], v6
    v_exp_f32 v130, v130
    v_exp_f32 v131, v131
    v_exp_f32 v132, v132
    v_mfma_f32_32x32x16_bf16 v[112:127], v[24:27], v[104:107], 0
    v_exp_f32 v133, v133
    v_exp_f32 v134, v134
    v_exp_f32 v135, v135
    v_exp_f32 v136, v136
    v_exp_f32 v137, v137
    v_exp_f32 v138, v138
    v_smfmac_f32_32x32x32_bf16 v[56:71], v[28:31], v[128:135], v6
    v_exp_f32 v139, v139
    v_exp_f32 v140, v140
    v_exp_f32 v141, v141
    v_exp_f32 v142, v142
    v_exp_f32 v143, v143
    v_exp_f32 v112, v112
    v_exp_f32 v113, v113
    v_smfmac_f32_32x32x32_bf16 v[56:71], v[32:35], v[136:143], v6
    ds_read_b128 v[168:171], v166 offset:29120
    v_exp_f32 v114, v114
    v_exp_f32 v115, v115
    v_exp_f32 v116, v116
    v_mfma_f32_32x32x16_bf16 v[128:143], v[24:27], v[108:111], 0
    ds_read_b128 v[172:175], v8 offset:29120
    v_exp_f32 v117, v117
    v_exp_f32 v118, v118
    v_exp_f32 v119, v119
    v_exp_f32 v120, v120
    v_exp_f32 v121, v121
    v_exp_f32 v122, v122
    v_smfmac_f32_32x32x32_bf16 v[72:87], v[28:31], v[112:119], v6
    ds_read_b128 v[176:179], v9 offset:29120
    v_exp_f32 v123, v123
    v_exp_f32 v124, v124
    v_exp_f32 v125, v125
    v_exp_f32 v126, v126
    v_exp_f32 v127, v127
    v_exp_f32 v128, v128
    v_exp_f32 v129, v129
    v_smfmac_f32_32x32x32_bf16 v[72:87], v[32:35], v[120:127], v6
    s_waitcnt lgkmcnt(2)
    v_exp_f32 v130, v130
    v_exp_f32 v131, v131
    v_exp_f32 v132, v132
    v_mfma_f32_32x32x16_bf16 v[112:127], v[168:171], v[16:19], 0
    v_exp_f32 v133, v133
    v_exp_f32 v134, v134
    v_exp_f32 v135, v135
    v_exp_f32 v136, v136
    v_exp_f32 v137, v137
    v_exp_f32 v138, v138
    v_smfmac_f32_32x32x32_bf16 v[88:103], v[28:31], v[128:135], v6
    s_waitcnt lgkmcnt(0)
    v_exp_f32 v139, v139
    v_exp_f32 v140, v140
    v_exp_f32 v141, v141
    v_exp_f32 v142, v142
    v_exp_f32 v143, v143
    v_exp_f32 v112, v112
    v_exp_f32 v113, v113
    v_smfmac_f32_32x32x32_bf16 v[88:103], v[32:35], v[136:143], v6
    v_exp_f32 v114, v114
    v_exp_f32 v115, v115
    v_exp_f32 v116, v116
    v_mfma_f32_32x32x16_bf16 v[128:143], v[168:171], v[20:23], 0
    v_exp_f32 v117, v117
    v_exp_f32 v118, v118
    v_exp_f32 v119, v119
    v_exp_f32 v120, v120
    v_exp_f32 v121, v121
    v_exp_f32 v122, v122
    v_smfmac_f32_32x32x32_bf16 v[40:55], v[172:175], v[112:119], v6
    v_exp_f32 v123, v123
    v_exp_f32 v124, v124
    v_exp_f32 v125, v125
    v_exp_f32 v126, v126
    v_exp_f32 v127, v127
    v_exp_f32 v128, v128
    v_exp_f32 v129, v129
    v_smfmac_f32_32x32x32_bf16 v[40:55], v[176:179], v[120:127], v6
    s_barrier
    v_exp_f32 v130, v130
    v_exp_f32 v131, v131
    v_exp_f32 v132, v132
    v_mfma_f32_32x32x16_bf16 v[112:127], v[168:171], v[104:107], 0
    v_exp_f32 v133, v133
    v_exp_f32 v134, v134
    v_exp_f32 v135, v135
    v_exp_f32 v136, v136
    v_exp_f32 v137, v137
    v_exp_f32 v138, v138
    v_smfmac_f32_32x32x32_bf16 v[56:71], v[172:175], v[128:135], v6
    v_exp_f32 v139, v139
    v_exp_f32 v140, v140
    v_exp_f32 v141, v141
    v_exp_f32 v142, v142
    v_exp_f32 v143, v143
    v_exp_f32 v112, v112
    v_exp_f32 v113, v113
    v_smfmac_f32_32x32x32_bf16 v[56:71], v[176:179], v[136:143], v6
    ds_read_b128 v[24:27], v166 offset:0
    v_exp_f32 v114, v114
    v_exp_f32 v115, v115
    v_exp_f32 v116, v116
    v_mfma_f32_32x32x16_bf16 v[128:143], v[168:171], v[108:111], 0
    ds_read_b128 v[28:31], v8 offset:0
    v_exp_f32 v117, v117
    v_exp_f32 v118, v118
    v_exp_f32 v119, v119
    v_exp_f32 v120, v120
    v_exp_f32 v121, v121
    v_exp_f32 v122, v122
    v_smfmac_f32_32x32x32_bf16 v[72:87], v[172:175], v[112:119], v6
    ds_read_b128 v[32:35], v9 offset:0
    v_exp_f32 v123, v123
    v_exp_f32 v124, v124
    v_exp_f32 v125, v125
    v_exp_f32 v126, v126
    v_exp_f32 v127, v127
    v_exp_f32 v128, v128
    v_exp_f32 v129, v129
    v_smfmac_f32_32x32x32_bf16 v[72:87], v[176:179], v[120:127], v6
    s_waitcnt lgkmcnt(2)
    v_exp_f32 v130, v130
    v_exp_f32 v131, v131
    v_exp_f32 v132, v132
    v_mfma_f32_32x32x16_bf16 v[112:127], v[24:27], v[16:19], 0
    v_exp_f32 v133, v133
    v_exp_f32 v134, v134
    v_exp_f32 v135, v135
    v_exp_f32 v136, v136
    v_exp_f32 v137, v137
    v_exp_f32 v138, v138
    v_smfmac_f32_32x32x32_bf16 v[88:103], v[172:175], v[128:135], v6
    s_waitcnt lgkmcnt(0)
    v_exp_f32 v139, v139
    v_exp_f32 v140, v140
    v_exp_f32 v141, v141
    v_exp_f32 v142, v142
    v_exp_f32 v143, v143
    v_exp_f32 v112, v112
    v_exp_f32 v113, v113
    v_smfmac_f32_32x32x32_bf16 v[88:103], v[176:179], v[136:143], v6
    v_exp_f32 v114, v114
    v_exp_f32 v115, v115
    v_exp_f32 v116, v116
    v_mfma_f32_32x32x16_bf16 v[128:143], v[24:27], v[20:23], 0
    v_exp_f32 v117, v117
    v_exp_f32 v118, v118
    v_exp_f32 v119, v119
    v_exp_f32 v120, v120
    v_exp_f32 v121, v121
    v_exp_f32 v122, v122
    v_smfmac_f32_32x32x32_bf16 v[40:55], v[28:31], v[112:119], v6
    v_exp_f32 v123, v123
    v_exp_f32 v124, v124
    v_exp_f32 v125, v125
    v_exp_f32 v126, v126
    v_exp_f32 v127, v127
    v_exp_f32 v128, v128
    v_exp_f32 v129, v129
    v_smfmac_f32_32x32x32_bf16 v[40:55], v[32:35], v[120:127], v6
    v_exp_f32 v130, v130
    v_exp_f32 v131, v131
    v_exp_f32 v132, v132
    v_mfma_f32_32x32x16_bf16 v[112:127], v[24:27], v[104:107], 0
    s_branch L_attn
L_exit:
    ds_read_b128 v[168:171], v166 offset:29120
    v_exp_f32 v117, v117
    v_exp_f32 v118, v118
    v_exp_f32 v119, v119
    v_exp_f32 v120, v120
    v_exp_f32 v121, v121
    v_exp_f32 v122, v122
    v_smfmac_f32_32x32x32_bf16 v[40:55], v[28:31], v[112:119], v6
    ds_read_b128 v[172:175], v8 offset:29120
    v_exp_f32 v123, v123
    v_exp_f32 v124, v124
    v_exp_f32 v125, v125
    v_exp_f32 v126, v126
    v_exp_f32 v127, v127
    v_exp_f32 v128, v128
    v_exp_f32 v129, v129
    v_smfmac_f32_32x32x32_bf16 v[40:55], v[32:35], v[120:127], v6
    s_waitcnt lgkmcnt(1)
    v_exp_f32 v130, v130
    v_exp_f32 v131, v131
    v_exp_f32 v132, v132
    v_mfma_f32_32x32x16_bf16 v[112:127], v[168:171], v[16:19], 0
    ds_read_b128 v[176:179], v9 offset:29120
    v_exp_f32 v133, v133
    v_exp_f32 v134, v134
    v_exp_f32 v135, v135
    v_exp_f32 v136, v136
    v_exp_f32 v137, v137
    v_exp_f32 v138, v138
    v_smfmac_f32_32x32x32_bf16 v[56:71], v[28:31], v[128:135], v6
    v_exp_f32 v139, v139
    v_exp_f32 v140, v140
    v_exp_f32 v141, v141
    v_exp_f32 v142, v142
    v_exp_f32 v143, v143
    v_exp_f32 v112, v112
    v_exp_f32 v113, v113
    v_smfmac_f32_32x32x32_bf16 v[56:71], v[32:35], v[136:143], v6
    s_waitcnt lgkmcnt(0)
    v_exp_f32 v114, v114
    v_exp_f32 v115, v115
    v_exp_f32 v116, v116
    v_mfma_f32_32x32x16_bf16 v[128:143], v[168:171], v[20:23], 0
    s_barrier
    v_exp_f32 v117, v117
    v_exp_f32 v118, v118
    v_exp_f32 v119, v119
    v_exp_f32 v120, v120
    v_exp_f32 v121, v121
    v_exp_f32 v122, v122
    v_smfmac_f32_32x32x32_bf16 v[40:55], v[172:175], v[112:119], v6
    v_exp_f32 v123, v123
    v_exp_f32 v124, v124
    v_exp_f32 v125, v125
    v_exp_f32 v126, v126
    v_exp_f32 v127, v127
    v_exp_f32 v128, v128
    v_exp_f32 v129, v129
    v_smfmac_f32_32x32x32_bf16 v[40:55], v[176:179], v[120:127], v6
    v_exp_f32 v130, v130
    v_exp_f32 v131, v131
    v_exp_f32 v132, v132
    v_mfma_f32_32x32x16_bf16 v[112:127], v[24:27], v[104:107], 0
    v_exp_f32 v133, v133
    v_exp_f32 v134, v134
    v_exp_f32 v135, v135
    v_exp_f32 v136, v136
    v_exp_f32 v137, v137
    v_exp_f32 v138, v138
    v_smfmac_f32_32x32x32_bf16 v[56:71], v[172:175], v[128:135], v6
    v_exp_f32 v139, v139
    v_exp_f32 v140, v140
    v_exp_f32 v141, v141
    v_exp_f32 v142, v142
    v_exp_f32 v143, v143
    v_exp_f32 v112, v112
    v_exp_f32 v113, v113
    v_smfmac_f32_32x32x32_bf16 v[56:71], v[176:179], v[136:143], v6
    ds_write_b128 v167, v[40:43] offset:8192
    v_exp_f32 v114, v114
    v_exp_f32 v115, v115
    v_exp_f32 v116, v116
    v_mfma_f32_32x32x16_bf16 v[128:143], v[24:27], v[108:111], 0
    ds_write_b128 v167, v[44:47] offset:9216
    v_exp_f32 v117, v117
    v_exp_f32 v118, v118
    v_exp_f32 v119, v119
    v_exp_f32 v120, v120
    v_exp_f32 v121, v121
    v_exp_f32 v122, v122
    v_smfmac_f32_32x32x32_bf16 v[72:87], v[28:31], v[112:119], v6
    ds_write_b128 v167, v[56:59] offset:16384
    v_mov_b32 v49, v64
    v_exp_f32 v123, v123
    v_exp_f32 v124, v124
    v_exp_f32 v125, v125
    v_exp_f32 v126, v126
    v_exp_f32 v127, v127
    v_exp_f32 v128, v128
    v_exp_f32 v129, v129
    v_smfmac_f32_32x32x32_bf16 v[72:87], v[32:35], v[120:127], v6
    ds_write_b128 v167, v[60:63] offset:17408
    v_exp_f32 v130, v130
    v_exp_f32 v131, v131
    v_exp_f32 v132, v132
    v_mfma_f32_32x32x16_bf16 v[112:127], v[168:171], v[104:107], 0
    ds_write_b64 v167, v[48:49] offset:24576
    v_exp_f32 v133, v133
    v_exp_f32 v134, v134
    v_exp_f32 v135, v135
    v_exp_f32 v136, v136
    v_exp_f32 v137, v137
    v_exp_f32 v138, v138
    v_smfmac_f32_32x32x32_bf16 v[88:103], v[28:31], v[128:135], v6
    v_exp_f32 v139, v139
    v_exp_f32 v140, v140
    v_exp_f32 v141, v141
    v_exp_f32 v142, v142
    v_exp_f32 v143, v143
    v_exp_f32 v112, v112
    v_exp_f32 v113, v113
    v_smfmac_f32_32x32x32_bf16 v[88:103], v[32:35], v[136:143], v6
    s_waitcnt lgkmcnt(0)
    v_exp_f32 v114, v114
    v_exp_f32 v115, v115
    v_exp_f32 v116, v116
    v_mfma_f32_32x32x16_bf16 v[128:143], v[168:171], v[108:111], 0
    s_barrier
    v_exp_f32 v117, v117
    v_exp_f32 v118, v118
    v_exp_f32 v119, v119
    v_exp_f32 v120, v120
    v_exp_f32 v121, v121
    v_exp_f32 v122, v122
    v_smfmac_f32_32x32x32_bf16 v[72:87], v[172:175], v[112:119], v6
    ds_read_b128 v[208:211], v162 offset:8192
    ds_read_b128 v[212:215], v162 offset:9216
    ds_read_b64 v[224:225], v162 offset:24576
    v_exp_f32 v123, v123
    v_exp_f32 v124, v124
    v_exp_f32 v125, v125
    v_exp_f32 v126, v126
    v_exp_f32 v127, v127
    v_exp_f32 v128, v128
    v_exp_f32 v129, v129
    v_smfmac_f32_32x32x32_bf16 v[72:87], v[176:179], v[120:127], v6
    ds_read_b128 v[216:219], v162 offset:16384
    ds_read_b128 v[220:223], v162 offset:17408
    v_exp_f32 v130, v130
    v_exp_f32 v131, v131
    v_exp_f32 v132, v132
    v_exp_f32 v133, v133
    v_exp_f32 v134, v134
    v_exp_f32 v135, v135
    v_exp_f32 v136, v136
    v_exp_f32 v137, v137
    v_exp_f32 v138, v138
    v_smfmac_f32_32x32x32_bf16 v[88:103], v[172:175], v[128:135], v6
    s_waitcnt lgkmcnt(0)
    v_exp_f32 v139, v139
    v_exp_f32 v140, v140
    v_exp_f32 v141, v141
    v_exp_f32 v142, v142
    v_exp_f32 v143, v143
    s_nop 0
    v_add_f32 v80, v80, v224
    v_smfmac_f32_32x32x32_bf16 v[88:103], v[176:179], v[136:143], v6
    v_add_f32 v72, v72, v208
    v_add_f32 v73, v73, v209
    v_add_f32 v74, v74, v210
    v_add_f32 v75, v75, v211
    v_add_f32 v76, v76, v212
    v_add_f32 v77, v77, v213
    v_add_f32 v78, v78, v214
    v_add_f32 v79, v79, v215
    s_nop 3
    v_add_f32 v96, v96, v225
    v_pk_add_f32 v[88:89], v[88:89], v[216:217]
    v_pk_add_f32 v[90:91], v[90:91], v[218:219]
    v_pk_add_f32 v[92:93], v[92:93], v[220:221]
    v_pk_add_f32 v[94:95], v[94:95], v[222:223]
L_norm:
    s_cmp_eq_u32 s3, 1
    s_cbranch_scc0 L_main_slow
    v_rcp_f32 v200, v80
    s_movk_i32 s50, 0x207
    v_mul_f32 v72, v200, v72
    v_mul_f32 v73, v200, v73
    v_mul_f32 v74, v200, v74
    v_mul_f32 v75, v200, v75
    v_mul_f32 v76, v200, v76
    v_mul_f32 v77, v200, v77
    v_mul_f32 v78, v200, v78
    v_mul_f32 v79, v200, v79
    v_rcp_f32 v200, v96
    v_min_f32 v204, v80, v96
    v_add_f32 v205, v80, v96
    v_pk_mul_f32 v[88:89], v[88:89], v[200:201] op_sel_hi:[1,0]
    v_pk_mul_f32 v[90:91], v[90:91], v[200:201] op_sel_hi:[1,0]
    v_pk_mul_f32 v[92:93], v[92:93], v[200:201] op_sel_hi:[1,0]
    v_pk_mul_f32 v[94:95], v[94:95], v[200:201] op_sel_hi:[1,0]
    v_pk_fma_f32 v[202:203], v[72:73], v[88:89], 0 op_sel_hi:[1,1,0]
    v_pk_fma_f32 v[202:203], v[74:75], v[90:91], v[202:203]
    v_pk_fma_f32 v[202:203], v[76:77], v[92:93], v[202:203]
    v_pk_fma_f32 v[202:203], v[78:79], v[94:95], v[202:203]
    v_cmp_nle_f32 vcc, 0x1f800000, v204
    v_add_f32 v202, v202, v203
    v_cmp_class_f32_e64 s[52:53], v202, s50
    s_or_b64 s[52:53], s[52:53], vcc
    v_cmp_nge_f32 vcc, 0x5f800000, v205
    v_cvt_pk_bf16_f32 v192, v72, v73
    v_cvt_pk_bf16_f32 v193, v74, v75
    v_cvt_pk_bf16_f32 v194, v76, v77
    v_cvt_pk_bf16_f32 v195, v78, v79
    s_or_b64 s[52:53], s[52:53], vcc
    s_cbranch_scc1 L_unsafe
L_safe:
    buffer_store_dwordx4 v[192:195], v7, s[40:43], s20 offen offset:0
    ds_read_b128 v[176:179], v163 offset:0
    ds_read_b128 v[180:183], v163 offset:16
    ds_read_b128 v[184:187], v163 offset:32
    ds_read_b128 v[188:191], v163 offset:48
    v_cvt_pk_bf16_f32 v196, v88, v89
    v_cvt_pk_bf16_f32 v197, v90, v91
    v_cvt_pk_bf16_f32 v198, v92, v93
    v_cvt_pk_bf16_f32 v199, v94, v95
    buffer_store_dwordx4 v[196:199], v7, s[40:43], s20 offen offset:1024
    s_xor_b32 s5, s20, 8192
    s_xor_b32 s9, s21, 1024
    s_xor_b32 s6, s20, 16384
    s_xor_b32 s10, s21, 2048
    s_xor_b32 s7, s20, 24576
    s_xor_b32 s11, s21, 3072
    s_waitcnt lgkmcnt(0)
    v_dot2_f32_bf16 v202, v192, v176, 0
    v_dot2_f32_bf16 v203, v192, v184, 0
    v_dot2_f32_bf16 v206, v193, v177, 0
    v_dot2_f32_bf16 v207, v193, v185, 0
    v_dot2_f32_bf16 v202, v194, v178, v202
    v_dot2_f32_bf16 v203, v194, v186, v203
    v_dot2_f32_bf16 v206, v195, v179, v206
    v_dot2_f32_bf16 v207, v195, v187, v207
    v_dot2_f32_bf16 v202, v196, v180, v202
    v_dot2_f32_bf16 v203, v196, v188, v203
    v_dot2_f32_bf16 v206, v197, v181, v206
    v_dot2_f32_bf16 v207, v197, v189, v207
    v_dot2_f32_bf16 v202, v198, v182, v202
    v_dot2_f32_bf16 v203, v198, v190, v203
    v_dot2_f32_bf16 v206, v199, v183, v206
    v_dot2_f32_bf16 v207, v199, v191, v207
    ds_write_b128 v162, v[192:195] offset:0
    ds_write_b128 v162, v[196:199] offset:1024
    s_nop 0
    v_pk_add_f32 v[202:203], v[202:203], v[206:207]
    v_add_f32 v202, v202, v203
    v_min_u32 v202, -2, v202
    buffer_load_dwordx4 v[208:211], v7, s[40:43], s5 offen offset:0 sc1
    buffer_load_dwordx4 v[212:215], v7, s[40:43], s5 offen offset:1024 sc1
    s_waitcnt lgkmcnt(0)
    s_barrier
    buffer_load_dwordx4 v[216:219], v7, s[40:43], s6 offen offset:0 sc1
    buffer_load_dwordx4 v[220:223], v7, s[40:43], s6 offen offset:1024 sc1
    buffer_store_dword v202, v164, s[40:43], s21 offen
    buffer_load_dwordx4 v[224:227], v7, s[40:43], s7 offen offset:0 sc1
    buffer_load_dwordx4 v[228:231], v7, s[40:43], s7 offen offset:1024 sc1
    v_mov_b32 v10, v160
    v_mov_b32 v11, v161
    v_lshrrev_b32 v13, 5, v0
    v_bfe_u32 v15, v0, 2, 3
    v_lshl_add_u32 v15, v13, 4, v15
    v_and_b32 v16, 3, v0
    v_lshlrev_b32 v16, 3, v16
    v_mul_u32_u24 v17, 96, v15
    v_add_u32 v17, v17, v16
    v_add_u32 v2, 57856, v17
    v_add_u32 v3, 107008, v17
    v_lshlrev_b32 v17, 7, v15
    v_bfe_u32 v18, v0, 3, 2
    v_lshlrev_b32 v18, 5, v18
    v_add3_u32 v24, v17, v18, v16
    v_xor_b32 v25, 32, v24
    v_xor_b32 v26, 64, v24
    v_xor_b32 v27, 96, v24
    v_lshrrev_b32 v14, 4, v0
    v_lshlrev_b32 v4, 12, v14
    v_bfe_u32 v15, v0, 3, 1
    v_lshl_add_u32 v4, v15, 10, v4
    v_and_b32 v15, 7, v0
    v_lshl_add_u32 v4, v15, 4, v4
    v_and_b32 v15, 15, v0
    v_lshlrev_b32 v15, 4, v15
    v_lshl_add_u32 v5, v14, 10, v15
    v_lshl_add_u32 v6, v13, 8, v15
    v_and_b32 v14, 1, v14
    v_lshl_add_u32 v6, v14, 9, v6
    s_lshl_b32 s50, s48, 2
    s_add_u32 s50, s50, 163744
    v_mov_b32 v14, s50
    v_mov_b32 v15, 163760
    s_waitcnt vmcnt(5)
    v_max_u32 v232, v208, v212
    v_cmp_eq_u32 vcc, -1, v232
    s_cbranch_vccz L_g1r
    s_mov_b32 s54, 131072
L_g1l:
    buffer_load_dwordx4 v[208:211], v7, s[40:43], s5 offen offset:0 sc1
    buffer_load_dwordx4 v[212:215], v7, s[40:43], s5 offen offset:1024 sc1
    s_waitcnt vmcnt(0)
    v_max_u32 v232, v208, v212
    v_cmp_eq_u32 vcc, -1, v232
    s_cbranch_vccz L_g1r
    s_sub_u32 s54, s54, 1
    s_cbranch_scc0 L_g1l
L_g1r:
    ds_write_b128 v162, v[208:211] offset:8192
    ds_write_b128 v162, v[212:215] offset:9216
    buffer_load_dword v233, v164, s[40:43], s9 offen sc1
    buffer_load_dword v234, v164, s[40:43], s10 offen sc1
    buffer_load_dword v235, v164, s[40:43], s11 offen sc1
    s_waitcnt vmcnt(6)
    v_max_u32 v232, v216, v220
    v_cmp_eq_u32 vcc, -1, v232
    s_cbranch_vccz L_g2r
    s_mov_b32 s54, 131072
L_g2l:
    buffer_load_dwordx4 v[216:219], v7, s[40:43], s6 offen offset:0 sc1
    buffer_load_dwordx4 v[220:223], v7, s[40:43], s6 offen offset:1024 sc1
    s_waitcnt vmcnt(0)
    v_max_u32 v232, v216, v220
    v_cmp_eq_u32 vcc, -1, v232
    s_cbranch_vccz L_g2r
    s_sub_u32 s54, s54, 1
    s_cbranch_scc0 L_g2l
L_g2r:
    ds_write_b128 v162, v[216:219] offset:16384
    ds_write_b128 v162, v[220:223] offset:17408
    s_waitcnt lgkmcnt(2)
    s_barrier
    s_waitcnt vmcnt(3)
    v_max_u32 v232, v224, v228
    v_cmp_eq_u32 vcc, -1, v232
    s_cbranch_vccz L_g3r
    s_mov_b32 s54, 131072
L_g3l:
    buffer_load_dwordx4 v[224:227], v7, s[40:43], s7 offen offset:0 sc1
    buffer_load_dwordx4 v[228:231], v7, s[40:43], s7 offen offset:1024 sc1
    s_waitcnt vmcnt(0)
    v_max_u32 v232, v224, v228
    v_cmp_eq_u32 vcc, -1, v232
    s_cbranch_vccz L_g3r
    s_sub_u32 s54, s54, 1
    s_cbranch_scc0 L_g3l
L_g3r:
    ds_write_b128 v162, v[224:227] offset:24576
    ds_write_b128 v162, v[228:231] offset:25600
    s_waitcnt lgkmcnt(2)
    s_barrier
    s_waitcnt vmcnt(0)
    v_max3_u32 v232, v233, v234, v235
    v_cmp_eq_u32 vcc, -1, v232
    s_cbranch_vccz L_gpr
    s_mov_b32 s54, 131072
L_gpl:
    buffer_load_dword v233, v164, s[40:43], s9 offen sc1
    buffer_load_dword v234, v164, s[40:43], s10 offen sc1
    buffer_load_dword v235, v164, s[40:43], s11 offen sc1
    s_waitcnt vmcnt(0)
    v_max3_u32 v232, v233, v234, v235
    v_cmp_eq_u32 vcc, -1, v232
    s_cbranch_vccz L_gpr
    s_sub_u32 s54, s54, 1
    s_cbranch_scc0 L_gpl
L_gpr:
    v_add_f32 v233, v233, v234
    v_add_f32 v202, v202, v235
    v_add_f32 v202, v202, v233
    ds_write_b32 v165, v202
    s_waitcnt lgkmcnt(0)
    s_barrier
    ds_read_b64_tr_b16 v[112:113], v2 offset:0
    ds_read_b64_tr_b16 v[114:115], v2 offset:768
    ds_read_b64_tr_b16 v[116:117], v2 offset:32
    ds_read_b64_tr_b16 v[118:119], v2 offset:800
    ds_read_b64_tr_b16 v[120:121], v2 offset:64
    ds_read_b64_tr_b16 v[122:123], v2 offset:832
    ds_read_b64_tr_b16 v[124:125], v24 offset:33280
    ds_read_b64_tr_b16 v[126:127], v24 offset:34304
    ds_read_b64_tr_b16 v[128:129], v25 offset:33280
    ds_read_b64_tr_b16 v[130:131], v25 offset:34304
    ds_read_b64_tr_b16 v[132:133], v26 offset:33280
    ds_read_b64_tr_b16 v[134:135], v26 offset:34304
    ds_read_b64_tr_b16 v[136:137], v27 offset:33280
    ds_read_b64_tr_b16 v[138:139], v27 offset:34304
    s_barrier
    buffer_load_dwordx4 v[40:43], v4, s[16:19], s68 offen offset:0 sc1
    buffer_load_dwordx4 v[44:47], v4, s[16:19], s68 offen offset:2048 sc1
    s_waitcnt vmcnt(0)
    v_max_u32 v13, v40, v44
    v_cmp_eq_u32 vcc, -1, v13
    s_cbranch_vccz L_a0r
    s_mov_b32 s54, 131072
L_a0l:
    buffer_load_dwordx4 v[40:43], v4, s[16:19], s68 offen offset:0 sc1
    buffer_load_dwordx4 v[44:47], v4, s[16:19], s68 offen offset:2048 sc1
    s_waitcnt vmcnt(0)
    v_max_u32 v13, v40, v44
    v_cmp_eq_u32 vcc, -1, v13
    s_cbranch_vccz L_a0r
    s_sub_u32 s54, s54, 1
    s_cbranch_scc0 L_a0l
L_a0r:
    s_waitcnt lgkmcnt(6)
    v_mfma_f32_16x16x32_bf16 v[144:147], v[112:115], v[40:43], 0
    buffer_load_dwordx4 v[48:51], v4, s[16:19], s70 offen offset:0 sc1
    buffer_load_dwordx4 v[52:55], v4, s[16:19], s70 offen offset:2048 sc1
    ds_read_b64_tr_b16 v[140:141], v2 offset:3072
    v_mfma_f32_16x16x32_bf16 v[148:151], v[112:115], v[44:47], 0
    ds_read_b64_tr_b16 v[142:143], v2 offset:3840
    v_mfma_f32_16x16x32_bf16 v[160:163], v[116:119], v[40:43], 0
    ds_read_b64_tr_b16 v[112:113], v2 offset:3104
    v_mfma_f32_16x16x32_bf16 v[164:167], v[116:119], v[44:47], 0
    ds_read_b64_tr_b16 v[114:115], v2 offset:3872
    v_mfma_f32_16x16x32_bf16 v[176:179], v[120:123], v[40:43], 0
    ds_read_b64_tr_b16 v[116:117], v2 offset:3136
    v_mfma_f32_16x16x32_bf16 v[180:183], v[120:123], v[44:47], 0
    ds_read_b64_tr_b16 v[118:119], v2 offset:3904
    v_mfma_f32_16x16x32_bf16 v[192:195], v[124:127], v[40:43], 0
    buffer_load_dwordx4 v[56:59], v4, s[16:19], s68 offen offset:128 sc1
    buffer_load_dwordx4 v[60:63], v4, s[16:19], s68 offen offset:2176 sc1
    ds_read_b64_tr_b16 v[120:121], v24 offset:37376
    v_mov_b32 v16, 1
    v_mfma_f32_16x16x32_bf16 v[196:199], v[124:127], v[44:47], 0
    ds_read_b64_tr_b16 v[122:123], v24 offset:38400
    ds_write_b32 v14, v16
    s_waitcnt lgkmcnt(7)
    v_mfma_f32_16x16x32_bf16 v[208:211], v[128:131], v[40:43], 0
    ds_read_b64_tr_b16 v[124:125], v25 offset:37376
    v_mfma_f32_16x16x32_bf16 v[212:215], v[128:131], v[44:47], 0
    ds_read_b64_tr_b16 v[126:127], v25 offset:38400
    v_mfma_f32_16x16x32_bf16 v[224:227], v[132:135], v[40:43], 0
    ds_read_b64_tr_b16 v[128:129], v26 offset:37376
    v_mfma_f32_16x16x32_bf16 v[228:231], v[132:135], v[44:47], 0
    ds_read_b64_tr_b16 v[130:131], v26 offset:38400
    v_mfma_f32_16x16x32_bf16 v[240:243], v[136:139], v[40:43], 0
    ds_read_b64_tr_b16 v[132:133], v27 offset:37376
    v_mfma_f32_16x16x32_bf16 v[244:247], v[136:139], v[44:47], 0
    ds_read_b64_tr_b16 v[134:135], v27 offset:38400
    v_mfma_f32_16x16x32_bf16 v[152:155], v[140:143], v[40:43], 0
    ds_read_b64_tr_b16 v[136:137], v2 offset:6144
    v_mfma_f32_16x16x32_bf16 v[156:159], v[140:143], v[44:47], 0
    ds_read_b64_tr_b16 v[138:139], v2 offset:6912
    s_waitcnt lgkmcnt(6)
    v_mfma_f32_16x16x32_bf16 v[168:171], v[112:115], v[40:43], 0
    buffer_load_dwordx4 v[64:67], v4, s[16:19], s70 offen offset:128 sc1
    buffer_load_dwordx4 v[68:71], v4, s[16:19], s70 offen offset:2176 sc1
    ds_read_b64_tr_b16 v[140:141], v2 offset:6176
    v_mfma_f32_16x16x32_bf16 v[172:175], v[112:115], v[44:47], 0
    ds_read_b64_tr_b16 v[142:143], v2 offset:6944
    v_mfma_f32_16x16x32_bf16 v[184:187], v[116:119], v[40:43], 0
    ds_read_b64_tr_b16 v[112:113], v2 offset:6208
    v_mfma_f32_16x16x32_bf16 v[188:191], v[116:119], v[44:47], 0
    ds_read_b64_tr_b16 v[114:115], v2 offset:6976
    v_mfma_f32_16x16x32_bf16 v[200:203], v[120:123], v[40:43], 0
    ds_read_b64_tr_b16 v[116:117], v24 offset:41472
    v_mfma_f32_16x16x32_bf16 v[204:207], v[120:123], v[44:47], 0
    ds_read_b64_tr_b16 v[118:119], v24 offset:42496
    v_mfma_f32_16x16x32_bf16 v[216:219], v[124:127], v[40:43], 0
    ds_read_b64_tr_b16 v[120:121], v25 offset:41472
    v_mfma_f32_16x16x32_bf16 v[220:223], v[124:127], v[44:47], 0
    ds_read_b64_tr_b16 v[122:123], v25 offset:42496
    s_waitcnt vmcnt(4)
    v_max_u32 v13, v48, v52
    v_cmp_eq_u32 vcc, -1, v13
    s_cbranch_vccnz L_a2s
L_a2r:
    s_waitcnt lgkmcnt(6)
    v_mfma_f32_16x16x32_bf16 v[232:235], v[128:131], v[40:43], 0
    ds_read_b64_tr_b16 v[124:125], v26 offset:41472
    v_mfma_f32_16x16x32_bf16 v[236:239], v[128:131], v[44:47], 0
    ds_read_b64_tr_b16 v[126:127], v26 offset:42496
    v_mfma_f32_16x16x32_bf16 v[248:251], v[132:135], v[40:43], 0
    ds_read_b64_tr_b16 v[128:129], v27 offset:41472
    v_mov_b32 v16, 2
    v_mfma_f32_16x16x32_bf16 v[252:255], v[132:135], v[44:47], 0
    ds_read_b64_tr_b16 v[130:131], v27 offset:42496
    ds_write_b32 v14, v16
    v_mfma_f32_16x16x32_bf16 v[144:147], v[136:139], v[48:51], v[144:147]
    ds_read_b64_tr_b16 v[132:133], v2 offset:9216
    v_mfma_f32_16x16x32_bf16 v[148:151], v[136:139], v[52:55], v[148:151]
    ds_read_b64_tr_b16 v[134:135], v2 offset:9984
    v_mfma_f32_16x16x32_bf16 v[160:163], v[140:143], v[48:51], v[160:163]
    buffer_load_dwordx4 v[72:75], v4, s[16:19], s68 offen offset:256 sc1
    buffer_load_dwordx4 v[76:79], v4, s[16:19], s68 offen offset:2304 sc1
    ds_read_b64_tr_b16 v[136:137], v2 offset:9248
    v_mfma_f32_16x16x32_bf16 v[164:167], v[140:143], v[52:55], v[164:167]
    ds_read_b64_tr_b16 v[138:139], v2 offset:10016
    s_waitcnt lgkmcnt(7)
    v_mfma_f32_16x16x32_bf16 v[176:179], v[112:115], v[48:51], v[176:179]
    ds_read_b64_tr_b16 v[140:141], v2 offset:9280
    v_mfma_f32_16x16x32_bf16 v[180:183], v[112:115], v[52:55], v[180:183]
    ds_read_b64_tr_b16 v[142:143], v2 offset:10048
    v_mfma_f32_16x16x32_bf16 v[192:195], v[116:119], v[48:51], v[192:195]
    ds_read_b64_tr_b16 v[112:113], v24 offset:45568
    v_mfma_f32_16x16x32_bf16 v[196:199], v[116:119], v[52:55], v[196:199]
    ds_read_b64_tr_b16 v[114:115], v24 offset:46592
    v_mfma_f32_16x16x32_bf16 v[208:211], v[120:123], v[48:51], v[208:211]
    ds_read_b64_tr_b16 v[116:117], v25 offset:45568
    v_mfma_f32_16x16x32_bf16 v[212:215], v[120:123], v[52:55], v[212:215]
    ds_read_b64_tr_b16 v[118:119], v25 offset:46592
    v_mfma_f32_16x16x32_bf16 v[224:227], v[124:127], v[48:51], v[224:227]
    ds_read_b64_tr_b16 v[120:121], v26 offset:45568
    v_mfma_f32_16x16x32_bf16 v[228:231], v[124:127], v[52:55], v[228:231]
    ds_read_b64_tr_b16 v[122:123], v26 offset:46592
    s_waitcnt lgkmcnt(6)
    v_mfma_f32_16x16x32_bf16 v[240:243], v[128:131], v[48:51], v[240:243]
    ds_read_b64_tr_b16 v[124:125], v27 offset:45568
    v_mfma_f32_16x16x32_bf16 v[244:247], v[128:131], v[52:55], v[244:247]
    ds_read_b64_tr_b16 v[126:127], v27 offset:46592
    v_mfma_f32_16x16x32_bf16 v[152:155], v[132:135], v[48:51], v[152:155]
    ds_read_b64_tr_b16 v[128:129], v2 offset:12288
    v_mfma_f32_16x16x32_bf16 v[156:159], v[132:135], v[52:55], v[156:159]
    ds_read_b64_tr_b16 v[130:131], v2 offset:13056
    v_mfma_f32_16x16x32_bf16 v[168:171], v[136:139], v[48:51], v[168:171]
    buffer_load_dwordx4 v[80:83], v4, s[16:19], s70 offen offset:256 sc1
    buffer_load_dwordx4 v[84:87], v4, s[16:19], s70 offen offset:2304 sc1
    ds_read_b64_tr_b16 v[132:133], v2 offset:12320
    v_mfma_f32_16x16x32_bf16 v[172:175], v[136:139], v[52:55], v[172:175]
    ds_read_b64_tr_b16 v[134:135], v2 offset:13088
    v_mfma_f32_16x16x32_bf16 v[184:187], v[140:143], v[48:51], v[184:187]
    ds_read_b64_tr_b16 v[136:137], v2 offset:12352
    v_mfma_f32_16x16x32_bf16 v[188:191], v[140:143], v[52:55], v[188:191]
    ds_read_b64_tr_b16 v[138:139], v2 offset:13120
    s_waitcnt lgkmcnt(6)
    v_mfma_f32_16x16x32_bf16 v[200:203], v[112:115], v[48:51], v[200:203]
    ds_read_b64_tr_b16 v[140:141], v24 offset:49664
    v_mfma_f32_16x16x32_bf16 v[204:207], v[112:115], v[52:55], v[204:207]
    ds_read_b64_tr_b16 v[142:143], v24 offset:50688
    v_mfma_f32_16x16x32_bf16 v[216:219], v[116:119], v[48:51], v[216:219]
    ds_read_b64_tr_b16 v[112:113], v25 offset:49664
    v_mfma_f32_16x16x32_bf16 v[220:223], v[116:119], v[52:55], v[220:223]
    ds_read_b64_tr_b16 v[114:115], v25 offset:50688
    s_waitcnt vmcnt(4)
    v_max3_u32 v13, v56, v60, v64
    v_max_u32 v13, v13, v68
    v_cmp_eq_u32 vcc, -1, v13
    s_cbranch_vccnz L_a4s
L_a4r:
    v_mfma_f32_16x16x32_bf16 v[232:235], v[120:123], v[48:51], v[232:235]
    ds_read_b64_tr_b16 v[116:117], v26 offset:49664
    v_mfma_f32_16x16x32_bf16 v[236:239], v[120:123], v[52:55], v[236:239]
    ds_read_b64_tr_b16 v[118:119], v26 offset:50688
    v_mfma_f32_16x16x32_bf16 v[248:251], v[124:127], v[48:51], v[248:251]
    ds_read_b64_tr_b16 v[120:121], v27 offset:49664
    v_mov_b32 v16, 3
    v_mfma_f32_16x16x32_bf16 v[252:255], v[124:127], v[52:55], v[252:255]
    ds_read_b64_tr_b16 v[122:123], v27 offset:50688
    ds_write_b32 v14, v16
    s_waitcnt lgkmcnt(7)
    v_mfma_f32_16x16x32_bf16 v[144:147], v[128:131], v[56:59], v[144:147]
    ds_read_b64_tr_b16 v[124:125], v2 offset:15360
    v_mfma_f32_16x16x32_bf16 v[148:151], v[128:131], v[60:63], v[148:151]
    ds_read_b64_tr_b16 v[126:127], v2 offset:16128
    v_mfma_f32_16x16x32_bf16 v[160:163], v[132:135], v[56:59], v[160:163]
    buffer_load_dwordx4 v[88:91], v4, s[16:19], s68 offen offset:384 sc1
    buffer_load_dwordx4 v[92:95], v4, s[16:19], s68 offen offset:2432 sc1
    ds_read_b64_tr_b16 v[128:129], v2 offset:15392
    v_mfma_f32_16x16x32_bf16 v[164:167], v[132:135], v[60:63], v[164:167]
    ds_read_b64_tr_b16 v[130:131], v2 offset:16160
    v_mfma_f32_16x16x32_bf16 v[176:179], v[136:139], v[56:59], v[176:179]
    ds_read_b64_tr_b16 v[132:133], v2 offset:15424
    v_mfma_f32_16x16x32_bf16 v[180:183], v[136:139], v[60:63], v[180:183]
    ds_read_b64_tr_b16 v[134:135], v2 offset:16192
    v_mfma_f32_16x16x32_bf16 v[192:195], v[140:143], v[56:59], v[192:195]
    ds_read_b64_tr_b16 v[136:137], v24 offset:53760
    v_mfma_f32_16x16x32_bf16 v[196:199], v[140:143], v[60:63], v[196:199]
    ds_read_b64_tr_b16 v[138:139], v24 offset:54784
    s_waitcnt lgkmcnt(6)
    v_mfma_f32_16x16x32_bf16 v[208:211], v[112:115], v[56:59], v[208:211]
    ds_read_b64_tr_b16 v[140:141], v25 offset:53760
    v_mfma_f32_16x16x32_bf16 v[212:215], v[112:115], v[60:63], v[212:215]
    ds_read_b64_tr_b16 v[142:143], v25 offset:54784
    v_mfma_f32_16x16x32_bf16 v[224:227], v[116:119], v[56:59], v[224:227]
    ds_read_b64_tr_b16 v[112:113], v26 offset:53760
    ds_read_b128 v[20:23], v15
    v_mfma_f32_16x16x32_bf16 v[228:231], v[116:119], v[60:63], v[228:231]
    ds_read_b64_tr_b16 v[114:115], v26 offset:54784
    v_mfma_f32_16x16x32_bf16 v[240:243], v[120:123], v[56:59], v[240:243]
    ds_read_b64_tr_b16 v[116:117], v27 offset:53760
    v_mfma_f32_16x16x32_bf16 v[244:247], v[120:123], v[60:63], v[244:247]
    ds_read_b64_tr_b16 v[118:119], v27 offset:54784
    v_mfma_f32_16x16x32_bf16 v[152:155], v[124:127], v[56:59], v[152:155]
    ds_read_b64_tr_b16 v[120:121], v2 offset:18432
    v_mfma_f32_16x16x32_bf16 v[156:159], v[124:127], v[60:63], v[156:159]
    ds_read_b64_tr_b16 v[122:123], v2 offset:19200
    s_waitcnt lgkmcnt(7)
    v_mfma_f32_16x16x32_bf16 v[168:171], v[128:131], v[56:59], v[168:171]
    buffer_load_dwordx4 v[96:99], v4, s[16:19], s70 offen offset:384 sc1
    buffer_load_dwordx4 v[100:103], v4, s[16:19], s70 offen offset:2432 sc1
    ds_read_b64_tr_b16 v[124:125], v2 offset:18464
    v_mfma_f32_16x16x32_bf16 v[172:175], v[128:131], v[60:63], v[172:175]
    ds_read_b64_tr_b16 v[126:127], v2 offset:19232
    v_mfma_f32_16x16x32_bf16 v[184:187], v[132:135], v[56:59], v[184:187]
    ds_read_b64_tr_b16 v[128:129], v2 offset:18496
    v_mfma_f32_16x16x32_bf16 v[188:191], v[132:135], v[60:63], v[188:191]
    ds_read_b64_tr_b16 v[130:131], v2 offset:19264
    s_waitcnt lgkmcnt(9)
    v_min3_u32 v20, v20, v21, v22
    v_min_u32 v20, v20, v23
    v_cmp_gt_u32 vcc, 5, v20
    v_mfma_f32_16x16x32_bf16 v[200:203], v[136:139], v[56:59], v[200:203]
    s_cbranch_vccnz L_ld5s
L_ld5r:
    ds_read_b64_tr_b16 v[132:133], v24 offset:0
    v_mfma_f32_16x16x32_bf16 v[204:207], v[136:139], v[60:63], v[204:207]
    ds_read_b64_tr_b16 v[134:135], v24 offset:1024
    v_mfma_f32_16x16x32_bf16 v[216:219], v[140:143], v[56:59], v[216:219]
    ds_read_b64_tr_b16 v[136:137], v25 offset:0
    v_mfma_f32_16x16x32_bf16 v[220:223], v[140:143], v[60:63], v[220:223]
    ds_read_b64_tr_b16 v[138:139], v25 offset:1024
    s_waitcnt lgkmcnt(6)
    v_mfma_f32_16x16x32_bf16 v[232:235], v[112:115], v[56:59], v[232:235]
    ds_read_b64_tr_b16 v[140:141], v26 offset:0
    v_mfma_f32_16x16x32_bf16 v[236:239], v[112:115], v[60:63], v[236:239]
    ds_read_b64_tr_b16 v[142:143], v26 offset:1024
    v_mfma_f32_16x16x32_bf16 v[248:251], v[116:119], v[56:59], v[248:251]
    ds_read_b64_tr_b16 v[112:113], v27 offset:0
    v_mov_b32 v16, 4
    v_mfma_f32_16x16x32_bf16 v[252:255], v[116:119], v[60:63], v[252:255]
    ds_read_b64_tr_b16 v[114:115], v27 offset:1024
    ds_write_b32 v14, v16
    v_mfma_f32_16x16x32_bf16 v[144:147], v[120:123], v[64:67], v[144:147]
    ds_read_b64_tr_b16 v[116:117], v2 offset:21504
    v_mfma_f32_16x16x32_bf16 v[148:151], v[120:123], v[68:71], v[148:151]
    ds_read_b64_tr_b16 v[118:119], v2 offset:22272
    v_mfma_f32_16x16x32_bf16 v[160:163], v[124:127], v[64:67], v[160:163]
    buffer_load_dwordx4 v[104:107], v4, s[16:19], s68 offen offset:512 sc1
    buffer_load_dwordx4 v[108:111], v4, s[16:19], s68 offen offset:2560 sc1
    ds_read_b64_tr_b16 v[120:121], v2 offset:21536
    v_mfma_f32_16x16x32_bf16 v[164:167], v[124:127], v[68:71], v[164:167]
    ds_read_b64_tr_b16 v[122:123], v2 offset:22304
    s_waitcnt lgkmcnt(7)
    v_mfma_f32_16x16x32_bf16 v[176:179], v[128:131], v[64:67], v[176:179]
    ds_read_b64_tr_b16 v[124:125], v2 offset:21568
    v_mfma_f32_16x16x32_bf16 v[180:183], v[128:131], v[68:71], v[180:183]
    ds_read_b64_tr_b16 v[126:127], v2 offset:22336
    v_mfma_f32_16x16x32_bf16 v[192:195], v[132:135], v[64:67], v[192:195]
    ds_read_b64_tr_b16 v[128:129], v24 offset:4096
    v_mfma_f32_16x16x32_bf16 v[196:199], v[132:135], v[68:71], v[196:199]
    ds_read_b64_tr_b16 v[130:131], v24 offset:5120
    v_mfma_f32_16x16x32_bf16 v[208:211], v[136:139], v[64:67], v[208:211]
    ds_read_b64_tr_b16 v[132:133], v25 offset:4096
    v_mfma_f32_16x16x32_bf16 v[212:215], v[136:139], v[68:71], v[212:215]
    ds_read_b64_tr_b16 v[134:135], v25 offset:5120
    v_mfma_f32_16x16x32_bf16 v[224:227], v[140:143], v[64:67], v[224:227]
    ds_read_b64_tr_b16 v[136:137], v26 offset:4096
    v_mfma_f32_16x16x32_bf16 v[228:231], v[140:143], v[68:71], v[228:231]
    ds_read_b64_tr_b16 v[138:139], v26 offset:5120
    s_waitcnt lgkmcnt(6)
    v_mfma_f32_16x16x32_bf16 v[240:243], v[112:115], v[64:67], v[240:243]
    ds_read_b64_tr_b16 v[140:141], v27 offset:4096
    v_mfma_f32_16x16x32_bf16 v[244:247], v[112:115], v[68:71], v[244:247]
    ds_read_b64_tr_b16 v[142:143], v27 offset:5120
    v_mfma_f32_16x16x32_bf16 v[152:155], v[116:119], v[64:67], v[152:155]
    ds_read_b64_tr_b16 v[112:113], v2 offset:24576
    v_mfma_f32_16x16x32_bf16 v[156:159], v[116:119], v[68:71], v[156:159]
    ds_read_b64_tr_b16 v[114:115], v2 offset:25344
    v_mfma_f32_16x16x32_bf16 v[168:171], v[120:123], v[64:67], v[168:171]
    buffer_load_dwordx4 v[40:43], v4, s[16:19], s70 offen offset:512 sc1
    buffer_load_dwordx4 v[44:47], v4, s[16:19], s70 offen offset:2560 sc1
    ds_read_b64_tr_b16 v[116:117], v2 offset:24608
    v_mfma_f32_16x16x32_bf16 v[172:175], v[120:123], v[68:71], v[172:175]
    ds_read_b64_tr_b16 v[118:119], v2 offset:25376
    v_mfma_f32_16x16x32_bf16 v[184:187], v[124:127], v[64:67], v[184:187]
    ds_read_b64_tr_b16 v[120:121], v2 offset:24640
    v_mfma_f32_16x16x32_bf16 v[188:191], v[124:127], v[68:71], v[188:191]
    ds_read_b64_tr_b16 v[122:123], v2 offset:25408
    s_waitcnt lgkmcnt(6)
    v_mfma_f32_16x16x32_bf16 v[200:203], v[128:131], v[64:67], v[200:203]
    ds_read_b64_tr_b16 v[124:125], v24 offset:8192
    v_mfma_f32_16x16x32_bf16 v[204:207], v[128:131], v[68:71], v[204:207]
    ds_read_b64_tr_b16 v[126:127], v24 offset:9216
    v_mfma_f32_16x16x32_bf16 v[216:219], v[132:135], v[64:67], v[216:219]
    ds_read_b64_tr_b16 v[128:129], v25 offset:8192
    v_mfma_f32_16x16x32_bf16 v[220:223], v[132:135], v[68:71], v[220:223]
    ds_read_b64_tr_b16 v[130:131], v25 offset:9216
    s_waitcnt vmcnt(8)
    v_max3_u32 v13, v72, v76, v80
    v_max_u32 v13, v13, v84
    v_cmp_eq_u32 vcc, -1, v13
    s_cbranch_vccnz L_a8s
L_a8r:
    v_mfma_f32_16x16x32_bf16 v[232:235], v[136:139], v[64:67], v[232:235]
    ds_read_b64_tr_b16 v[132:133], v26 offset:8192
    v_mfma_f32_16x16x32_bf16 v[236:239], v[136:139], v[68:71], v[236:239]
    ds_read_b64_tr_b16 v[134:135], v26 offset:9216
    v_mfma_f32_16x16x32_bf16 v[248:251], v[140:143], v[64:67], v[248:251]
    ds_read_b64_tr_b16 v[136:137], v27 offset:8192
    v_mov_b32 v16, 5
    v_mfma_f32_16x16x32_bf16 v[252:255], v[140:143], v[68:71], v[252:255]
    ds_read_b64_tr_b16 v[138:139], v27 offset:9216
    ds_write_b32 v14, v16
    s_waitcnt lgkmcnt(7)
    v_mfma_f32_16x16x32_bf16 v[144:147], v[112:115], v[72:75], v[144:147]
    ds_read_b64_tr_b16 v[140:141], v2 offset:27648
    v_mfma_f32_16x16x32_bf16 v[148:151], v[112:115], v[76:79], v[148:151]
    ds_read_b64_tr_b16 v[142:143], v2 offset:28416
    v_mfma_f32_16x16x32_bf16 v[160:163], v[116:119], v[72:75], v[160:163]
    buffer_load_dwordx4 v[48:51], v4, s[16:19], s68 offen offset:640 sc1
    buffer_load_dwordx4 v[52:55], v4, s[16:19], s68 offen offset:2688 sc1
    ds_read_b64_tr_b16 v[112:113], v2 offset:27680
    v_mfma_f32_16x16x32_bf16 v[164:167], v[116:119], v[76:79], v[164:167]
    ds_read_b64_tr_b16 v[114:115], v2 offset:28448
    v_mfma_f32_16x16x32_bf16 v[176:179], v[120:123], v[72:75], v[176:179]
    ds_read_b64_tr_b16 v[116:117], v2 offset:27712
    v_mfma_f32_16x16x32_bf16 v[180:183], v[120:123], v[76:79], v[180:183]
    ds_read_b64_tr_b16 v[118:119], v2 offset:28480
    v_mfma_f32_16x16x32_bf16 v[192:195], v[124:127], v[72:75], v[192:195]
    ds_read_b64_tr_b16 v[120:121], v24 offset:12288
    v_mfma_f32_16x16x32_bf16 v[196:199], v[124:127], v[76:79], v[196:199]
    ds_read_b64_tr_b16 v[122:123], v24 offset:13312
    s_waitcnt lgkmcnt(6)
    v_mfma_f32_16x16x32_bf16 v[208:211], v[128:131], v[72:75], v[208:211]
    ds_read_b64_tr_b16 v[124:125], v25 offset:12288
    v_mfma_f32_16x16x32_bf16 v[212:215], v[128:131], v[76:79], v[212:215]
    ds_read_b64_tr_b16 v[126:127], v25 offset:13312
    v_mfma_f32_16x16x32_bf16 v[224:227], v[132:135], v[72:75], v[224:227]
    ds_read_b64_tr_b16 v[128:129], v26 offset:12288
    ds_read_b128 v[20:23], v15
    v_mfma_f32_16x16x32_bf16 v[228:231], v[132:135], v[76:79], v[228:231]
    ds_read_b64_tr_b16 v[130:131], v26 offset:13312
    v_mfma_f32_16x16x32_bf16 v[240:243], v[136:139], v[72:75], v[240:243]
    ds_read_b64_tr_b16 v[132:133], v27 offset:12288
    v_mfma_f32_16x16x32_bf16 v[244:247], v[136:139], v[76:79], v[244:247]
    ds_read_b64_tr_b16 v[134:135], v27 offset:13312
    v_mfma_f32_16x16x32_bf16 v[152:155], v[140:143], v[72:75], v[152:155]
    ds_read_b64_tr_b16 v[136:137], v2 offset:30720
    v_mfma_f32_16x16x32_bf16 v[156:159], v[140:143], v[76:79], v[156:159]
    ds_read_b64_tr_b16 v[138:139], v2 offset:31488
    s_waitcnt lgkmcnt(7)
    v_mfma_f32_16x16x32_bf16 v[168:171], v[112:115], v[72:75], v[168:171]
    buffer_load_dwordx4 v[56:59], v4, s[16:19], s70 offen offset:640 sc1
    buffer_load_dwordx4 v[60:63], v4, s[16:19], s70 offen offset:2688 sc1
    ds_read_b64_tr_b16 v[140:141], v2 offset:30752
    v_mfma_f32_16x16x32_bf16 v[172:175], v[112:115], v[76:79], v[172:175]
    ds_read_b64_tr_b16 v[142:143], v2 offset:31520
    v_mfma_f32_16x16x32_bf16 v[184:187], v[116:119], v[72:75], v[184:187]
    ds_read_b64_tr_b16 v[112:113], v2 offset:30784
    v_mfma_f32_16x16x32_bf16 v[188:191], v[116:119], v[76:79], v[188:191]
    ds_read_b64_tr_b16 v[114:115], v2 offset:31552
    s_waitcnt lgkmcnt(9)
    v_min3_u32 v20, v20, v21, v22
    v_min_u32 v20, v20, v23
    v_cmp_gt_u32 vcc, 7, v20
    v_mfma_f32_16x16x32_bf16 v[200:203], v[120:123], v[72:75], v[200:203]
    s_cbranch_vccnz L_ld7s
L_ld7r:
    ds_read_b64_tr_b16 v[116:117], v24 offset:16384
    v_mfma_f32_16x16x32_bf16 v[204:207], v[120:123], v[76:79], v[204:207]
    ds_read_b64_tr_b16 v[118:119], v24 offset:17408
    v_mfma_f32_16x16x32_bf16 v[216:219], v[124:127], v[72:75], v[216:219]
    ds_read_b64_tr_b16 v[120:121], v25 offset:16384
    v_mfma_f32_16x16x32_bf16 v[220:223], v[124:127], v[76:79], v[220:223]
    ds_read_b64_tr_b16 v[122:123], v25 offset:17408
    s_waitcnt lgkmcnt(6)
    v_mfma_f32_16x16x32_bf16 v[232:235], v[128:131], v[72:75], v[232:235]
    ds_read_b64_tr_b16 v[124:125], v26 offset:16384
    v_mfma_f32_16x16x32_bf16 v[236:239], v[128:131], v[76:79], v[236:239]
    ds_read_b64_tr_b16 v[126:127], v26 offset:17408
    v_mfma_f32_16x16x32_bf16 v[248:251], v[132:135], v[72:75], v[248:251]
    ds_read_b64_tr_b16 v[128:129], v27 offset:16384
    v_mov_b32 v16, 6
    v_mfma_f32_16x16x32_bf16 v[252:255], v[132:135], v[76:79], v[252:255]
    ds_read_b64_tr_b16 v[130:131], v27 offset:17408
    ds_write_b32 v14, v16
    v_mfma_f32_16x16x32_bf16 v[144:147], v[136:139], v[80:83], v[144:147]
    ds_read_b64_tr_b16 v[132:133], v2 offset:33792
    v_mfma_f32_16x16x32_bf16 v[148:151], v[136:139], v[84:87], v[148:151]
    ds_read_b64_tr_b16 v[134:135], v2 offset:34560
    v_mfma_f32_16x16x32_bf16 v[160:163], v[140:143], v[80:83], v[160:163]
    buffer_load_dwordx4 v[64:67], v4, s[16:19], s68 offen offset:768 sc1
    buffer_load_dwordx4 v[68:71], v4, s[16:19], s68 offen offset:2816 sc1
    ds_read_b64_tr_b16 v[136:137], v2 offset:33824
    v_mfma_f32_16x16x32_bf16 v[164:167], v[140:143], v[84:87], v[164:167]
    ds_read_b64_tr_b16 v[138:139], v2 offset:34592
    s_waitcnt lgkmcnt(7)
    v_mfma_f32_16x16x32_bf16 v[176:179], v[112:115], v[80:83], v[176:179]
    ds_read_b64_tr_b16 v[140:141], v2 offset:33856
    v_mfma_f32_16x16x32_bf16 v[180:183], v[112:115], v[84:87], v[180:183]
    ds_read_b64_tr_b16 v[142:143], v2 offset:34624
    v_mfma_f32_16x16x32_bf16 v[192:195], v[116:119], v[80:83], v[192:195]
    ds_read_b64_tr_b16 v[112:113], v24 offset:20480
    v_mfma_f32_16x16x32_bf16 v[196:199], v[116:119], v[84:87], v[196:199]
    ds_read_b64_tr_b16 v[114:115], v24 offset:21504
    v_mfma_f32_16x16x32_bf16 v[208:211], v[120:123], v[80:83], v[208:211]
    ds_read_b64_tr_b16 v[116:117], v25 offset:20480
    v_mfma_f32_16x16x32_bf16 v[212:215], v[120:123], v[84:87], v[212:215]
    ds_read_b64_tr_b16 v[118:119], v25 offset:21504
    v_mfma_f32_16x16x32_bf16 v[224:227], v[124:127], v[80:83], v[224:227]
    ds_read_b64_tr_b16 v[120:121], v26 offset:20480
    v_mfma_f32_16x16x32_bf16 v[228:231], v[124:127], v[84:87], v[228:231]
    ds_read_b64_tr_b16 v[122:123], v26 offset:21504
    s_waitcnt lgkmcnt(6)
    v_mfma_f32_16x16x32_bf16 v[240:243], v[128:131], v[80:83], v[240:243]
    ds_read_b64_tr_b16 v[124:125], v27 offset:20480
    v_mfma_f32_16x16x32_bf16 v[244:247], v[128:131], v[84:87], v[244:247]
    ds_read_b64_tr_b16 v[126:127], v27 offset:21504
    s_waitcnt vmcnt(10)
    v_max3_u32 v13, v88, v92, v96
    v_max_u32 v13, v13, v100
    v_cmp_eq_u32 vcc, -1, v13
    s_cbranch_vccnz L_a12s
L_a12r:
    v_mfma_f32_16x16x32_bf16 v[152:155], v[132:135], v[80:83], v[152:155]
    ds_read_b64_tr_b16 v[128:129], v2 offset:36864
    v_mfma_f32_16x16x32_bf16 v[156:159], v[132:135], v[84:87], v[156:159]
    ds_read_b64_tr_b16 v[130:131], v2 offset:37632
    v_mfma_f32_16x16x32_bf16 v[168:171], v[136:139], v[80:83], v[168:171]
    buffer_load_dwordx4 v[72:75], v4, s[16:19], s70 offen offset:768 sc1
    buffer_load_dwordx4 v[76:79], v4, s[16:19], s70 offen offset:2816 sc1
    ds_read_b64_tr_b16 v[132:133], v2 offset:36896
    v_mfma_f32_16x16x32_bf16 v[172:175], v[136:139], v[84:87], v[172:175]
    ds_read_b64_tr_b16 v[134:135], v2 offset:37664
    v_mfma_f32_16x16x32_bf16 v[184:187], v[140:143], v[80:83], v[184:187]
    ds_read_b64_tr_b16 v[136:137], v2 offset:36928
    v_mfma_f32_16x16x32_bf16 v[188:191], v[140:143], v[84:87], v[188:191]
    ds_read_b64_tr_b16 v[138:139], v2 offset:37696
    s_waitcnt lgkmcnt(6)
    v_mfma_f32_16x16x32_bf16 v[200:203], v[112:115], v[80:83], v[200:203]
    ds_read_b64_tr_b16 v[140:141], v24 offset:24576
    v_mfma_f32_16x16x32_bf16 v[204:207], v[112:115], v[84:87], v[204:207]
    ds_read_b64_tr_b16 v[142:143], v24 offset:25600
    v_mfma_f32_16x16x32_bf16 v[216:219], v[116:119], v[80:83], v[216:219]
    ds_read_b64_tr_b16 v[112:113], v25 offset:24576
    v_mfma_f32_16x16x32_bf16 v[220:223], v[116:119], v[84:87], v[220:223]
    ds_read_b64_tr_b16 v[114:115], v25 offset:25600
    v_mfma_f32_16x16x32_bf16 v[232:235], v[120:123], v[80:83], v[232:235]
    ds_read_b64_tr_b16 v[116:117], v26 offset:24576
    v_mfma_f32_16x16x32_bf16 v[236:239], v[120:123], v[84:87], v[236:239]
    ds_read_b64_tr_b16 v[118:119], v26 offset:25600
    v_mfma_f32_16x16x32_bf16 v[248:251], v[124:127], v[80:83], v[248:251]
    ds_read_b64_tr_b16 v[120:121], v27 offset:24576
    v_mov_b32 v16, 7
    v_mfma_f32_16x16x32_bf16 v[252:255], v[124:127], v[84:87], v[252:255]
    ds_read_b64_tr_b16 v[122:123], v27 offset:25600
    ds_write_b32 v14, v16
    s_waitcnt lgkmcnt(7)
    v_mfma_f32_16x16x32_bf16 v[144:147], v[128:131], v[88:91], v[144:147]
    ds_read_b64_tr_b16 v[124:125], v2 offset:39936
    v_mfma_f32_16x16x32_bf16 v[148:151], v[128:131], v[92:95], v[148:151]
    ds_read_b64_tr_b16 v[126:127], v2 offset:40704
    v_mfma_f32_16x16x32_bf16 v[160:163], v[132:135], v[88:91], v[160:163]
    buffer_load_dwordx4 v[80:83], v4, s[16:19], s68 offen offset:896 sc1
    buffer_load_dwordx4 v[84:87], v4, s[16:19], s68 offen offset:2944 sc1
    ds_read_b64_tr_b16 v[128:129], v2 offset:39968
    v_mfma_f32_16x16x32_bf16 v[164:167], v[132:135], v[92:95], v[164:167]
    ds_read_b64_tr_b16 v[130:131], v2 offset:40736
    v_mfma_f32_16x16x32_bf16 v[176:179], v[136:139], v[88:91], v[176:179]
    ds_read_b64_tr_b16 v[132:133], v2 offset:40000
    v_mfma_f32_16x16x32_bf16 v[180:183], v[136:139], v[92:95], v[180:183]
    ds_read_b64_tr_b16 v[134:135], v2 offset:40768
    v_mfma_f32_16x16x32_bf16 v[192:195], v[140:143], v[88:91], v[192:195]
    ds_read_b64_tr_b16 v[136:137], v24 offset:28672
    v_mfma_f32_16x16x32_bf16 v[196:199], v[140:143], v[92:95], v[196:199]
    ds_read_b64_tr_b16 v[138:139], v24 offset:29696
    s_waitcnt lgkmcnt(6)
    v_mfma_f32_16x16x32_bf16 v[208:211], v[112:115], v[88:91], v[208:211]
    buffer_load_dwordx4 v[28:31], v5, s[40:43], s25 offen offset:512 sc1
    buffer_load_dwordx4 v[32:35], v5, s[40:43], s25 offen offset:768 sc1
    ds_read_b64_tr_b16 v[140:141], v25 offset:28672
    v_mfma_f32_16x16x32_bf16 v[212:215], v[112:115], v[92:95], v[212:215]
    ds_read_b64_tr_b16 v[142:143], v25 offset:29696
    v_mfma_f32_16x16x32_bf16 v[224:227], v[116:119], v[88:91], v[224:227]
    ds_read_b64_tr_b16 v[112:113], v26 offset:28672
    ds_read_b128 v[20:23], v15
    v_mfma_f32_16x16x32_bf16 v[228:231], v[116:119], v[92:95], v[228:231]
    ds_read_b64_tr_b16 v[114:115], v26 offset:29696
    v_mfma_f32_16x16x32_bf16 v[240:243], v[120:123], v[88:91], v[240:243]
    ds_read_b64_tr_b16 v[116:117], v27 offset:28672
    v_mfma_f32_16x16x32_bf16 v[244:247], v[120:123], v[92:95], v[244:247]
    ds_read_b64_tr_b16 v[118:119], v27 offset:29696
    v_mfma_f32_16x16x32_bf16 v[152:155], v[124:127], v[88:91], v[152:155]
    ds_read_b64_tr_b16 v[120:121], v2 offset:43008
    v_mfma_f32_16x16x32_bf16 v[156:159], v[124:127], v[92:95], v[156:159]
    ds_read_b64_tr_b16 v[122:123], v2 offset:43776
    s_waitcnt lgkmcnt(7)
    v_mfma_f32_16x16x32_bf16 v[168:171], v[128:131], v[88:91], v[168:171]
    ds_read_b64_tr_b16 v[124:125], v2 offset:43040
    v_mfma_f32_16x16x32_bf16 v[172:175], v[128:131], v[92:95], v[172:175]
    ds_read_b64_tr_b16 v[126:127], v2 offset:43808
    v_mfma_f32_16x16x32_bf16 v[184:187], v[132:135], v[88:91], v[184:187]
    ds_read_b64_tr_b16 v[128:129], v2 offset:43072
    v_mfma_f32_16x16x32_bf16 v[188:191], v[132:135], v[92:95], v[188:191]
    ds_read_b64_tr_b16 v[130:131], v2 offset:43840
    s_waitcnt lgkmcnt(9)
    v_min3_u32 v20, v20, v21, v22
    v_min_u32 v20, v20, v23
    v_cmp_gt_u32 vcc, 9, v20
    v_mfma_f32_16x16x32_bf16 v[200:203], v[136:139], v[88:91], v[200:203]
    s_cbranch_vccnz L_ld9s
L_ld9r:
    ds_read_b64_tr_b16 v[132:133], v24 offset:33280
    v_mfma_f32_16x16x32_bf16 v[204:207], v[136:139], v[92:95], v[204:207]
    ds_read_b64_tr_b16 v[134:135], v24 offset:34304
    v_mfma_f32_16x16x32_bf16 v[216:219], v[140:143], v[88:91], v[216:219]
    ds_read_b64_tr_b16 v[136:137], v25 offset:33280
    v_mfma_f32_16x16x32_bf16 v[220:223], v[140:143], v[92:95], v[220:223]
    ds_read_b64_tr_b16 v[138:139], v25 offset:34304
    s_waitcnt lgkmcnt(6)
    v_mfma_f32_16x16x32_bf16 v[232:235], v[112:115], v[88:91], v[232:235]
    ds_read_b64_tr_b16 v[140:141], v26 offset:33280
    v_mfma_f32_16x16x32_bf16 v[236:239], v[112:115], v[92:95], v[236:239]
    ds_read_b64_tr_b16 v[142:143], v26 offset:34304
    s_waitcnt vmcnt(12)
    v_max3_u32 v13, v104, v108, v40
    v_max_u32 v13, v13, v44
    v_cmp_eq_u32 vcc, -1, v13
    s_cbranch_vccnz L_a16s
L_a16r:
    v_mfma_f32_16x16x32_bf16 v[248:251], v[116:119], v[88:91], v[248:251]
    ds_read_b64_tr_b16 v[112:113], v27 offset:33280
    v_mov_b32 v16, 8
    v_mfma_f32_16x16x32_bf16 v[252:255], v[116:119], v[92:95], v[252:255]
    ds_read_b64_tr_b16 v[114:115], v27 offset:34304
    ds_write_b32 v14, v16
    v_mfma_f32_16x16x32_bf16 v[144:147], v[120:123], v[96:99], v[144:147]
    ds_read_b64_tr_b16 v[116:117], v2 offset:46080
    v_mfma_f32_16x16x32_bf16 v[148:151], v[120:123], v[100:103], v[148:151]
    ds_read_b64_tr_b16 v[118:119], v2 offset:46848
    v_mfma_f32_16x16x32_bf16 v[160:163], v[124:127], v[96:99], v[160:163]
    buffer_load_dwordx4 v[88:91], v4, s[16:19], s70 offen offset:896 sc1
    buffer_load_dwordx4 v[92:95], v4, s[16:19], s70 offen offset:2944 sc1
    ds_read_b64_tr_b16 v[120:121], v2 offset:46112
    v_mfma_f32_16x16x32_bf16 v[164:167], v[124:127], v[100:103], v[164:167]
    ds_read_b64_tr_b16 v[122:123], v2 offset:46880
    s_waitcnt lgkmcnt(7)
    v_mfma_f32_16x16x32_bf16 v[176:179], v[128:131], v[96:99], v[176:179]
    ds_read_b64_tr_b16 v[124:125], v2 offset:46144
    v_mfma_f32_16x16x32_bf16 v[180:183], v[128:131], v[100:103], v[180:183]
    ds_read_b64_tr_b16 v[126:127], v2 offset:46912
    v_mfma_f32_16x16x32_bf16 v[192:195], v[132:135], v[96:99], v[192:195]
    ds_read_b64_tr_b16 v[128:129], v24 offset:37376
    v_mfma_f32_16x16x32_bf16 v[196:199], v[132:135], v[100:103], v[196:199]
    ds_read_b64_tr_b16 v[130:131], v24 offset:38400
    v_mfma_f32_16x16x32_bf16 v[208:211], v[136:139], v[96:99], v[208:211]
    ds_read_b64_tr_b16 v[132:133], v25 offset:37376
    v_mfma_f32_16x16x32_bf16 v[212:215], v[136:139], v[100:103], v[212:215]
    ds_read_b64_tr_b16 v[134:135], v25 offset:38400
    v_mfma_f32_16x16x32_bf16 v[224:227], v[140:143], v[96:99], v[224:227]
    ds_read_b64_tr_b16 v[136:137], v26 offset:37376
    v_mfma_f32_16x16x32_bf16 v[228:231], v[140:143], v[100:103], v[228:231]
    ds_read_b64_tr_b16 v[138:139], v26 offset:38400
    s_waitcnt vmcnt(10)
    v_max3_u32 v13, v48, v52, v56
    v_max_u32 v13, v13, v60
    v_cmp_eq_u32 vcc, -1, v13
    s_cbranch_vccnz L_a20s
L_a20r:
    s_waitcnt lgkmcnt(6)
    v_mfma_f32_16x16x32_bf16 v[240:243], v[112:115], v[96:99], v[240:243]
    ds_read_b64_tr_b16 v[140:141], v27 offset:37376
    v_mfma_f32_16x16x32_bf16 v[244:247], v[112:115], v[100:103], v[244:247]
    ds_read_b64_tr_b16 v[142:143], v27 offset:38400
    v_mfma_f32_16x16x32_bf16 v[152:155], v[116:119], v[96:99], v[152:155]
    ds_read_b64_tr_b16 v[112:113], v3 offset:0
    v_mfma_f32_16x16x32_bf16 v[156:159], v[116:119], v[100:103], v[156:159]
    ds_read_b64_tr_b16 v[114:115], v3 offset:768
    v_mfma_f32_16x16x32_bf16 v[168:171], v[120:123], v[96:99], v[168:171]
    ds_read_b64_tr_b16 v[116:117], v3 offset:32
    v_mfma_f32_16x16x32_bf16 v[172:175], v[120:123], v[100:103], v[172:175]
    ds_read_b64_tr_b16 v[118:119], v3 offset:800
    v_mfma_f32_16x16x32_bf16 v[184:187], v[124:127], v[96:99], v[184:187]
    ds_read_b64_tr_b16 v[120:121], v3 offset:64
    v_mfma_f32_16x16x32_bf16 v[188:191], v[124:127], v[100:103], v[188:191]
    ds_read_b64_tr_b16 v[122:123], v3 offset:832
    s_waitcnt lgkmcnt(6)
    v_mfma_f32_16x16x32_bf16 v[200:203], v[128:131], v[96:99], v[200:203]
    ds_read_b64_tr_b16 v[124:125], v24 offset:41472
    v_mfma_f32_16x16x32_bf16 v[204:207], v[128:131], v[100:103], v[204:207]
    ds_read_b64_tr_b16 v[126:127], v24 offset:42496
    v_mfma_f32_16x16x32_bf16 v[216:219], v[132:135], v[96:99], v[216:219]
    ds_read_b64_tr_b16 v[128:129], v25 offset:41472
    v_mfma_f32_16x16x32_bf16 v[220:223], v[132:135], v[100:103], v[220:223]
    ds_read_b64_tr_b16 v[130:131], v25 offset:42496
    v_mfma_f32_16x16x32_bf16 v[232:235], v[136:139], v[96:99], v[232:235]
    ds_read_b64_tr_b16 v[132:133], v26 offset:41472
    v_mfma_f32_16x16x32_bf16 v[236:239], v[136:139], v[100:103], v[236:239]
    ds_read_b64_tr_b16 v[134:135], v26 offset:42496
    s_waitcnt vmcnt(6)
    v_max3_u32 v13, v64, v68, v72
    v_max_u32 v13, v13, v76
    v_cmp_eq_u32 vcc, -1, v13
    s_cbranch_vccnz L_a24s
L_a24r:
    v_mfma_f32_16x16x32_bf16 v[248:251], v[140:143], v[96:99], v[248:251]
    ds_read_b64_tr_b16 v[136:137], v27 offset:41472
    v_mov_b32 v16, 9
    v_mfma_f32_16x16x32_bf16 v[252:255], v[140:143], v[100:103], v[252:255]
    ds_read_b64_tr_b16 v[138:139], v27 offset:42496
    ds_write_b32 v14, v16
    s_waitcnt lgkmcnt(7)
    v_mfma_f32_16x16x32_bf16 v[144:147], v[112:115], v[104:107], v[144:147]
    ds_read_b64_tr_b16 v[140:141], v3 offset:3072
    v_mfma_f32_16x16x32_bf16 v[148:151], v[112:115], v[108:111], v[148:151]
    ds_read_b64_tr_b16 v[142:143], v3 offset:3840
    s_waitcnt vmcnt(2)
    v_mfma_f32_16x16x32_bf16 v[160:163], v[116:119], v[104:107], v[160:163]
    ds_read_b64_tr_b16 v[112:113], v3 offset:3104
    v_max3_u32 v36, v28, v29, v30
    v_max3_u32 v36, v36, v31, v32
    v_max3_u32 v36, v36, v33, v34
    v_max_u32 v36, v36, v35
    v_cmp_eq_u32 vcc, -1, v36
    s_cbranch_vccnz L_sts
L_str:
    v_mfma_f32_16x16x32_bf16 v[164:167], v[116:119], v[108:111], v[164:167]
    ds_read_b64_tr_b16 v[114:115], v3 offset:3872
    v_add_f32 v28, v28, v29
    v_mfma_f32_16x16x32_bf16 v[176:179], v[120:123], v[104:107], v[176:179]
    ds_read_b64_tr_b16 v[116:117], v3 offset:3136
    v_add_f32 v30, v30, v31
    v_mfma_f32_16x16x32_bf16 v[180:183], v[120:123], v[108:111], v[180:183]
    ds_read_b64_tr_b16 v[118:119], v3 offset:3904
    v_add_f32 v32, v32, v33
    v_mfma_f32_16x16x32_bf16 v[192:195], v[124:127], v[104:107], v[192:195]
    ds_read_b64_tr_b16 v[120:121], v24 offset:45568
    v_add_f32 v34, v34, v35
    v_mfma_f32_16x16x32_bf16 v[196:199], v[124:127], v[108:111], v[196:199]
    ds_read_b64_tr_b16 v[122:123], v24 offset:46592
    v_add_f32 v28, v28, v30
    s_waitcnt lgkmcnt(6)
    v_mfma_f32_16x16x32_bf16 v[208:211], v[128:131], v[104:107], v[208:211]
    ds_read_b64_tr_b16 v[124:125], v25 offset:45568
    v_add_f32 v32, v32, v34
    v_mfma_f32_16x16x32_bf16 v[212:215], v[128:131], v[108:111], v[212:215]
    ds_read_b64_tr_b16 v[126:127], v25 offset:46592
    v_permlane16_swap_b32 v28, v32
    v_mfma_f32_16x16x32_bf16 v[224:227], v[132:135], v[104:107], v[224:227]
    ds_read_b64_tr_b16 v[128:129], v26 offset:45568
    v_add_f32 v28, v28, v32
    v_mfma_f32_16x16x32_bf16 v[228:231], v[132:135], v[108:111], v[228:231]
    ds_read_b64_tr_b16 v[130:131], v26 offset:46592
    v_mov_b32 v32, v28
    v_mfma_f32_16x16x32_bf16 v[240:243], v[136:139], v[104:107], v[240:243]
    ds_read_b64_tr_b16 v[132:133], v27 offset:45568
    v_mov_b32 v30, 0x3727c5ac
    v_mfma_f32_16x16x32_bf16 v[244:247], v[136:139], v[108:111], v[244:247]
    ds_read_b64_tr_b16 v[134:135], v27 offset:46592
    v_permlane32_swap_b32 v28, v32
    v_mfma_f32_16x16x32_bf16 v[152:155], v[140:143], v[104:107], v[152:155]
    ds_read_b64_tr_b16 v[136:137], v3 offset:6144
    v_add_f32 v28, v28, v32
    v_mfma_f32_16x16x32_bf16 v[156:159], v[140:143], v[108:111], v[156:159]
    ds_read_b64_tr_b16 v[138:139], v3 offset:6912
    v_fmac_f32 v30, 0x3b000000, v28
    s_waitcnt lgkmcnt(6)
    v_mfma_f32_16x16x32_bf16 v[168:171], v[112:115], v[104:107], v[168:171]
    ds_read_b64_tr_b16 v[140:141], v3 offset:12288
    v_rsq_f32 v31, v30
    v_mfma_f32_16x16x32_bf16 v[172:175], v[112:115], v[108:111], v[172:175]
    ds_read_b64_tr_b16 v[142:143], v3 offset:13056
    v_sqrt_f32 v17, v30
    v_mfma_f32_16x16x32_bf16 v[184:187], v[116:119], v[104:107], v[184:187]
    ds_read_b64_tr_b16 v[112:113], v3 offset:18432
    v_sqrt_f32 v18, v30
    v_mfma_f32_16x16x32_bf16 v[188:191], v[116:119], v[108:111], v[188:191]
    ds_read_b64_tr_b16 v[114:115], v3 offset:19200
    v_mul_f32 v8, 0xbfb8aa3b, v31
    v_mfma_f32_16x16x32_bf16 v[200:203], v[120:123], v[104:107], v[200:203]
    ds_read_b64_tr_b16 v[116:117], v3 offset:24576
    v_mul_f32 v9, 0xbfb8aa3b, v31
    v_mfma_f32_16x16x32_bf16 v[204:207], v[120:123], v[108:111], v[204:207]
    ds_read_b64_tr_b16 v[118:119], v3 offset:25344
    v_permlane16_swap_b32 v17, v18
    v_mfma_f32_16x16x32_bf16 v[216:219], v[124:127], v[104:107], v[216:219]
    ds_read_b64_tr_b16 v[120:121], v3 offset:30720
    v_permlane16_swap_b32 v8, v9
    v_mfma_f32_16x16x32_bf16 v[220:223], v[124:127], v[108:111], v[220:223]
    ds_read_b64_tr_b16 v[122:123], v3 offset:31488
    s_waitcnt lgkmcnt(6)
    v_mfma_f32_16x16x32_bf16 v[232:235], v[128:131], v[104:107], v[232:235]
    ds_read_b64_tr_b16 v[124:125], v3 offset:36864
    v_mfma_f32_16x16x32_bf16 v[236:239], v[128:131], v[108:111], v[236:239]
    ds_read_b64_tr_b16 v[126:127], v3 offset:37632
    s_waitcnt vmcnt(0)
    v_max3_u32 v13, v80, v84, v88
    v_max_u32 v13, v13, v92
    v_cmp_eq_u32 vcc, -1, v13
    s_cbranch_vccnz L_a28s
L_a28r:
    v_mfma_f32_16x16x32_bf16 v[248:251], v[132:135], v[104:107], v[248:251]
    ds_read_b64_tr_b16 v[128:129], v3 offset:43008
    v_mfma_f32_16x16x32_bf16 v[252:255], v[132:135], v[108:111], v[252:255]
    ds_read_b64_tr_b16 v[130:131], v3 offset:43776
    v_mfma_f32_16x16x32_bf16 v[144:147], v[136:139], v[40:43], v[144:147]
    ds_read_b64_tr_b16 v[132:133], v3 offset:9216
    v_mfma_f32_16x16x32_bf16 v[148:151], v[136:139], v[44:47], v[148:151]
    ds_read_b64_tr_b16 v[134:135], v3 offset:9984
    v_mfma_f32_16x16x32_bf16 v[144:147], v[140:143], v[48:51], v[144:147]
    ds_read_b64_tr_b16 v[136:137], v3 offset:15360
    v_mfma_f32_16x16x32_bf16 v[148:151], v[140:143], v[52:55], v[148:151]
    ds_read_b64_tr_b16 v[138:139], v3 offset:16128
    s_waitcnt lgkmcnt(6)
    v_mfma_f32_16x16x32_bf16 v[144:147], v[112:115], v[56:59], v[144:147]
    ds_read_b64_tr_b16 v[140:141], v3 offset:21504
    v_mfma_f32_16x16x32_bf16 v[148:151], v[112:115], v[60:63], v[148:151]
    ds_read_b64_tr_b16 v[142:143], v3 offset:22272
    v_mfma_f32_16x16x32_bf16 v[144:147], v[116:119], v[64:67], v[144:147]
    ds_read_b64_tr_b16 v[112:113], v3 offset:27648
    v_mfma_f32_16x16x32_bf16 v[148:151], v[116:119], v[68:71], v[148:151]
    ds_read_b64_tr_b16 v[114:115], v3 offset:28416
    v_mfma_f32_16x16x32_bf16 v[144:147], v[120:123], v[72:75], v[144:147]
    ds_read_b64_tr_b16 v[116:117], v3 offset:33792
    v_mfma_f32_16x16x32_bf16 v[148:151], v[120:123], v[76:79], v[148:151]
    ds_read_b64_tr_b16 v[118:119], v3 offset:34560
    v_mfma_f32_16x16x32_bf16 v[144:147], v[124:127], v[80:83], v[144:147]
    ds_read_b64_tr_b16 v[120:121], v3 offset:39936
    v_mfma_f32_16x16x32_bf16 v[148:151], v[124:127], v[84:87], v[148:151]
    ds_read_b64_tr_b16 v[122:123], v3 offset:40704
    s_waitcnt lgkmcnt(6)
    v_mfma_f32_16x16x32_bf16 v[144:147], v[128:131], v[88:91], v[144:147]
    ds_read_b64_tr_b16 v[124:125], v3 offset:46080
    v_mfma_f32_16x16x32_bf16 v[148:151], v[128:131], v[92:95], v[148:151]
    ds_read_b64_tr_b16 v[126:127], v3 offset:46848
    v_mfma_f32_16x16x32_bf16 v[152:155], v[132:135], v[40:43], v[152:155]
    ds_read_b64_tr_b16 v[128:129], v3 offset:6176
    v_mfma_f32_16x16x32_bf16 v[156:159], v[132:135], v[44:47], v[156:159]
    ds_read_b64_tr_b16 v[130:131], v3 offset:6944
    v_mfma_f32_16x16x32_bf16 v[152:155], v[136:139], v[48:51], v[152:155]
    ds_read_b64_tr_b16 v[132:133], v3 offset:12320
    v_mfma_f32_16x16x32_bf16 v[156:159], v[136:139], v[52:55], v[156:159]
    ds_read_b64_tr_b16 v[134:135], v3 offset:13088
    v_mul_f32 v144, v8, v144
    v_mul_f32 v145, v8, v145
    v_mul_f32 v146, v8, v146
    v_mfma_f32_16x16x32_bf16 v[152:155], v[140:143], v[56:59], v[152:155]
    ds_read_b64_tr_b16 v[136:137], v3 offset:18464
    v_mul_f32 v147, v8, v147
    v_mul_f32 v148, v9, v148
    v_mfma_f32_16x16x32_bf16 v[156:159], v[140:143], v[60:63], v[156:159]
    ds_read_b64_tr_b16 v[138:139], v3 offset:19232
    v_mul_f32 v149, v9, v149
    v_mul_f32 v150, v9, v150
    v_mul_f32 v151, v9, v151
    s_waitcnt lgkmcnt(6)
    v_mfma_f32_16x16x32_bf16 v[152:155], v[112:115], v[64:67], v[152:155]
    ds_read_b64_tr_b16 v[140:141], v3 offset:24608
    v_exp_f32 v144, v144
    v_mfma_f32_16x16x32_bf16 v[156:159], v[112:115], v[68:71], v[156:159]
    ds_read_b64_tr_b16 v[142:143], v3 offset:25376
    v_exp_f32 v145, v145
    v_mfma_f32_16x16x32_bf16 v[152:155], v[116:119], v[72:75], v[152:155]
    ds_read_b64_tr_b16 v[112:113], v3 offset:30752
    v_exp_f32 v146, v146
    v_exp_f32 v147, v147
    v_mfma_f32_16x16x32_bf16 v[156:159], v[116:119], v[76:79], v[156:159]
    ds_read_b64_tr_b16 v[114:115], v3 offset:31520
    v_exp_f32 v148, v148
    v_mfma_f32_16x16x32_bf16 v[152:155], v[120:123], v[80:83], v[152:155]
    ds_read_b64_tr_b16 v[116:117], v3 offset:36896
    v_exp_f32 v149, v149
    v_mfma_f32_16x16x32_bf16 v[156:159], v[120:123], v[84:87], v[156:159]
    ds_read_b64_tr_b16 v[118:119], v3 offset:37664
    v_exp_f32 v150, v150
    v_mfma_f32_16x16x32_bf16 v[152:155], v[124:127], v[88:91], v[152:155]
    ds_read_b64_tr_b16 v[120:121], v3 offset:43040
    v_exp_f32 v151, v151
    v_mfma_f32_16x16x32_bf16 v[156:159], v[124:127], v[92:95], v[156:159]
    ds_read_b64_tr_b16 v[122:123], v3 offset:43808
    v_fma_f32 v144, v144, v17, v17
    v_fma_f32 v145, v145, v17, v17
    v_fma_f32 v146, v146, v17, v17
    s_waitcnt lgkmcnt(6)
    v_mfma_f32_16x16x32_bf16 v[160:163], v[128:131], v[40:43], v[160:163]
    ds_read_b64_tr_b16 v[124:125], v3 offset:9248
    v_fma_f32 v147, v147, v17, v17
    v_fma_f32 v148, v148, v18, v18
    v_mfma_f32_16x16x32_bf16 v[164:167], v[128:131], v[44:47], v[164:167]
    ds_read_b64_tr_b16 v[126:127], v3 offset:10016
    v_fma_f32 v149, v149, v18, v18
    v_fma_f32 v150, v150, v18, v18
    v_mfma_f32_16x16x32_bf16 v[160:163], v[132:135], v[48:51], v[160:163]
    ds_read_b64_tr_b16 v[128:129], v3 offset:15392
    v_fma_f32 v151, v151, v18, v18
    v_rcp_f32 v144, v144
    v_mfma_f32_16x16x32_bf16 v[164:167], v[132:135], v[52:55], v[164:167]
    ds_read_b64_tr_b16 v[130:131], v3 offset:16160
    v_rcp_f32 v145, v145
    v_mfma_f32_16x16x32_bf16 v[160:163], v[136:139], v[56:59], v[160:163]
    ds_read_b64_tr_b16 v[132:133], v3 offset:21536
    v_rcp_f32 v146, v146
    v_rcp_f32 v147, v147
    v_mfma_f32_16x16x32_bf16 v[164:167], v[136:139], v[60:63], v[164:167]
    ds_read_b64_tr_b16 v[134:135], v3 offset:22304
    v_rcp_f32 v148, v148
    v_mfma_f32_16x16x32_bf16 v[160:163], v[140:143], v[64:67], v[160:163]
    ds_read_b64_tr_b16 v[136:137], v3 offset:27680
    v_rcp_f32 v149, v149
    v_mfma_f32_16x16x32_bf16 v[164:167], v[140:143], v[68:71], v[164:167]
    ds_read_b64_tr_b16 v[138:139], v3 offset:28448
    v_rcp_f32 v150, v150
    s_waitcnt lgkmcnt(6)
    v_mfma_f32_16x16x32_bf16 v[160:163], v[112:115], v[72:75], v[160:163]
    ds_read_b64_tr_b16 v[140:141], v3 offset:33824
    v_rcp_f32 v151, v151
    v_mfma_f32_16x16x32_bf16 v[164:167], v[112:115], v[76:79], v[164:167]
    ds_read_b64_tr_b16 v[142:143], v3 offset:34592
    v_mul_f32 v144, v144, v152
    v_mul_f32 v145, v145, v153
    v_mul_f32 v146, v146, v154
    v_mfma_f32_16x16x32_bf16 v[160:163], v[116:119], v[80:83], v[160:163]
    ds_read_b64_tr_b16 v[112:113], v3 offset:39968
    v_mul_f32 v147, v147, v155
    v_mul_f32 v148, v148, v156
    v_mfma_f32_16x16x32_bf16 v[164:167], v[116:119], v[84:87], v[164:167]
    ds_read_b64_tr_b16 v[114:115], v3 offset:40736
    v_mul_f32 v149, v149, v157
    v_mul_f32 v150, v150, v158
    v_mfma_f32_16x16x32_bf16 v[160:163], v[120:123], v[88:91], v[160:163]
    ds_read_b64_tr_b16 v[116:117], v3 offset:46112
    v_mul_f32 v151, v151, v159
    v_cvt_pk_bf16_f32 v152, v144, v145
    v_cvt_pk_bf16_f32 v154, v148, v149
    v_mfma_f32_16x16x32_bf16 v[164:167], v[120:123], v[92:95], v[164:167]
    ds_read_b64_tr_b16 v[118:119], v3 offset:46880
    v_cvt_pk_bf16_f32 v153, v146, v147
    v_cvt_pk_bf16_f32 v155, v150, v151
    v_mfma_f32_16x16x32_bf16 v[168:171], v[124:127], v[40:43], v[168:171]
    ds_read_b64_tr_b16 v[120:121], v3 offset:6208
    v_permlane32_swap_b32 v152, v154
    s_nop 0
    v_permlane32_swap_b32 v153, v155
    v_mfma_f32_16x16x32_bf16 v[172:175], v[124:127], v[44:47], v[172:175]
    buffer_store_dwordx4 v[152:155], v6, s[40:43], s26 offen offset:0 sc1
    ds_read_b64_tr_b16 v[122:123], v3 offset:6976
    s_waitcnt lgkmcnt(6)
    v_mfma_f32_16x16x32_bf16 v[168:171], v[128:131], v[48:51], v[168:171]
    ds_read_b64_tr_b16 v[124:125], v3 offset:12352
    v_mfma_f32_16x16x32_bf16 v[172:175], v[128:131], v[52:55], v[172:175]
    ds_read_b64_tr_b16 v[126:127], v3 offset:13120
    v_mul_f32 v160, v8, v160
    v_mul_f32 v161, v8, v161
    v_mul_f32 v162, v8, v162
    v_mfma_f32_16x16x32_bf16 v[168:171], v[132:135], v[56:59], v[168:171]
    ds_read_b64_tr_b16 v[128:129], v3 offset:18496
    v_mul_f32 v163, v8, v163
    v_mul_f32 v164, v9, v164
    v_mfma_f32_16x16x32_bf16 v[172:175], v[132:135], v[60:63], v[172:175]
    ds_read_b64_tr_b16 v[130:131], v3 offset:19264
    v_mul_f32 v165, v9, v165
    v_mul_f32 v166, v9, v166
    v_mul_f32 v167, v9, v167
    v_mfma_f32_16x16x32_bf16 v[168:171], v[136:139], v[64:67], v[168:171]
    ds_read_b64_tr_b16 v[132:133], v3 offset:24640
    v_exp_f32 v160, v160
    v_mfma_f32_16x16x32_bf16 v[172:175], v[136:139], v[68:71], v[172:175]
    ds_read_b64_tr_b16 v[134:135], v3 offset:25408
    v_exp_f32 v161, v161
    v_mfma_f32_16x16x32_bf16 v[168:171], v[140:143], v[72:75], v[168:171]
    ds_read_b64_tr_b16 v[136:137], v3 offset:30784
    v_exp_f32 v162, v162
    v_exp_f32 v163, v163
    v_mfma_f32_16x16x32_bf16 v[172:175], v[140:143], v[76:79], v[172:175]
    ds_read_b64_tr_b16 v[138:139], v3 offset:31552
    v_exp_f32 v164, v164
    s_waitcnt lgkmcnt(6)
    v_mfma_f32_16x16x32_bf16 v[168:171], v[112:115], v[80:83], v[168:171]
    ds_read_b64_tr_b16 v[140:141], v3 offset:36928
    v_exp_f32 v165, v165
    v_mfma_f32_16x16x32_bf16 v[172:175], v[112:115], v[84:87], v[172:175]
    ds_read_b64_tr_b16 v[142:143], v3 offset:37696
    v_exp_f32 v166, v166
    v_mfma_f32_16x16x32_bf16 v[168:171], v[116:119], v[88:91], v[168:171]
    ds_read_b64_tr_b16 v[112:113], v3 offset:43072
    v_exp_f32 v167, v167
    v_mfma_f32_16x16x32_bf16 v[172:175], v[116:119], v[92:95], v[172:175]
    ds_read_b64_tr_b16 v[114:115], v3 offset:43840
    v_fma_f32 v160, v160, v17, v17
    v_fma_f32 v161, v161, v17, v17
    v_fma_f32 v162, v162, v17, v17
    v_mfma_f32_16x16x32_bf16 v[176:179], v[120:123], v[40:43], v[176:179]
    ds_read_b64_tr_b16 v[116:117], v3 offset:9280
    v_fma_f32 v163, v163, v17, v17
    v_fma_f32 v164, v164, v18, v18
    v_mfma_f32_16x16x32_bf16 v[180:183], v[120:123], v[44:47], v[180:183]
    ds_read_b64_tr_b16 v[118:119], v3 offset:10048
    v_fma_f32 v165, v165, v18, v18
    v_fma_f32 v166, v166, v18, v18
    v_mfma_f32_16x16x32_bf16 v[176:179], v[124:127], v[48:51], v[176:179]
    ds_read_b64_tr_b16 v[120:121], v3 offset:15424
    v_fma_f32 v167, v167, v18, v18
    v_rcp_f32 v160, v160
    v_mfma_f32_16x16x32_bf16 v[180:183], v[124:127], v[52:55], v[180:183]
    ds_read_b64_tr_b16 v[122:123], v3 offset:16192
    v_rcp_f32 v161, v161
    s_waitcnt lgkmcnt(6)
    v_mfma_f32_16x16x32_bf16 v[176:179], v[128:131], v[56:59], v[176:179]
    ds_read_b64_tr_b16 v[124:125], v3 offset:21568
    ds_read_b128 v[20:23], v15
    v_rcp_f32 v162, v162
    v_rcp_f32 v163, v163
    v_mfma_f32_16x16x32_bf16 v[180:183], v[128:131], v[60:63], v[180:183]
    ds_read_b64_tr_b16 v[126:127], v3 offset:22336
    v_rcp_f32 v164, v164
    v_mfma_f32_16x16x32_bf16 v[176:179], v[132:135], v[64:67], v[176:179]
    ds_read_b64_tr_b16 v[128:129], v3 offset:27712
    v_rcp_f32 v165, v165
    v_mfma_f32_16x16x32_bf16 v[180:183], v[132:135], v[68:71], v[180:183]
    ds_read_b64_tr_b16 v[130:131], v3 offset:28480
    v_rcp_f32 v166, v166
    v_mfma_f32_16x16x32_bf16 v[176:179], v[136:139], v[72:75], v[176:179]
    ds_read_b64_tr_b16 v[132:133], v3 offset:33856
    v_rcp_f32 v167, v167
    v_mfma_f32_16x16x32_bf16 v[180:183], v[136:139], v[76:79], v[180:183]
    ds_read_b64_tr_b16 v[134:135], v3 offset:34624
    v_mul_f32 v160, v160, v168
    v_mul_f32 v161, v161, v169
    v_mul_f32 v162, v162, v170
    v_mfma_f32_16x16x32_bf16 v[176:179], v[140:143], v[80:83], v[176:179]
    ds_read_b64_tr_b16 v[136:137], v3 offset:40000
    v_mul_f32 v163, v163, v171
    v_mul_f32 v164, v164, v172
    v_mfma_f32_16x16x32_bf16 v[180:183], v[140:143], v[84:87], v[180:183]
    ds_read_b64_tr_b16 v[138:139], v3 offset:40768
    v_mul_f32 v165, v165, v173
    v_mul_f32 v166, v166, v174
    s_waitcnt lgkmcnt(6)
    v_mfma_f32_16x16x32_bf16 v[176:179], v[112:115], v[88:91], v[176:179]
    ds_read_b64_tr_b16 v[140:141], v3 offset:46144
    v_mul_f32 v167, v167, v175
    v_cvt_pk_bf16_f32 v168, v160, v161
    v_cvt_pk_bf16_f32 v170, v164, v165
    v_mfma_f32_16x16x32_bf16 v[180:183], v[112:115], v[92:95], v[180:183]
    ds_read_b64_tr_b16 v[142:143], v3 offset:46912
    v_min3_u32 v20, v20, v21, v22
    v_min_u32 v20, v20, v23
    v_cmp_gt_u32 vcc, 16, v20
    v_cvt_pk_bf16_f32 v169, v162, v163
    v_cvt_pk_bf16_f32 v171, v166, v167
    v_mfma_f32_16x16x32_bf16 v[184:187], v[116:119], v[40:43], v[184:187]
    s_cbranch_vccnz L_ld16s
L_ld16r:
    ds_read_b64_tr_b16 v[112:113], v24 offset:57856
    v_permlane32_swap_b32 v168, v170
    s_nop 0
    v_permlane32_swap_b32 v169, v171
    v_mfma_f32_16x16x32_bf16 v[188:191], v[116:119], v[44:47], v[188:191]
    buffer_store_dwordx4 v[168:171], v6, s[40:43], s26 offen offset:1024 sc1
    ds_read_b64_tr_b16 v[114:115], v24 offset:58880
    v_mfma_f32_16x16x32_bf16 v[184:187], v[120:123], v[48:51], v[184:187]
    ds_read_b64_tr_b16 v[116:117], v24 offset:49664
    v_mfma_f32_16x16x32_bf16 v[188:191], v[120:123], v[52:55], v[188:191]
    ds_read_b64_tr_b16 v[118:119], v24 offset:50688
    v_mul_f32 v176, v8, v176
    v_mul_f32 v177, v8, v177
    v_mul_f32 v178, v8, v178
    v_mfma_f32_16x16x32_bf16 v[184:187], v[124:127], v[56:59], v[184:187]
    ds_read_b64_tr_b16 v[120:121], v24 offset:0
    v_mul_f32 v179, v8, v179
    v_mul_f32 v180, v9, v180
    v_mfma_f32_16x16x32_bf16 v[188:191], v[124:127], v[60:63], v[188:191]
    ds_read_b64_tr_b16 v[122:123], v24 offset:1024
    v_mul_f32 v181, v9, v181
    v_mul_f32 v182, v9, v182
    v_mul_f32 v183, v9, v183
    s_waitcnt lgkmcnt(6)
    v_mfma_f32_16x16x32_bf16 v[184:187], v[128:131], v[64:67], v[184:187]
    ds_read_b64_tr_b16 v[124:125], v24 offset:8192
    v_exp_f32 v176, v176
    v_mfma_f32_16x16x32_bf16 v[188:191], v[128:131], v[68:71], v[188:191]
    ds_read_b64_tr_b16 v[126:127], v24 offset:9216
    v_exp_f32 v177, v177
    v_mfma_f32_16x16x32_bf16 v[184:187], v[132:135], v[72:75], v[184:187]
    ds_read_b64_tr_b16 v[128:129], v24 offset:16384
    v_exp_f32 v178, v178
    v_exp_f32 v179, v179
    v_mfma_f32_16x16x32_bf16 v[188:191], v[132:135], v[76:79], v[188:191]
    ds_read_b64_tr_b16 v[130:131], v24 offset:17408
    v_exp_f32 v180, v180
    v_mfma_f32_16x16x32_bf16 v[184:187], v[136:139], v[80:83], v[184:187]
    ds_read_b64_tr_b16 v[132:133], v24 offset:24576
    v_exp_f32 v181, v181
    v_mfma_f32_16x16x32_bf16 v[188:191], v[136:139], v[84:87], v[188:191]
    ds_read_b64_tr_b16 v[134:135], v24 offset:25600
    v_exp_f32 v182, v182
    v_mfma_f32_16x16x32_bf16 v[184:187], v[140:143], v[88:91], v[184:187]
    ds_read_b64_tr_b16 v[136:137], v24 offset:33280
    v_mov_b32 v16, 20
    v_exp_f32 v183, v183
    v_mfma_f32_16x16x32_bf16 v[188:191], v[140:143], v[92:95], v[188:191]
    ds_read_b64_tr_b16 v[138:139], v24 offset:34304
    ds_write_b32 v14, v16
    v_fma_f32 v176, v176, v17, v17
    v_fma_f32 v177, v177, v17, v17
    v_fma_f32 v178, v178, v17, v17
    s_waitcnt lgkmcnt(7)
    v_mfma_f32_16x16x32_bf16 v[192:195], v[112:115], v[40:43], v[192:195]
    ds_read_b64_tr_b16 v[140:141], v24 offset:61952
    v_fma_f32 v179, v179, v17, v17
    v_fma_f32 v180, v180, v18, v18
    v_mfma_f32_16x16x32_bf16 v[196:199], v[112:115], v[44:47], v[196:199]
    ds_read_b64_tr_b16 v[142:143], v24 offset:62976
    v_fma_f32 v181, v181, v18, v18
    v_fma_f32 v182, v182, v18, v18
    v_mfma_f32_16x16x32_bf16 v[192:195], v[116:119], v[48:51], v[192:195]
    ds_read_b64_tr_b16 v[112:113], v24 offset:53760
    v_fma_f32 v183, v183, v18, v18
    v_rcp_f32 v176, v176
    v_mfma_f32_16x16x32_bf16 v[196:199], v[116:119], v[52:55], v[196:199]
    ds_read_b64_tr_b16 v[114:115], v24 offset:54784
    v_rcp_f32 v177, v177
    v_mfma_f32_16x16x32_bf16 v[192:195], v[120:123], v[56:59], v[192:195]
    ds_read_b64_tr_b16 v[116:117], v24 offset:4096
    v_rcp_f32 v178, v178
    v_rcp_f32 v179, v179
    v_mfma_f32_16x16x32_bf16 v[196:199], v[120:123], v[60:63], v[196:199]
    ds_read_b64_tr_b16 v[118:119], v24 offset:5120
    v_rcp_f32 v180, v180
    v_mfma_f32_16x16x32_bf16 v[192:195], v[124:127], v[64:67], v[192:195]
    ds_read_b64_tr_b16 v[120:121], v24 offset:12288
    v_rcp_f32 v181, v181
    v_mfma_f32_16x16x32_bf16 v[196:199], v[124:127], v[68:71], v[196:199]
    ds_read_b64_tr_b16 v[122:123], v24 offset:13312
    v_rcp_f32 v182, v182
    s_waitcnt lgkmcnt(6)
    v_mfma_f32_16x16x32_bf16 v[192:195], v[128:131], v[72:75], v[192:195]
    ds_read_b64_tr_b16 v[124:125], v24 offset:20480
    v_rcp_f32 v183, v183
    v_mfma_f32_16x16x32_bf16 v[196:199], v[128:131], v[76:79], v[196:199]
    ds_read_b64_tr_b16 v[126:127], v24 offset:21504
    v_mul_f32 v176, v176, v184
    v_mul_f32 v177, v177, v185
    v_mul_f32 v178, v178, v186
    v_mfma_f32_16x16x32_bf16 v[192:195], v[132:135], v[80:83], v[192:195]
    ds_read_b64_tr_b16 v[128:129], v24 offset:28672
    v_mul_f32 v179, v179, v187
    v_mul_f32 v180, v180, v188
    v_mfma_f32_16x16x32_bf16 v[196:199], v[132:135], v[84:87], v[196:199]
    ds_read_b64_tr_b16 v[130:131], v24 offset:29696
    v_mul_f32 v181, v181, v189
    v_mul_f32 v182, v182, v190
    v_mfma_f32_16x16x32_bf16 v[192:195], v[136:139], v[88:91], v[192:195]
    ds_read_b64_tr_b16 v[132:133], v24 offset:37376
    v_mul_f32 v183, v183, v191
    v_cvt_pk_bf16_f32 v184, v176, v177
    v_cvt_pk_bf16_f32 v186, v180, v181
    v_mfma_f32_16x16x32_bf16 v[196:199], v[136:139], v[92:95], v[196:199]
    ds_read_b64_tr_b16 v[134:135], v24 offset:38400
    v_cvt_pk_bf16_f32 v185, v178, v179
    v_cvt_pk_bf16_f32 v187, v182, v183
    v_mfma_f32_16x16x32_bf16 v[200:203], v[140:143], v[40:43], v[200:203]
    ds_read_b64_tr_b16 v[136:137], v25 offset:57856
    v_permlane32_swap_b32 v184, v186
    s_nop 0
    v_permlane32_swap_b32 v185, v187
    v_mfma_f32_16x16x32_bf16 v[204:207], v[140:143], v[44:47], v[204:207]
    buffer_store_dwordx4 v[184:187], v6, s[40:43], s26 offen offset:2048 sc1
    ds_read_b64_tr_b16 v[138:139], v25 offset:58880
    s_waitcnt lgkmcnt(6)
    v_mfma_f32_16x16x32_bf16 v[200:203], v[112:115], v[48:51], v[200:203]
    ds_read_b64_tr_b16 v[140:141], v25 offset:49664
    v_mfma_f32_16x16x32_bf16 v[204:207], v[112:115], v[52:55], v[204:207]
    ds_read_b64_tr_b16 v[142:143], v25 offset:50688
    v_mul_f32 v192, v8, v192
    v_mul_f32 v193, v8, v193
    v_mul_f32 v194, v8, v194
    v_mfma_f32_16x16x32_bf16 v[200:203], v[116:119], v[56:59], v[200:203]
    ds_read_b64_tr_b16 v[112:113], v25 offset:0
    v_mul_f32 v195, v8, v195
    v_mul_f32 v196, v9, v196
    v_mfma_f32_16x16x32_bf16 v[204:207], v[116:119], v[60:63], v[204:207]
    v_add_u32 v11, 1, v11
    s_waitcnt vmcnt(1)
    buffer_store_dword v11, v10, s[40:43], s24 offen
    ds_read_b64_tr_b16 v[114:115], v25 offset:1024
    v_mul_f32 v197, v9, v197
    v_mul_f32 v198, v9, v198
    v_mul_f32 v199, v9, v199
    v_mfma_f32_16x16x32_bf16 v[200:203], v[120:123], v[64:67], v[200:203]
    ds_read_b64_tr_b16 v[116:117], v25 offset:8192
    v_exp_f32 v192, v192
    v_mfma_f32_16x16x32_bf16 v[204:207], v[120:123], v[68:71], v[204:207]
    ds_read_b64_tr_b16 v[118:119], v25 offset:9216
    v_exp_f32 v193, v193
    v_mfma_f32_16x16x32_bf16 v[200:203], v[124:127], v[72:75], v[200:203]
    ds_read_b64_tr_b16 v[120:121], v25 offset:16384
    v_exp_f32 v194, v194
    v_exp_f32 v195, v195
    v_mfma_f32_16x16x32_bf16 v[204:207], v[124:127], v[76:79], v[204:207]
    ds_read_b64_tr_b16 v[122:123], v25 offset:17408
    v_exp_f32 v196, v196
    s_waitcnt lgkmcnt(6)
    v_mfma_f32_16x16x32_bf16 v[200:203], v[128:131], v[80:83], v[200:203]
    ds_read_b64_tr_b16 v[124:125], v25 offset:24576
    v_exp_f32 v197, v197
    v_mfma_f32_16x16x32_bf16 v[204:207], v[128:131], v[84:87], v[204:207]
    ds_read_b64_tr_b16 v[126:127], v25 offset:25600
    v_exp_f32 v198, v198
    v_mfma_f32_16x16x32_bf16 v[200:203], v[132:135], v[88:91], v[200:203]
    ds_read_b64_tr_b16 v[128:129], v25 offset:33280
    v_exp_f32 v199, v199
    v_mfma_f32_16x16x32_bf16 v[204:207], v[132:135], v[92:95], v[204:207]
    ds_read_b64_tr_b16 v[130:131], v25 offset:34304
    v_fma_f32 v192, v192, v17, v17
    v_fma_f32 v193, v193, v17, v17
    v_fma_f32 v194, v194, v17, v17
    v_mfma_f32_16x16x32_bf16 v[208:211], v[136:139], v[40:43], v[208:211]
    ds_read_b64_tr_b16 v[132:133], v25 offset:61952
    v_fma_f32 v195, v195, v17, v17
    v_fma_f32 v196, v196, v18, v18
    v_mfma_f32_16x16x32_bf16 v[212:215], v[136:139], v[44:47], v[212:215]
    ds_read_b64_tr_b16 v[134:135], v25 offset:62976
    v_fma_f32 v197, v197, v18, v18
    v_fma_f32 v198, v198, v18, v18
    v_mfma_f32_16x16x32_bf16 v[208:211], v[140:143], v[48:51], v[208:211]
    ds_read_b64_tr_b16 v[136:137], v25 offset:53760
    v_fma_f32 v199, v199, v18, v18
    v_rcp_f32 v192, v192
    v_mfma_f32_16x16x32_bf16 v[212:215], v[140:143], v[52:55], v[212:215]
    ds_read_b64_tr_b16 v[138:139], v25 offset:54784
    v_rcp_f32 v193, v193
    s_waitcnt lgkmcnt(6)
    v_mfma_f32_16x16x32_bf16 v[208:211], v[112:115], v[56:59], v[208:211]
    ds_read_b64_tr_b16 v[140:141], v25 offset:4096
    v_rcp_f32 v194, v194
    v_rcp_f32 v195, v195
    v_mfma_f32_16x16x32_bf16 v[212:215], v[112:115], v[60:63], v[212:215]
    ds_read_b64_tr_b16 v[142:143], v25 offset:5120
    v_rcp_f32 v196, v196
    v_mfma_f32_16x16x32_bf16 v[208:211], v[116:119], v[64:67], v[208:211]
    ds_read_b64_tr_b16 v[112:113], v25 offset:12288
    v_rcp_f32 v197, v197
    v_mfma_f32_16x16x32_bf16 v[212:215], v[116:119], v[68:71], v[212:215]
    ds_read_b64_tr_b16 v[114:115], v25 offset:13312
    v_rcp_f32 v198, v198
    v_mfma_f32_16x16x32_bf16 v[208:211], v[120:123], v[72:75], v[208:211]
    ds_read_b64_tr_b16 v[116:117], v25 offset:20480
    v_rcp_f32 v199, v199
    v_mfma_f32_16x16x32_bf16 v[212:215], v[120:123], v[76:79], v[212:215]
    ds_read_b64_tr_b16 v[118:119], v25 offset:21504
    v_mul_f32 v192, v192, v200
    v_mul_f32 v193, v193, v201
    v_mul_f32 v194, v194, v202
    v_mfma_f32_16x16x32_bf16 v[208:211], v[124:127], v[80:83], v[208:211]
    ds_read_b64_tr_b16 v[120:121], v25 offset:28672
    v_mul_f32 v195, v195, v203
    v_mul_f32 v196, v196, v204
    v_mfma_f32_16x16x32_bf16 v[212:215], v[124:127], v[84:87], v[212:215]
    ds_read_b64_tr_b16 v[122:123], v25 offset:29696
    v_mul_f32 v197, v197, v205
    v_mul_f32 v198, v198, v206
    s_waitcnt lgkmcnt(6)
    v_mfma_f32_16x16x32_bf16 v[208:211], v[128:131], v[88:91], v[208:211]
    ds_read_b64_tr_b16 v[124:125], v25 offset:37376
    v_mul_f32 v199, v199, v207
    v_cvt_pk_bf16_f32 v200, v192, v193
    v_cvt_pk_bf16_f32 v202, v196, v197
    v_mfma_f32_16x16x32_bf16 v[212:215], v[128:131], v[92:95], v[212:215]
    ds_read_b64_tr_b16 v[126:127], v25 offset:38400
    v_cvt_pk_bf16_f32 v201, v194, v195
    v_cvt_pk_bf16_f32 v203, v198, v199
    v_mfma_f32_16x16x32_bf16 v[216:219], v[132:135], v[40:43], v[216:219]
    ds_read_b64_tr_b16 v[128:129], v26 offset:57856
    v_permlane32_swap_b32 v200, v202
    s_nop 0
    v_permlane32_swap_b32 v201, v203
    v_mfma_f32_16x16x32_bf16 v[220:223], v[132:135], v[44:47], v[220:223]
    buffer_store_dwordx4 v[200:203], v6, s[40:43], s26 offen offset:3072 sc1
    ds_read_b64_tr_b16 v[130:131], v26 offset:58880
    v_mfma_f32_16x16x32_bf16 v[216:219], v[136:139], v[48:51], v[216:219]
    ds_read_b64_tr_b16 v[132:133], v26 offset:49664
    v_mfma_f32_16x16x32_bf16 v[220:223], v[136:139], v[52:55], v[220:223]
    ds_read_b64_tr_b16 v[134:135], v26 offset:50688
    v_mul_f32 v208, v8, v208
    v_mul_f32 v209, v8, v209
    v_mul_f32 v210, v8, v210
    v_mfma_f32_16x16x32_bf16 v[216:219], v[140:143], v[56:59], v[216:219]
    ds_read_b64_tr_b16 v[136:137], v26 offset:0
    v_mul_f32 v211, v8, v211
    v_mul_f32 v212, v9, v212
    v_mfma_f32_16x16x32_bf16 v[220:223], v[140:143], v[60:63], v[220:223]
    ds_read_b64_tr_b16 v[138:139], v26 offset:1024
    v_mul_f32 v213, v9, v213
    v_mul_f32 v214, v9, v214
    v_mul_f32 v215, v9, v215
    s_waitcnt lgkmcnt(6)
    v_mfma_f32_16x16x32_bf16 v[216:219], v[112:115], v[64:67], v[216:219]
    ds_read_b64_tr_b16 v[140:141], v26 offset:8192
    v_exp_f32 v208, v208
    v_mfma_f32_16x16x32_bf16 v[220:223], v[112:115], v[68:71], v[220:223]
    ds_read_b64_tr_b16 v[142:143], v26 offset:9216
    v_exp_f32 v209, v209
    v_mfma_f32_16x16x32_bf16 v[216:219], v[116:119], v[72:75], v[216:219]
    ds_read_b64_tr_b16 v[112:113], v26 offset:16384
    v_exp_f32 v210, v210
    v_exp_f32 v211, v211
    v_mfma_f32_16x16x32_bf16 v[220:223], v[116:119], v[76:79], v[220:223]
    ds_read_b64_tr_b16 v[114:115], v26 offset:17408
    v_exp_f32 v212, v212
    v_mfma_f32_16x16x32_bf16 v[216:219], v[120:123], v[80:83], v[216:219]
    ds_read_b64_tr_b16 v[116:117], v26 offset:24576
    v_exp_f32 v213, v213
    v_mfma_f32_16x16x32_bf16 v[220:223], v[120:123], v[84:87], v[220:223]
    ds_read_b64_tr_b16 v[118:119], v26 offset:25600
    v_exp_f32 v214, v214
    v_mfma_f32_16x16x32_bf16 v[216:219], v[124:127], v[88:91], v[216:219]
    ds_read_b64_tr_b16 v[120:121], v26 offset:33280
    v_exp_f32 v215, v215
    v_mfma_f32_16x16x32_bf16 v[220:223], v[124:127], v[92:95], v[220:223]
    ds_read_b64_tr_b16 v[122:123], v26 offset:34304
    v_fma_f32 v208, v208, v17, v17
    v_fma_f32 v209, v209, v17, v17
    v_fma_f32 v210, v210, v17, v17
    s_waitcnt lgkmcnt(6)
    v_mfma_f32_16x16x32_bf16 v[224:227], v[128:131], v[40:43], v[224:227]
    ds_read_b64_tr_b16 v[124:125], v26 offset:61952
    v_fma_f32 v211, v211, v17, v17
    v_fma_f32 v212, v212, v18, v18
    v_mfma_f32_16x16x32_bf16 v[228:231], v[128:131], v[44:47], v[228:231]
    ds_read_b64_tr_b16 v[126:127], v26 offset:62976
    v_fma_f32 v213, v213, v18, v18
    v_fma_f32 v214, v214, v18, v18
    v_mfma_f32_16x16x32_bf16 v[224:227], v[132:135], v[48:51], v[224:227]
    ds_read_b64_tr_b16 v[128:129], v26 offset:53760
    v_fma_f32 v215, v215, v18, v18
    v_rcp_f32 v208, v208
    v_mfma_f32_16x16x32_bf16 v[228:231], v[132:135], v[52:55], v[228:231]
    ds_read_b64_tr_b16 v[130:131], v26 offset:54784
    v_rcp_f32 v209, v209
    v_mfma_f32_16x16x32_bf16 v[224:227], v[136:139], v[56:59], v[224:227]
    ds_read_b64_tr_b16 v[132:133], v26 offset:4096
    v_rcp_f32 v210, v210
    v_rcp_f32 v211, v211
    v_mfma_f32_16x16x32_bf16 v[228:231], v[136:139], v[60:63], v[228:231]
    ds_read_b64_tr_b16 v[134:135], v26 offset:5120
    v_rcp_f32 v212, v212
    v_mfma_f32_16x16x32_bf16 v[224:227], v[140:143], v[64:67], v[224:227]
    ds_read_b64_tr_b16 v[136:137], v26 offset:12288
    v_rcp_f32 v213, v213
    v_mfma_f32_16x16x32_bf16 v[228:231], v[140:143], v[68:71], v[228:231]
    ds_read_b64_tr_b16 v[138:139], v26 offset:13312
    v_rcp_f32 v214, v214
    s_waitcnt lgkmcnt(6)
    v_mfma_f32_16x16x32_bf16 v[224:227], v[112:115], v[72:75], v[224:227]
    ds_read_b64_tr_b16 v[140:141], v26 offset:20480
    v_rcp_f32 v215, v215
    v_mfma_f32_16x16x32_bf16 v[228:231], v[112:115], v[76:79], v[228:231]
    ds_read_b64_tr_b16 v[142:143], v26 offset:21504
    v_mul_f32 v208, v208, v216
    v_mul_f32 v209, v209, v217
    v_mul_f32 v210, v210, v218
    v_mfma_f32_16x16x32_bf16 v[224:227], v[116:119], v[80:83], v[224:227]
    ds_read_b64_tr_b16 v[112:113], v26 offset:28672
    v_mul_f32 v211, v211, v219
    v_mul_f32 v212, v212, v220
    v_mfma_f32_16x16x32_bf16 v[228:231], v[116:119], v[84:87], v[228:231]
    ds_read_b64_tr_b16 v[114:115], v26 offset:29696
    v_mul_f32 v213, v213, v221
    v_mul_f32 v214, v214, v222
    v_mfma_f32_16x16x32_bf16 v[224:227], v[120:123], v[88:91], v[224:227]
    ds_read_b64_tr_b16 v[116:117], v26 offset:37376
    v_mul_f32 v215, v215, v223
    v_cvt_pk_bf16_f32 v216, v208, v209
    v_cvt_pk_bf16_f32 v218, v212, v213
    v_mfma_f32_16x16x32_bf16 v[228:231], v[120:123], v[92:95], v[228:231]
    ds_read_b64_tr_b16 v[118:119], v26 offset:38400
    v_cvt_pk_bf16_f32 v217, v210, v211
    v_cvt_pk_bf16_f32 v219, v214, v215
    v_mfma_f32_16x16x32_bf16 v[232:235], v[124:127], v[40:43], v[232:235]
    ds_read_b64_tr_b16 v[120:121], v27 offset:57856
    v_permlane32_swap_b32 v216, v218
    s_nop 0
    v_permlane32_swap_b32 v217, v219
    v_mfma_f32_16x16x32_bf16 v[236:239], v[124:127], v[44:47], v[236:239]
    buffer_store_dwordx4 v[216:219], v6, s[40:43], s27 offen offset:0 sc1
    ds_read_b64_tr_b16 v[122:123], v27 offset:58880
    s_waitcnt lgkmcnt(6)
    v_mfma_f32_16x16x32_bf16 v[232:235], v[128:131], v[48:51], v[232:235]
    ds_read_b64_tr_b16 v[124:125], v27 offset:49664
    v_mfma_f32_16x16x32_bf16 v[236:239], v[128:131], v[52:55], v[236:239]
    ds_read_b64_tr_b16 v[126:127], v27 offset:50688
    v_mul_f32 v224, v8, v224
    v_mul_f32 v225, v8, v225
    v_mul_f32 v226, v8, v226
    v_mfma_f32_16x16x32_bf16 v[232:235], v[132:135], v[56:59], v[232:235]
    ds_read_b64_tr_b16 v[128:129], v27 offset:0
    v_mul_f32 v227, v8, v227
    v_mul_f32 v228, v9, v228
    v_mfma_f32_16x16x32_bf16 v[236:239], v[132:135], v[60:63], v[236:239]
    v_add_u32 v11, 2, v11
    s_waitcnt vmcnt(1)
    buffer_store_dword v11, v10, s[40:43], s24 offen
    ds_read_b64_tr_b16 v[130:131], v27 offset:1024
    v_mul_f32 v229, v9, v229
    v_mul_f32 v230, v9, v230
    v_mul_f32 v231, v9, v231
    v_mfma_f32_16x16x32_bf16 v[232:235], v[136:139], v[64:67], v[232:235]
    ds_read_b64_tr_b16 v[132:133], v27 offset:8192
    v_exp_f32 v224, v224
    v_mfma_f32_16x16x32_bf16 v[236:239], v[136:139], v[68:71], v[236:239]
    ds_read_b64_tr_b16 v[134:135], v27 offset:9216
    v_exp_f32 v225, v225
    v_mfma_f32_16x16x32_bf16 v[232:235], v[140:143], v[72:75], v[232:235]
    ds_read_b64_tr_b16 v[136:137], v27 offset:16384
    v_exp_f32 v226, v226
    v_exp_f32 v227, v227
    v_mfma_f32_16x16x32_bf16 v[236:239], v[140:143], v[76:79], v[236:239]
    ds_read_b64_tr_b16 v[138:139], v27 offset:17408
    v_exp_f32 v228, v228
    s_waitcnt lgkmcnt(6)
    v_mfma_f32_16x16x32_bf16 v[232:235], v[112:115], v[80:83], v[232:235]
    ds_read_b64_tr_b16 v[140:141], v27 offset:24576
    v_exp_f32 v229, v229
    v_mfma_f32_16x16x32_bf16 v[236:239], v[112:115], v[84:87], v[236:239]
    ds_read_b64_tr_b16 v[142:143], v27 offset:25600
    v_exp_f32 v230, v230
    v_mfma_f32_16x16x32_bf16 v[232:235], v[116:119], v[88:91], v[232:235]
    ds_read_b64_tr_b16 v[112:113], v27 offset:33280
    v_exp_f32 v231, v231
    v_mfma_f32_16x16x32_bf16 v[236:239], v[116:119], v[92:95], v[236:239]
    ds_read_b64_tr_b16 v[114:115], v27 offset:34304
    v_fma_f32 v224, v224, v17, v17
    v_fma_f32 v225, v225, v17, v17
    v_fma_f32 v226, v226, v17, v17
    v_mfma_f32_16x16x32_bf16 v[240:243], v[120:123], v[40:43], v[240:243]
    ds_read_b64_tr_b16 v[116:117], v27 offset:61952
    v_fma_f32 v227, v227, v17, v17
    v_fma_f32 v228, v228, v18, v18
    v_mfma_f32_16x16x32_bf16 v[244:247], v[120:123], v[44:47], v[244:247]
    ds_read_b64_tr_b16 v[118:119], v27 offset:62976
    v_fma_f32 v229, v229, v18, v18
    v_fma_f32 v230, v230, v18, v18
    v_mfma_f32_16x16x32_bf16 v[240:243], v[124:127], v[48:51], v[240:243]
    ds_read_b64_tr_b16 v[120:121], v27 offset:53760
    v_fma_f32 v231, v231, v18, v18
    v_rcp_f32 v224, v224
    v_mfma_f32_16x16x32_bf16 v[244:247], v[124:127], v[52:55], v[244:247]
    ds_read_b64_tr_b16 v[122:123], v27 offset:54784
    v_rcp_f32 v225, v225
    s_waitcnt lgkmcnt(6)
    v_mfma_f32_16x16x32_bf16 v[240:243], v[128:131], v[56:59], v[240:243]
    ds_read_b64_tr_b16 v[124:125], v27 offset:4096
    v_rcp_f32 v226, v226
    v_rcp_f32 v227, v227
    v_mfma_f32_16x16x32_bf16 v[244:247], v[128:131], v[60:63], v[244:247]
    ds_read_b64_tr_b16 v[126:127], v27 offset:5120
    v_rcp_f32 v228, v228
    v_mfma_f32_16x16x32_bf16 v[240:243], v[132:135], v[64:67], v[240:243]
    ds_read_b64_tr_b16 v[128:129], v27 offset:12288
    v_rcp_f32 v229, v229
    v_mfma_f32_16x16x32_bf16 v[244:247], v[132:135], v[68:71], v[244:247]
    ds_read_b64_tr_b16 v[130:131], v27 offset:13312
    v_rcp_f32 v230, v230
    v_mfma_f32_16x16x32_bf16 v[240:243], v[136:139], v[72:75], v[240:243]
    ds_read_b64_tr_b16 v[132:133], v27 offset:20480
    v_rcp_f32 v231, v231
    v_mfma_f32_16x16x32_bf16 v[244:247], v[136:139], v[76:79], v[244:247]
    ds_read_b64_tr_b16 v[134:135], v27 offset:21504
    v_mul_f32 v224, v224, v232
    v_mul_f32 v225, v225, v233
    v_mul_f32 v226, v226, v234
    v_mfma_f32_16x16x32_bf16 v[240:243], v[140:143], v[80:83], v[240:243]
    ds_read_b64_tr_b16 v[136:137], v27 offset:28672
    v_mul_f32 v227, v227, v235
    v_mul_f32 v228, v228, v236
    v_mfma_f32_16x16x32_bf16 v[244:247], v[140:143], v[84:87], v[244:247]
    ds_read_b64_tr_b16 v[138:139], v27 offset:29696
    v_mul_f32 v229, v229, v237
    v_mul_f32 v230, v230, v238
    s_waitcnt lgkmcnt(6)
    v_mfma_f32_16x16x32_bf16 v[240:243], v[112:115], v[88:91], v[240:243]
    ds_read_b64_tr_b16 v[140:141], v27 offset:37376
    v_mul_f32 v231, v231, v239
    v_cvt_pk_bf16_f32 v232, v224, v225
    v_cvt_pk_bf16_f32 v234, v228, v229
    v_mfma_f32_16x16x32_bf16 v[244:247], v[112:115], v[92:95], v[244:247]
    ds_read_b64_tr_b16 v[142:143], v27 offset:38400
    v_cvt_pk_bf16_f32 v233, v226, v227
    v_cvt_pk_bf16_f32 v235, v230, v231
    v_mfma_f32_16x16x32_bf16 v[248:251], v[116:119], v[40:43], v[248:251]
    v_permlane32_swap_b32 v232, v234
    s_nop 0
    v_permlane32_swap_b32 v233, v235
    v_mfma_f32_16x16x32_bf16 v[252:255], v[116:119], v[44:47], v[252:255]
    buffer_store_dwordx4 v[232:235], v6, s[40:43], s27 offen offset:1024 sc1
    v_mfma_f32_16x16x32_bf16 v[248:251], v[120:123], v[48:51], v[248:251]
    v_mfma_f32_16x16x32_bf16 v[252:255], v[120:123], v[52:55], v[252:255]
    v_mul_f32 v240, v8, v240
    v_mul_f32 v241, v8, v241
    v_mul_f32 v242, v8, v242
    v_mfma_f32_16x16x32_bf16 v[248:251], v[124:127], v[56:59], v[248:251]
    v_mul_f32 v243, v8, v243
    v_mul_f32 v244, v9, v244
    v_mfma_f32_16x16x32_bf16 v[252:255], v[124:127], v[60:63], v[252:255]
    v_mul_f32 v245, v9, v245
    v_mul_f32 v246, v9, v246
    v_mul_f32 v247, v9, v247
    s_waitcnt lgkmcnt(0)
    v_mfma_f32_16x16x32_bf16 v[248:251], v[128:131], v[64:67], v[248:251]
    v_exp_f32 v240, v240
    v_mfma_f32_16x16x32_bf16 v[252:255], v[128:131], v[68:71], v[252:255]
    v_exp_f32 v241, v241
    v_mfma_f32_16x16x32_bf16 v[248:251], v[132:135], v[72:75], v[248:251]
    v_exp_f32 v242, v242
    v_exp_f32 v243, v243
    v_mfma_f32_16x16x32_bf16 v[252:255], v[132:135], v[76:79], v[252:255]
    v_exp_f32 v244, v244
    v_mfma_f32_16x16x32_bf16 v[248:251], v[136:139], v[80:83], v[248:251]
    v_exp_f32 v245, v245
    v_mfma_f32_16x16x32_bf16 v[252:255], v[136:139], v[84:87], v[252:255]
    v_exp_f32 v246, v246
    v_mfma_f32_16x16x32_bf16 v[248:251], v[140:143], v[88:91], v[248:251]
    v_mov_b32 v16, 30
    v_exp_f32 v247, v247
    v_mfma_f32_16x16x32_bf16 v[252:255], v[140:143], v[92:95], v[252:255]
    ds_write_b32 v14, v16
    v_fma_f32 v240, v240, v17, v17
    v_fma_f32 v241, v241, v17, v17
    v_fma_f32 v242, v242, v17, v17
    v_fma_f32 v243, v243, v17, v17
    v_fma_f32 v244, v244, v18, v18
    v_fma_f32 v245, v245, v18, v18
    v_fma_f32 v246, v246, v18, v18
    v_fma_f32 v247, v247, v18, v18
    v_rcp_f32 v240, v240
    v_rcp_f32 v241, v241
    v_rcp_f32 v242, v242
    v_rcp_f32 v243, v243
    v_rcp_f32 v244, v244
    v_rcp_f32 v245, v245
    v_rcp_f32 v246, v246
    v_rcp_f32 v247, v247
    v_mul_f32 v240, v240, v248
    v_mul_f32 v241, v241, v249
    v_mul_f32 v242, v242, v250
    v_mul_f32 v243, v243, v251
    v_mul_f32 v244, v244, v252
    v_mul_f32 v245, v245, v253
    v_mul_f32 v246, v246, v254
    v_mul_f32 v247, v247, v255
    v_cvt_pk_bf16_f32 v248, v240, v241
    v_cvt_pk_bf16_f32 v250, v244, v245
    v_cvt_pk_bf16_f32 v249, v242, v243
    v_cvt_pk_bf16_f32 v251, v246, v247
    v_permlane32_swap_b32 v248, v250
    s_nop 0
    v_permlane32_swap_b32 v249, v251
    buffer_store_dwordx4 v[248:251], v6, s[40:43], s27 offen offset:2048 sc1
    v_add_u32 v11, 3, v11
    s_waitcnt vmcnt(0)
    buffer_store_dword v11, v10, s[40:43], s24 offen
    s_endpgm
L_codeend:
L_fallback:
    s_mov_b32 s29, 1
    v_subrev_u32 v8, s30, v8
    v_subrev_u32 v9, s30, v9
    v_mov_b32 v10, 0xff800000
    v_mov_b32 v11, 0xff800000
    s_mov_b32 s50, 0
L_fb1:
    buffer_load_dwordx4 v[24:27], v7, s[40:43], s50 offen sc1
    s_waitcnt vmcnt(0)
    v_mfma_f32_32x32x16_bf16 v[112:127], v[24:27], v[104:107], 0
    v_mfma_f32_32x32x16_bf16 v[128:143], v[24:27], v[108:111], 0
    s_nop 11
    v_max3_f32 v10, v112, v113, v10
    v_max3_f32 v10, v114, v115, v10
    v_max3_f32 v10, v116, v117, v10
    v_max3_f32 v10, v118, v119, v10
    v_max3_f32 v10, v120, v121, v10
    v_max3_f32 v10, v122, v123, v10
    v_max3_f32 v10, v124, v125, v10
    v_max3_f32 v10, v126, v127, v10
    v_max3_f32 v11, v128, v129, v11
    v_max3_f32 v11, v130, v131, v11
    v_max3_f32 v11, v132, v133, v11
    v_max3_f32 v11, v134, v135, v11
    v_max3_f32 v11, v136, v137, v11
    v_max3_f32 v11, v138, v139, v11
    v_max3_f32 v11, v140, v141, v11
    v_max3_f32 v11, v142, v143, v11
    s_add_u32 s50, s50, 2048
    s_cmp_lt_u32 s50, 131072
    s_cbranch_scc1 L_fb1
    v_mov_b32 v12, v10
    v_mov_b32 v13, v11
    s_nop 1
    v_permlane32_swap_b32 v10, v12
    v_permlane32_swap_b32 v11, v13
    v_max_f32 v10, v10, v12
    v_max_f32 v11, v11, v13
    v_sub_f32 v40, 0, v10
    v_mov_b32 v72, 0
    v_sub_f32 v41, 0, v10
    v_mov_b32 v73, 0
    v_sub_f32 v42, 0, v10
    v_mov_b32 v74, 0
    v_sub_f32 v43, 0, v10
    v_mov_b32 v75, 0
    v_sub_f32 v44, 0, v10
    v_mov_b32 v76, 0
    v_sub_f32 v45, 0, v10
    v_mov_b32 v77, 0
    v_sub_f32 v46, 0, v10
    v_mov_b32 v78, 0
    v_sub_f32 v47, 0, v10
    v_mov_b32 v79, 0
    v_sub_f32 v48, 0, v10
    v_mov_b32 v80, 0
    v_sub_f32 v49, 0, v10
    v_mov_b32 v81, 0
    v_sub_f32 v50, 0, v10
    v_mov_b32 v82, 0
    v_sub_f32 v51, 0, v10
    v_mov_b32 v83, 0
    v_sub_f32 v52, 0, v10
    v_mov_b32 v84, 0
    v_sub_f32 v53, 0, v10
    v_mov_b32 v85, 0
    v_sub_f32 v54, 0, v10
    v_mov_b32 v86, 0
    v_sub_f32 v55, 0, v10
    v_mov_b32 v87, 0
    v_sub_f32 v56, 0, v11
    v_mov_b32 v88, 0
    v_sub_f32 v57, 0, v11
    v_mov_b32 v89, 0
    v_sub_f32 v58, 0, v11
    v_mov_b32 v90, 0
    v_sub_f32 v59, 0, v11
    v_mov_b32 v91, 0
    v_sub_f32 v60, 0, v11
    v_mov_b32 v92, 0
    v_sub_f32 v61, 0, v11
    v_mov_b32 v93, 0
    v_sub_f32 v62, 0, v11
    v_mov_b32 v94, 0
    v_sub_f32 v63, 0, v11
    v_mov_b32 v95, 0
    v_sub_f32 v64, 0, v11
    v_mov_b32 v96, 0
    v_sub_f32 v65, 0, v11
    v_mov_b32 v97, 0
    v_sub_f32 v66, 0, v11
    v_mov_b32 v98, 0
    v_sub_f32 v67, 0, v11
    v_mov_b32 v99, 0
    v_sub_f32 v68, 0, v11
    v_mov_b32 v100, 0
    v_sub_f32 v69, 0, v11
    v_mov_b32 v101, 0
    v_sub_f32 v70, 0, v11
    v_mov_b32 v102, 0
    v_sub_f32 v71, 0, v11
    v_mov_b32 v103, 0
    v_and_b32 v12, 27, v0
    v_cmp_eq_u32 vcc, 16, v12
    v_mov_b32 v13, s60
    s_nop 0
    v_cndmask_b32 v13, 0, v13, vcc
    v_mov_b32 v28, v13
    v_mov_b32 v29, v13
    v_mov_b32 v30, v13
    v_mov_b32 v31, v13
    v_mov_b32 v32, v13
    v_mov_b32 v33, v13
    v_mov_b32 v34, v13
    v_mov_b32 v35, v13
    s_mov_b32 s50, 0
    s_mov_b32 s52, 0xffff
    s_mov_b32 s53, 0xffff
L_fb2:
    buffer_load_dwordx4 v[24:27], v7, s[40:43], s50 offen sc1
    s_mov_b64 exec, s[52:53]
    buffer_load_dwordx4 v[28:31], v8, s[40:43], s50 offen sc1
    buffer_load_dwordx4 v[32:35], v9, s[40:43], s50 offen sc1
    s_mov_b64 exec, -1
    s_waitcnt vmcnt(0)
    v_mfma_f32_32x32x16_bf16 v[112:127], v[24:27], v[104:107], v[40:55]
    v_mfma_f32_32x32x16_bf16 v[128:143], v[24:27], v[108:111], v[56:71]
    s_nop 11
    v_exp_f32 v112, v112
    v_exp_f32 v113, v113
    v_exp_f32 v114, v114
    v_exp_f32 v115, v115
    v_exp_f32 v116, v116
    v_exp_f32 v117, v117
    v_exp_f32 v118, v118
    v_exp_f32 v119, v119
    v_exp_f32 v120, v120
    v_exp_f32 v121, v121
    v_exp_f32 v122, v122
    v_exp_f32 v123, v123
    v_exp_f32 v124, v124
    v_exp_f32 v125, v125
    v_exp_f32 v126, v126
    v_exp_f32 v127, v127
    v_exp_f32 v128, v128
    v_exp_f32 v129, v129
    v_exp_f32 v130, v130
    v_exp_f32 v131, v131
    v_exp_f32 v132, v132
    v_exp_f32 v133, v133
    v_exp_f32 v134, v134
    v_exp_f32 v135, v135
    v_exp_f32 v136, v136
    v_exp_f32 v137, v137
    v_exp_f32 v138, v138
    v_exp_f32 v139, v139
    v_exp_f32 v140, v140
    v_exp_f32 v141, v141
    v_exp_f32 v142, v142
    v_exp_f32 v143, v143
    s_nop 1
    v_smfmac_f32_32x32x32_bf16 v[72:87], v[28:31], v[112:119], v6
    v_smfmac_f32_32x32x32_bf16 v[72:87], v[32:35], v[120:127], v6
    v_smfmac_f32_32x32x32_bf16 v[88:103], v[28:31], v[128:135], v6
    v_smfmac_f32_32x32x32_bf16 v[88:103], v[32:35], v[136:143], v6
    s_add_u32 s50, s50, 2048
    s_cmp_lt_u32 s50, 131072
    s_cbranch_scc1 L_fb2
    s_nop 11
    s_branch L_norm
L_unsafe:
    s_waitcnt lgkmcnt(0)
    s_cmp_eq_u32 s29, 0
    s_cbranch_scc1 L_fallback
    v_min_u32 v192, -2, v192
    v_cmp_o_f32 vcc, v88, v88
    v_mov_b32 v201, 0x7fc00000
    s_nop 0
    v_cndmask_b32 v88, v201, v88, vcc
    s_branch L_safe
L_unsafe_s:
    s_waitcnt lgkmcnt(0)
    s_cmp_eq_u32 s29, 0
    s_cbranch_scc1 L_fallback
    v_min_u32 v192, -2, v192
    v_cmp_o_f32 vcc, v88, v88
    v_mov_b32 v201, 0x7fc00000
    s_nop 0
    v_cndmask_b32 v88, v201, v88, vcc
    s_branch L_safe_s
L_a2_ss:
    s_mov_b32 s54, 131072
L_a2_sl:
    buffer_load_dwordx4 v[48:51], v4, s[16:19], s70 offen offset:0 sc1
    buffer_load_dwordx4 v[52:55], v4, s[16:19], s70 offen offset:2048 sc1
    buffer_load_dwordx4 v[56:59], v4, s[16:19], s68 offen offset:128 sc1
    buffer_load_dwordx4 v[60:63], v4, s[16:19], s68 offen offset:2176 sc1
    buffer_load_dwordx4 v[64:67], v4, s[16:19], s70 offen offset:128 sc1
    buffer_load_dwordx4 v[68:71], v4, s[16:19], s70 offen offset:2176 sc1
    s_waitcnt vmcnt(0)
    v_max_u32 v13, v48, v52
    v_cmp_eq_u32 vcc, -1, v13
    s_cbranch_vccz L_a2_sr
    s_sub_u32 s54, s54, 1
    s_cbranch_scc0 L_a2_sl
    s_branch L_a2_sr
L_a4_ss:
    s_mov_b32 s54, 131072
L_a4_sl:
    buffer_load_dwordx4 v[56:59], v4, s[16:19], s68 offen offset:128 sc1
    buffer_load_dwordx4 v[60:63], v4, s[16:19], s68 offen offset:2176 sc1
    buffer_load_dwordx4 v[64:67], v4, s[16:19], s70 offen offset:128 sc1
    buffer_load_dwordx4 v[68:71], v4, s[16:19], s70 offen offset:2176 sc1
    s_waitcnt vmcnt(0)
    v_max3_u32 v13, v56, v60, v64
    v_max_u32 v13, v13, v68
    v_cmp_eq_u32 vcc, -1, v13
    s_cbranch_vccz L_a4_sr
    s_sub_u32 s54, s54, 1
    s_cbranch_scc0 L_a4_sl
    s_branch L_a4_sr
L_ld5_ss:
    s_mov_b32 s54, 2097152
L_ld5_s:
    ds_read_b128 v[20:23], v15
    s_waitcnt lgkmcnt(0)
    v_min3_u32 v20, v20, v21, v22
    v_min_u32 v20, v20, v23
    v_cmp_gt_u32 vcc, 5, v20
    s_cbranch_vccz L_ld5_s_ok
    s_sub_u32 s54, s54, 1
    s_cbranch_scc0 L_ld5_s
L_ld5_s_ok:
    s_branch L_ld5_sr
L_a8_ss:
    s_mov_b32 s54, 131072
L_a8_sl:
    buffer_load_dwordx4 v[72:75], v4, s[16:19], s68 offen offset:256 sc1
    buffer_load_dwordx4 v[76:79], v4, s[16:19], s68 offen offset:2304 sc1
    buffer_load_dwordx4 v[80:83], v4, s[16:19], s70 offen offset:256 sc1
    buffer_load_dwordx4 v[84:87], v4, s[16:19], s70 offen offset:2304 sc1
    buffer_load_dwordx4 v[88:91], v4, s[16:19], s68 offen offset:384 sc1
    buffer_load_dwordx4 v[92:95], v4, s[16:19], s68 offen offset:2432 sc1
    buffer_load_dwordx4 v[96:99], v4, s[16:19], s70 offen offset:384 sc1
    buffer_load_dwordx4 v[100:103], v4, s[16:19], s70 offen offset:2432 sc1
    s_waitcnt vmcnt(0)
    v_max3_u32 v13, v72, v76, v80
    v_max_u32 v13, v13, v84
    v_cmp_eq_u32 vcc, -1, v13
    s_cbranch_vccz L_a8_sr
    s_sub_u32 s54, s54, 1
    s_cbranch_scc0 L_a8_sl
    s_branch L_a8_sr
L_ld7_ss:
    s_mov_b32 s54, 2097152
L_ld7_s:
    ds_read_b128 v[20:23], v15
    s_waitcnt lgkmcnt(0)
    v_min3_u32 v20, v20, v21, v22
    v_min_u32 v20, v20, v23
    v_cmp_gt_u32 vcc, 7, v20
    s_cbranch_vccz L_ld7_s_ok
    s_sub_u32 s54, s54, 1
    s_cbranch_scc0 L_ld7_s
L_ld7_s_ok:
    s_branch L_ld7_sr
L_a12_ss:
    s_mov_b32 s54, 131072
L_a12_sl:
    buffer_load_dwordx4 v[88:91], v4, s[16:19], s68 offen offset:384 sc1
    buffer_load_dwordx4 v[92:95], v4, s[16:19], s68 offen offset:2432 sc1
    buffer_load_dwordx4 v[96:99], v4, s[16:19], s70 offen offset:384 sc1
    buffer_load_dwordx4 v[100:103], v4, s[16:19], s70 offen offset:2432 sc1
    s_waitcnt vmcnt(0)
    v_max3_u32 v13, v88, v92, v96
    v_max_u32 v13, v13, v100
    v_cmp_eq_u32 vcc, -1, v13
    s_cbranch_vccz L_a12_sr
    s_sub_u32 s54, s54, 1
    s_cbranch_scc0 L_a12_sl
    s_branch L_a12_sr
L_ld9_ss:
    s_mov_b32 s54, 2097152
L_ld9_s:
    ds_read_b128 v[20:23], v15
    s_waitcnt lgkmcnt(0)
    v_min3_u32 v20, v20, v21, v22
    v_min_u32 v20, v20, v23
    v_cmp_gt_u32 vcc, 9, v20
    s_cbranch_vccz L_ld9_s_ok
    s_sub_u32 s54, s54, 1
    s_cbranch_scc0 L_ld9_s
L_ld9_s_ok:
    s_branch L_ld9_sr
L_a16_ss:
    s_mov_b32 s54, 131072
L_a16_sl:
    buffer_load_dwordx4 v[104:107], v4, s[16:19], s68 offen offset:512 sc1
    buffer_load_dwordx4 v[108:111], v4, s[16:19], s68 offen offset:2560 sc1
    buffer_load_dwordx4 v[40:43], v4, s[16:19], s70 offen offset:512 sc1
    buffer_load_dwordx4 v[44:47], v4, s[16:19], s70 offen offset:2560 sc1
    buffer_load_dwordx4 v[48:51], v4, s[16:19], s68 offen offset:640 sc1
    buffer_load_dwordx4 v[52:55], v4, s[16:19], s68 offen offset:2688 sc1
    buffer_load_dwordx4 v[56:59], v4, s[16:19], s70 offen offset:640 sc1
    buffer_load_dwordx4 v[60:63], v4, s[16:19], s70 offen offset:2688 sc1
    s_waitcnt vmcnt(0)
    v_max3_u32 v13, v104, v108, v40
    v_max_u32 v13, v13, v44
    v_cmp_eq_u32 vcc, -1, v13
    s_cbranch_vccz L_a16_sr
    s_sub_u32 s54, s54, 1
    s_cbranch_scc0 L_a16_sl
    s_branch L_a16_sr
L_a20_ss:
    s_mov_b32 s54, 131072
L_a20_sl:
    buffer_load_dwordx4 v[48:51], v4, s[16:19], s68 offen offset:640 sc1
    buffer_load_dwordx4 v[52:55], v4, s[16:19], s68 offen offset:2688 sc1
    buffer_load_dwordx4 v[56:59], v4, s[16:19], s70 offen offset:640 sc1
    buffer_load_dwordx4 v[60:63], v4, s[16:19], s70 offen offset:2688 sc1
    s_waitcnt vmcnt(0)
    v_max3_u32 v13, v48, v52, v56
    v_max_u32 v13, v13, v60
    v_cmp_eq_u32 vcc, -1, v13
    s_cbranch_vccz L_a20_sr
    s_sub_u32 s54, s54, 1
    s_cbranch_scc0 L_a20_sl
    s_branch L_a20_sr
L_a24_ss:
    s_mov_b32 s54, 131072
L_a24_sl:
    buffer_load_dwordx4 v[64:67], v4, s[16:19], s68 offen offset:768 sc1
    buffer_load_dwordx4 v[68:71], v4, s[16:19], s68 offen offset:2816 sc1
    buffer_load_dwordx4 v[72:75], v4, s[16:19], s70 offen offset:768 sc1
    buffer_load_dwordx4 v[76:79], v4, s[16:19], s70 offen offset:2816 sc1
    buffer_load_dwordx4 v[80:83], v4, s[16:19], s68 offen offset:896 sc1
    buffer_load_dwordx4 v[84:87], v4, s[16:19], s68 offen offset:2944 sc1
    buffer_load_dwordx4 v[88:91], v4, s[16:19], s70 offen offset:896 sc1
    buffer_load_dwordx4 v[92:95], v4, s[16:19], s70 offen offset:2944 sc1
    s_waitcnt vmcnt(0)
    v_max3_u32 v13, v64, v68, v72
    v_max_u32 v13, v13, v76
    v_cmp_eq_u32 vcc, -1, v13
    s_cbranch_vccz L_a24_sr
    s_sub_u32 s54, s54, 1
    s_cbranch_scc0 L_a24_sl
    s_branch L_a24_sr
L_st_ss:
    s_mov_b32 s54, 131072
L_st_sl:
    buffer_load_dwordx4 v[28:31], v5, s[40:43], s25 offen offset:512 sc1
    buffer_load_dwordx4 v[32:35], v5, s[40:43], s25 offen offset:768 sc1
    s_waitcnt vmcnt(0)
    v_max3_u32 v36, v28, v29, v30
    v_max3_u32 v36, v36, v31, v32
    v_max3_u32 v36, v36, v33, v34
    v_max_u32 v36, v36, v35
    v_cmp_eq_u32 vcc, -1, v36
    s_cbranch_vccz L_st_sr
    s_sub_u32 s54, s54, 1
    s_cbranch_scc0 L_st_sl
    s_branch L_st_sr
L_a28_ss:
    s_mov_b32 s54, 131072
L_a28_sl:
    buffer_load_dwordx4 v[80:83], v4, s[16:19], s68 offen offset:896 sc1
    buffer_load_dwordx4 v[84:87], v4, s[16:19], s68 offen offset:2944 sc1
    buffer_load_dwordx4 v[88:91], v4, s[16:19], s70 offen offset:896 sc1
    buffer_load_dwordx4 v[92:95], v4, s[16:19], s70 offen offset:2944 sc1
    s_waitcnt vmcnt(0)
    v_max3_u32 v13, v80, v84, v88
    v_max_u32 v13, v13, v92
    v_cmp_eq_u32 vcc, -1, v13
    s_cbranch_vccz L_a28_sr
    s_sub_u32 s54, s54, 1
    s_cbranch_scc0 L_a28_sl
    s_branch L_a28_sr
L_ld16_ss:
    s_mov_b32 s54, 2097152
L_ld16_s:
    ds_read_b128 v[20:23], v15
    s_waitcnt lgkmcnt(0)
    v_min3_u32 v20, v20, v21, v22
    v_min_u32 v20, v20, v23
    v_cmp_gt_u32 vcc, 16, v20
    s_cbranch_vccz L_ld16_s_ok
    s_sub_u32 s54, s54, 1
    s_cbranch_scc0 L_ld16_s
L_ld16_s_ok:
    s_branch L_ld16_sr
L_Cxs:
    s_lshl_b32 s51, s50, 11
    s_add_u32 s51, s51, 1048576
    buffer_store_dwordx4 v[8:11], v1, s[40:43], s51 offen offset:0 sc1
    buffer_store_dwordx4 v[8:11], v1, s[40:43], s51 offen offset:1024 sc1
    s_lshl_b32 s51, s46, 1
    s_and_b32 s53, s48, 1
    s_add_u32 s51, s51, s53
    s_lshl_b32 s51, s51, 14
    s_lshl_b32 s53, s47, 2
    s_add_u32 s53, s53, s48
    s_lshr_b32 s53, s53, 1
    s_lshl_b32 s53, s53, 7
    s_add_u32 s51, s51, s53
    buffer_store_dwordx4 v[8:11], v19, s[32:35], s51 offen sc1
    s_add_u32 s51, s51, 8192
    buffer_store_dwordx4 v[8:11], v19, s[32:35], s51 offen sc1
    s_bfm_b64 exec, 16, 0
    s_lshl_b32 s51, s50, 8
    s_add_u32 s51, s51, 393216
    buffer_store_dwordx4 v[8:11], v1, s[40:43], s51 offen sc1
    s_lshl_b32 s51, s50, 8
    s_add_u32 s51, s51, 786432
    buffer_store_dwordx4 v[8:11], v1, s[40:43], s51 offen sc1
    s_mov_b64 exec, -1
    s_branch L_Cxd
L_Cfs:
    s_lshl_b32 s51, s50, 2
    s_add_u32 s51, s51, 327680
    s_mov_b64 exec, 1
    buffer_store_dword v29, off, s[40:43], s51 sc1
    s_mov_b64 exec, -1
    s_branch L_Cfd
L_c_slow:
    s_nop 9
    v_pk_add_f32 v[16:17], v[16:17], v[12:13] op_sel_hi:[1,0]
    v_pk_add_f32 v[18:19], v[18:19], v[12:13] op_sel_hi:[1,0]
    v_pk_add_f32 v[20:21], v[20:21], v[12:13] op_sel_hi:[1,0]
    v_pk_add_f32 v[22:23], v[22:23], v[12:13] op_sel_hi:[1,0]
    v_cvt_pk_bf16_f32 v40, v16, v17
    v_cvt_pk_bf16_f32 v41, v18, v19
    v_cvt_pk_bf16_f32 v42, v20, v21
    v_cvt_pk_bf16_f32 v43, v22, v23
    v_min_u32 v40, -2, v40
    buffer_store_dwordx4 v[40:43], v3, s[32:35], s55 offen sc1
    v_pk_add_f32 v[24:25], v[24:25], v[12:13] op_sel_hi:[1,0]
    v_pk_add_f32 v[26:27], v[26:27], v[12:13] op_sel_hi:[1,0]
    v_pk_add_f32 v[28:29], v[28:29], v[12:13] op_sel_hi:[1,0]
    v_pk_add_f32 v[30:31], v[30:31], v[12:13] op_sel_hi:[1,0]
    v_cvt_pk_bf16_f32 v44, v24, v25
    v_cvt_pk_bf16_f32 v45, v26, v27
    v_cvt_pk_bf16_f32 v46, v28, v29
    v_cvt_pk_bf16_f32 v47, v30, v31
    v_min_u32 v44, -2, v44
    buffer_store_dwordx4 v[44:47], v3, s[32:35], s56 offen sc1
    s_barrier
    v_dot2_f32_bf16 v15, v40, v40, 0
    v_dot2_f32_bf16 v15, v41, v41, v15
    v_dot2_f32_bf16 v15, v42, v42, v15
    v_dot2_f32_bf16 v15, v43, v43, v15
    v_dot2_f32_bf16 v15, v44, v44, v15
    v_dot2_f32_bf16 v15, v45, v45, v15
    v_dot2_f32_bf16 v15, v46, v46, v15
    v_dot2_f32_bf16 v15, v47, v47, v15
    s_nop 2
    v_permlane32_swap_b32 v14, v15
    v_add_f32 v2, v14, v15
    v_min_u32 v2, -2, v2
    buffer_store_dword v2, v1, s[40:43], s59 offen sc1
    s_branch L_c_done
L_main_slow:
    v_rcp_f32 v200, v80
    s_movk_i32 s50, 0x207
    v_mul_f32 v72, v200, v72
    v_mul_f32 v73, v200, v73
    v_mul_f32 v74, v200, v74
    v_mul_f32 v75, v200, v75
    v_mul_f32 v76, v200, v76
    v_mul_f32 v77, v200, v77
    v_mul_f32 v78, v200, v78
    v_mul_f32 v79, v200, v79
    v_rcp_f32 v200, v96
    v_min_f32 v204, v80, v96
    v_add_f32 v205, v80, v96
    v_pk_mul_f32 v[88:89], v[88:89], v[200:201] op_sel_hi:[1,0]
    v_pk_mul_f32 v[90:91], v[90:91], v[200:201] op_sel_hi:[1,0]
    v_pk_mul_f32 v[92:93], v[92:93], v[200:201] op_sel_hi:[1,0]
    v_pk_mul_f32 v[94:95], v[94:95], v[200:201] op_sel_hi:[1,0]
    v_pk_fma_f32 v[202:203], v[72:73], v[88:89], 0 op_sel_hi:[1,1,0]
    v_pk_fma_f32 v[202:203], v[74:75], v[90:91], v[202:203]
    v_pk_fma_f32 v[202:203], v[76:77], v[92:93], v[202:203]
    v_pk_fma_f32 v[202:203], v[78:79], v[94:95], v[202:203]
    v_cmp_nle_f32 vcc, 0x1f800000, v204
    v_add_f32 v202, v202, v203
    v_cmp_class_f32_e64 s[52:53], v202, s50
    s_or_b64 s[52:53], s[52:53], vcc
    v_cmp_nge_f32 vcc, 0x5f800000, v205
    v_cvt_pk_bf16_f32 v192, v72, v73
    v_cvt_pk_bf16_f32 v193, v74, v75
    v_cvt_pk_bf16_f32 v194, v76, v77
    v_cvt_pk_bf16_f32 v195, v78, v79
    s_or_b64 s[52:53], s[52:53], vcc
    s_cbranch_scc1 L_unsafe_s
L_safe_s:
    buffer_store_dwordx4 v[192:195], v7, s[40:43], s20 offen offset:0 sc1
    ds_read_b128 v[176:179], v163 offset:0
    ds_read_b128 v[180:183], v163 offset:16
    ds_read_b128 v[184:187], v163 offset:32
    ds_read_b128 v[188:191], v163 offset:48
    v_cvt_pk_bf16_f32 v196, v88, v89
    v_cvt_pk_bf16_f32 v197, v90, v91
    v_cvt_pk_bf16_f32 v198, v92, v93
    v_cvt_pk_bf16_f32 v199, v94, v95
    buffer_store_dwordx4 v[196:199], v7, s[40:43], s20 offen offset:1024 sc1
    s_xor_b32 s5, s20, 8192
    s_xor_b32 s9, s21, 1024
    s_xor_b32 s6, s20, 16384
    s_xor_b32 s10, s21, 2048
    s_xor_b32 s7, s20, 24576
    s_xor_b32 s11, s21, 3072
    s_waitcnt lgkmcnt(0)
    v_dot2_f32_bf16 v202, v192, v176, 0
    v_dot2_f32_bf16 v203, v192, v184, 0
    v_dot2_f32_bf16 v206, v193, v177, 0
    v_dot2_f32_bf16 v207, v193, v185, 0
    v_dot2_f32_bf16 v202, v194, v178, v202
    v_dot2_f32_bf16 v203, v194, v186, v203
    v_dot2_f32_bf16 v206, v195, v179, v206
    v_dot2_f32_bf16 v207, v195, v187, v207
    v_dot2_f32_bf16 v202, v196, v180, v202
    v_dot2_f32_bf16 v203, v196, v188, v203
    v_dot2_f32_bf16 v206, v197, v181, v206
    v_dot2_f32_bf16 v207, v197, v189, v207
    v_dot2_f32_bf16 v202, v198, v182, v202
    v_dot2_f32_bf16 v203, v198, v190, v203
    v_dot2_f32_bf16 v206, v199, v183, v206
    v_dot2_f32_bf16 v207, v199, v191, v207
    ds_write_b128 v162, v[192:195] offset:0
    ds_write_b128 v162, v[196:199] offset:1024
    s_nop 0
    v_pk_add_f32 v[202:203], v[202:203], v[206:207]
    v_add_f32 v202, v202, v203
    v_min_u32 v202, -2, v202
    buffer_load_dwordx4 v[208:211], v7, s[40:43], s5 offen offset:0 sc1
    buffer_load_dwordx4 v[212:215], v7, s[40:43], s5 offen offset:1024 sc1
    s_waitcnt lgkmcnt(0)
    s_barrier
    buffer_load_dwordx4 v[216:219], v7, s[40:43], s6 offen offset:0 sc1
    buffer_load_dwordx4 v[220:223], v7, s[40:43], s6 offen offset:1024 sc1
    buffer_store_dword v202, v164, s[40:43], s21 offen sc1
    buffer_load_dwordx4 v[224:227], v7, s[40:43], s7 offen offset:0 sc1
    buffer_load_dwordx4 v[228:231], v7, s[40:43], s7 offen offset:1024 sc1
    v_mov_b32 v10, v160
    v_mov_b32 v11, v161
    v_lshrrev_b32 v13, 5, v0
    v_bfe_u32 v15, v0, 2, 3
    v_lshl_add_u32 v15, v13, 4, v15
    v_and_b32 v16, 3, v0
    v_lshlrev_b32 v16, 3, v16
    v_mul_u32_u24 v17, 96, v15
    v_add_u32 v17, v17, v16
    v_add_u32 v2, 57856, v17
    v_add_u32 v3, 107008, v17
    v_lshlrev_b32 v17, 7, v15
    v_bfe_u32 v18, v0, 3, 2
    v_lshlrev_b32 v18, 5, v18
    v_add3_u32 v24, v17, v18, v16
    v_xor_b32 v25, 32, v24
    v_xor_b32 v26, 64, v24
    v_xor_b32 v27, 96, v24
    v_lshrrev_b32 v14, 4, v0
    v_lshlrev_b32 v4, 12, v14
    v_bfe_u32 v15, v0, 3, 1
    v_lshl_add_u32 v4, v15, 10, v4
    v_and_b32 v15, 7, v0
    v_lshl_add_u32 v4, v15, 4, v4
    v_and_b32 v15, 15, v0
    v_lshlrev_b32 v15, 4, v15
    v_lshl_add_u32 v5, v14, 10, v15
    v_lshl_add_u32 v6, v13, 8, v15
    v_and_b32 v14, 1, v14
    v_lshl_add_u32 v6, v14, 9, v6
    s_lshl_b32 s50, s48, 2
    s_add_u32 s50, s50, 163744
    v_mov_b32 v14, s50
    v_mov_b32 v15, 163760
    s_waitcnt vmcnt(5)
    v_max_u32 v232, v208, v212
    v_cmp_eq_u32 vcc, -1, v232
    s_cbranch_vccz L_g1_sr
    s_mov_b32 s54, 131072
L_g1_sl:
    buffer_load_dwordx4 v[208:211], v7, s[40:43], s5 offen offset:0 sc1
    buffer_load_dwordx4 v[212:215], v7, s[40:43], s5 offen offset:1024 sc1
    s_waitcnt vmcnt(0)
    v_max_u32 v232, v208, v212
    v_cmp_eq_u32 vcc, -1, v232
    s_cbranch_vccz L_g1_sr
    s_sub_u32 s54, s54, 1
    s_cbranch_scc0 L_g1_sl
L_g1_sr:
    ds_write_b128 v162, v[208:211] offset:8192
    ds_write_b128 v162, v[212:215] offset:9216
    buffer_load_dword v233, v164, s[40:43], s9 offen sc1
    buffer_load_dword v234, v164, s[40:43], s10 offen sc1
    buffer_load_dword v235, v164, s[40:43], s11 offen sc1
    s_waitcnt vmcnt(6)
    v_max_u32 v232, v216, v220
    v_cmp_eq_u32 vcc, -1, v232
    s_cbranch_vccz L_g2_sr
    s_mov_b32 s54, 131072
L_g2_sl:
    buffer_load_dwordx4 v[216:219], v7, s[40:43], s6 offen offset:0 sc1
    buffer_load_dwordx4 v[220:223], v7, s[40:43], s6 offen offset:1024 sc1
    s_waitcnt vmcnt(0)
    v_max_u32 v232, v216, v220
    v_cmp_eq_u32 vcc, -1, v232
    s_cbranch_vccz L_g2_sr
    s_sub_u32 s54, s54, 1
    s_cbranch_scc0 L_g2_sl
L_g2_sr:
    ds_write_b128 v162, v[216:219] offset:16384
    ds_write_b128 v162, v[220:223] offset:17408
    s_waitcnt lgkmcnt(2)
    s_barrier
    s_waitcnt vmcnt(3)
    v_max_u32 v232, v224, v228
    v_cmp_eq_u32 vcc, -1, v232
    s_cbranch_vccz L_g3_sr
    s_mov_b32 s54, 131072
L_g3_sl:
    buffer_load_dwordx4 v[224:227], v7, s[40:43], s7 offen offset:0 sc1
    buffer_load_dwordx4 v[228:231], v7, s[40:43], s7 offen offset:1024 sc1
    s_waitcnt vmcnt(0)
    v_max_u32 v232, v224, v228
    v_cmp_eq_u32 vcc, -1, v232
    s_cbranch_vccz L_g3_sr
    s_sub_u32 s54, s54, 1
    s_cbranch_scc0 L_g3_sl
L_g3_sr:
    ds_write_b128 v162, v[224:227] offset:24576
    ds_write_b128 v162, v[228:231] offset:25600
    s_waitcnt lgkmcnt(2)
    s_barrier
    s_waitcnt vmcnt(0)
    v_max3_u32 v232, v233, v234, v235
    v_cmp_eq_u32 vcc, -1, v232
    s_cbranch_vccz L_gp_sr
    s_mov_b32 s54, 131072
L_gp_sl:
    buffer_load_dword v233, v164, s[40:43], s9 offen sc1
    buffer_load_dword v234, v164, s[40:43], s10 offen sc1
    buffer_load_dword v235, v164, s[40:43], s11 offen sc1
    s_waitcnt vmcnt(0)
    v_max3_u32 v232, v233, v234, v235
    v_cmp_eq_u32 vcc, -1, v232
    s_cbranch_vccz L_gp_sr
    s_sub_u32 s54, s54, 1
    s_cbranch_scc0 L_gp_sl
L_gp_sr:
    v_add_f32 v233, v233, v234
    v_add_f32 v202, v202, v235
    v_add_f32 v202, v202, v233
    ds_write_b32 v165, v202
    s_waitcnt lgkmcnt(0)
    s_barrier
    ds_read_b64_tr_b16 v[112:113], v2 offset:0
    ds_read_b64_tr_b16 v[114:115], v2 offset:768
    ds_read_b64_tr_b16 v[116:117], v2 offset:32
    ds_read_b64_tr_b16 v[118:119], v2 offset:800
    ds_read_b64_tr_b16 v[120:121], v2 offset:64
    ds_read_b64_tr_b16 v[122:123], v2 offset:832
    ds_read_b64_tr_b16 v[124:125], v24 offset:33280
    ds_read_b64_tr_b16 v[126:127], v24 offset:34304
    ds_read_b64_tr_b16 v[128:129], v25 offset:33280
    ds_read_b64_tr_b16 v[130:131], v25 offset:34304
    ds_read_b64_tr_b16 v[132:133], v26 offset:33280
    ds_read_b64_tr_b16 v[134:135], v26 offset:34304
    ds_read_b64_tr_b16 v[136:137], v27 offset:33280
    ds_read_b64_tr_b16 v[138:139], v27 offset:34304
    s_barrier
    buffer_load_dwordx4 v[40:43], v4, s[16:19], s68 offen offset:0 sc1
    buffer_load_dwordx4 v[44:47], v4, s[16:19], s68 offen offset:2048 sc1
    s_waitcnt vmcnt(0)
    v_max_u32 v13, v40, v44
    v_cmp_eq_u32 vcc, -1, v13
    s_cbranch_vccz L_a0_sr
    s_mov_b32 s54, 131072
L_a0_sl:
    buffer_load_dwordx4 v[40:43], v4, s[16:19], s68 offen offset:0 sc1
    buffer_load_dwordx4 v[44:47], v4, s[16:19], s68 offen offset:2048 sc1
    s_waitcnt vmcnt(0)
    v_max_u32 v13, v40, v44
    v_cmp_eq_u32 vcc, -1, v13
    s_cbranch_vccz L_a0_sr
    s_sub_u32 s54, s54, 1
    s_cbranch_scc0 L_a0_sl
L_a0_sr:
    s_waitcnt lgkmcnt(6)
    v_mfma_f32_16x16x32_bf16 v[144:147], v[112:115], v[40:43], 0
    buffer_load_dwordx4 v[48:51], v4, s[16:19], s70 offen offset:0 sc1
    buffer_load_dwordx4 v[52:55], v4, s[16:19], s70 offen offset:2048 sc1
    ds_read_b64_tr_b16 v[140:141], v2 offset:3072
    v_mfma_f32_16x16x32_bf16 v[148:151], v[112:115], v[44:47], 0
    ds_read_b64_tr_b16 v[142:143], v2 offset:3840
    v_mfma_f32_16x16x32_bf16 v[160:163], v[116:119], v[40:43], 0
    ds_read_b64_tr_b16 v[112:113], v2 offset:3104
    v_mfma_f32_16x16x32_bf16 v[164:167], v[116:119], v[44:47], 0
    ds_read_b64_tr_b16 v[114:115], v2 offset:3872
    v_mfma_f32_16x16x32_bf16 v[176:179], v[120:123], v[40:43], 0
    ds_read_b64_tr_b16 v[116:117], v2 offset:3136
    v_mfma_f32_16x16x32_bf16 v[180:183], v[120:123], v[44:47], 0
    ds_read_b64_tr_b16 v[118:119], v2 offset:3904
    v_mfma_f32_16x16x32_bf16 v[192:195], v[124:127], v[40:43], 0
    buffer_load_dwordx4 v[56:59], v4, s[16:19], s68 offen offset:128 sc1
    buffer_load_dwordx4 v[60:63], v4, s[16:19], s68 offen offset:2176 sc1
    ds_read_b64_tr_b16 v[120:121], v24 offset:37376
    v_mov_b32 v16, 1
    v_mfma_f32_16x16x32_bf16 v[196:199], v[124:127], v[44:47], 0
    ds_read_b64_tr_b16 v[122:123], v24 offset:38400
    ds_write_b32 v14, v16
    s_waitcnt lgkmcnt(7)
    v_mfma_f32_16x16x32_bf16 v[208:211], v[128:131], v[40:43], 0
    ds_read_b64_tr_b16 v[124:125], v25 offset:37376
    v_mfma_f32_16x16x32_bf16 v[212:215], v[128:131], v[44:47], 0
    ds_read_b64_tr_b16 v[126:127], v25 offset:38400
    v_mfma_f32_16x16x32_bf16 v[224:227], v[132:135], v[40:43], 0
    ds_read_b64_tr_b16 v[128:129], v26 offset:37376
    v_mfma_f32_16x16x32_bf16 v[228:231], v[132:135], v[44:47], 0
    ds_read_b64_tr_b16 v[130:131], v26 offset:38400
    v_mfma_f32_16x16x32_bf16 v[240:243], v[136:139], v[40:43], 0
    ds_read_b64_tr_b16 v[132:133], v27 offset:37376
    v_mfma_f32_16x16x32_bf16 v[244:247], v[136:139], v[44:47], 0
    ds_read_b64_tr_b16 v[134:135], v27 offset:38400
    v_mfma_f32_16x16x32_bf16 v[152:155], v[140:143], v[40:43], 0
    ds_read_b64_tr_b16 v[136:137], v2 offset:6144
    v_mfma_f32_16x16x32_bf16 v[156:159], v[140:143], v[44:47], 0
    ds_read_b64_tr_b16 v[138:139], v2 offset:6912
    s_waitcnt lgkmcnt(6)
    v_mfma_f32_16x16x32_bf16 v[168:171], v[112:115], v[40:43], 0
    buffer_load_dwordx4 v[64:67], v4, s[16:19], s70 offen offset:128 sc1
    buffer_load_dwordx4 v[68:71], v4, s[16:19], s70 offen offset:2176 sc1
    ds_read_b64_tr_b16 v[140:141], v2 offset:6176
    v_mfma_f32_16x16x32_bf16 v[172:175], v[112:115], v[44:47], 0
    ds_read_b64_tr_b16 v[142:143], v2 offset:6944
    v_mfma_f32_16x16x32_bf16 v[184:187], v[116:119], v[40:43], 0
    ds_read_b64_tr_b16 v[112:113], v2 offset:6208
    v_mfma_f32_16x16x32_bf16 v[188:191], v[116:119], v[44:47], 0
    ds_read_b64_tr_b16 v[114:115], v2 offset:6976
    v_mfma_f32_16x16x32_bf16 v[200:203], v[120:123], v[40:43], 0
    ds_read_b64_tr_b16 v[116:117], v24 offset:41472
    v_mfma_f32_16x16x32_bf16 v[204:207], v[120:123], v[44:47], 0
    ds_read_b64_tr_b16 v[118:119], v24 offset:42496
    v_mfma_f32_16x16x32_bf16 v[216:219], v[124:127], v[40:43], 0
    ds_read_b64_tr_b16 v[120:121], v25 offset:41472
    v_mfma_f32_16x16x32_bf16 v[220:223], v[124:127], v[44:47], 0
    ds_read_b64_tr_b16 v[122:123], v25 offset:42496
    s_waitcnt vmcnt(4)
    v_max_u32 v13, v48, v52
    v_cmp_eq_u32 vcc, -1, v13
    s_cbranch_vccnz L_a2_ss
L_a2_sr:
    s_waitcnt lgkmcnt(6)
    v_mfma_f32_16x16x32_bf16 v[232:235], v[128:131], v[40:43], 0
    ds_read_b64_tr_b16 v[124:125], v26 offset:41472
    v_mfma_f32_16x16x32_bf16 v[236:239], v[128:131], v[44:47], 0
    ds_read_b64_tr_b16 v[126:127], v26 offset:42496
    v_mfma_f32_16x16x32_bf16 v[248:251], v[132:135], v[40:43], 0
    ds_read_b64_tr_b16 v[128:129], v27 offset:41472
    v_mov_b32 v16, 2
    v_mfma_f32_16x16x32_bf16 v[252:255], v[132:135], v[44:47], 0
    ds_read_b64_tr_b16 v[130:131], v27 offset:42496
    ds_write_b32 v14, v16
    v_mfma_f32_16x16x32_bf16 v[144:147], v[136:139], v[48:51], v[144:147]
    ds_read_b64_tr_b16 v[132:133], v2 offset:9216
    v_mfma_f32_16x16x32_bf16 v[148:151], v[136:139], v[52:55], v[148:151]
    ds_read_b64_tr_b16 v[134:135], v2 offset:9984
    v_mfma_f32_16x16x32_bf16 v[160:163], v[140:143], v[48:51], v[160:163]
    buffer_load_dwordx4 v[72:75], v4, s[16:19], s68 offen offset:256 sc1
    buffer_load_dwordx4 v[76:79], v4, s[16:19], s68 offen offset:2304 sc1
    ds_read_b64_tr_b16 v[136:137], v2 offset:9248
    v_mfma_f32_16x16x32_bf16 v[164:167], v[140:143], v[52:55], v[164:167]
    ds_read_b64_tr_b16 v[138:139], v2 offset:10016
    s_waitcnt lgkmcnt(7)
    v_mfma_f32_16x16x32_bf16 v[176:179], v[112:115], v[48:51], v[176:179]
    ds_read_b64_tr_b16 v[140:141], v2 offset:9280
    v_mfma_f32_16x16x32_bf16 v[180:183], v[112:115], v[52:55], v[180:183]
    ds_read_b64_tr_b16 v[142:143], v2 offset:10048
    v_mfma_f32_16x16x32_bf16 v[192:195], v[116:119], v[48:51], v[192:195]
    ds_read_b64_tr_b16 v[112:113], v24 offset:45568
    v_mfma_f32_16x16x32_bf16 v[196:199], v[116:119], v[52:55], v[196:199]
    ds_read_b64_tr_b16 v[114:115], v24 offset:46592
    v_mfma_f32_16x16x32_bf16 v[208:211], v[120:123], v[48:51], v[208:211]
    ds_read_b64_tr_b16 v[116:117], v25 offset:45568
    v_mfma_f32_16x16x32_bf16 v[212:215], v[120:123], v[52:55], v[212:215]
    ds_read_b64_tr_b16 v[118:119], v25 offset:46592
    v_mfma_f32_16x16x32_bf16 v[224:227], v[124:127], v[48:51], v[224:227]
    ds_read_b64_tr_b16 v[120:121], v26 offset:45568
    v_mfma_f32_16x16x32_bf16 v[228:231], v[124:127], v[52:55], v[228:231]
    ds_read_b64_tr_b16 v[122:123], v26 offset:46592
    s_waitcnt lgkmcnt(6)
    v_mfma_f32_16x16x32_bf16 v[240:243], v[128:131], v[48:51], v[240:243]
    ds_read_b64_tr_b16 v[124:125], v27 offset:45568
    v_mfma_f32_16x16x32_bf16 v[244:247], v[128:131], v[52:55], v[244:247]
    ds_read_b64_tr_b16 v[126:127], v27 offset:46592
    v_mfma_f32_16x16x32_bf16 v[152:155], v[132:135], v[48:51], v[152:155]
    ds_read_b64_tr_b16 v[128:129], v2 offset:12288
    v_mfma_f32_16x16x32_bf16 v[156:159], v[132:135], v[52:55], v[156:159]
    ds_read_b64_tr_b16 v[130:131], v2 offset:13056
    v_mfma_f32_16x16x32_bf16 v[168:171], v[136:139], v[48:51], v[168:171]
    buffer_load_dwordx4 v[80:83], v4, s[16:19], s70 offen offset:256 sc1
    buffer_load_dwordx4 v[84:87], v4, s[16:19], s70 offen offset:2304 sc1
    ds_read_b64_tr_b16 v[132:133], v2 offset:12320
    v_mfma_f32_16x16x32_bf16 v[172:175], v[136:139], v[52:55], v[172:175]
    ds_read_b64_tr_b16 v[134:135], v2 offset:13088
    v_mfma_f32_16x16x32_bf16 v[184:187], v[140:143], v[48:51], v[184:187]
    ds_read_b64_tr_b16 v[136:137], v2 offset:12352
    v_mfma_f32_16x16x32_bf16 v[188:191], v[140:143], v[52:55], v[188:191]
    ds_read_b64_tr_b16 v[138:139], v2 offset:13120
    s_waitcnt lgkmcnt(6)
    v_mfma_f32_16x16x32_bf16 v[200:203], v[112:115], v[48:51], v[200:203]
    ds_read_b64_tr_b16 v[140:141], v24 offset:49664
    v_mfma_f32_16x16x32_bf16 v[204:207], v[112:115], v[52:55], v[204:207]
    ds_read_b64_tr_b16 v[142:143], v24 offset:50688
    v_mfma_f32_16x16x32_bf16 v[216:219], v[116:119], v[48:51], v[216:219]
    ds_read_b64_tr_b16 v[112:113], v25 offset:49664
    v_mfma_f32_16x16x32_bf16 v[220:223], v[116:119], v[52:55], v[220:223]
    ds_read_b64_tr_b16 v[114:115], v25 offset:50688
    s_waitcnt vmcnt(4)
    v_max3_u32 v13, v56, v60, v64
    v_max_u32 v13, v13, v68
    v_cmp_eq_u32 vcc, -1, v13
    s_cbranch_vccnz L_a4_ss
L_a4_sr:
    v_mfma_f32_16x16x32_bf16 v[232:235], v[120:123], v[48:51], v[232:235]
    ds_read_b64_tr_b16 v[116:117], v26 offset:49664
    v_mfma_f32_16x16x32_bf16 v[236:239], v[120:123], v[52:55], v[236:239]
    ds_read_b64_tr_b16 v[118:119], v26 offset:50688
    v_mfma_f32_16x16x32_bf16 v[248:251], v[124:127], v[48:51], v[248:251]
    ds_read_b64_tr_b16 v[120:121], v27 offset:49664
    v_mov_b32 v16, 3
    v_mfma_f32_16x16x32_bf16 v[252:255], v[124:127], v[52:55], v[252:255]
    ds_read_b64_tr_b16 v[122:123], v27 offset:50688
    ds_write_b32 v14, v16
    s_waitcnt lgkmcnt(7)
    v_mfma_f32_16x16x32_bf16 v[144:147], v[128:131], v[56:59], v[144:147]
    ds_read_b64_tr_b16 v[124:125], v2 offset:15360
    v_mfma_f32_16x16x32_bf16 v[148:151], v[128:131], v[60:63], v[148:151]
    ds_read_b64_tr_b16 v[126:127], v2 offset:16128
    v_mfma_f32_16x16x32_bf16 v[160:163], v[132:135], v[56:59], v[160:163]
    buffer_load_dwordx4 v[88:91], v4, s[16:19], s68 offen offset:384 sc1
    buffer_load_dwordx4 v[92:95], v4, s[16:19], s68 offen offset:2432 sc1
    ds_read_b64_tr_b16 v[128:129], v2 offset:15392
    v_mfma_f32_16x16x32_bf16 v[164:167], v[132:135], v[60:63], v[164:167]
    ds_read_b64_tr_b16 v[130:131], v2 offset:16160
    v_mfma_f32_16x16x32_bf16 v[176:179], v[136:139], v[56:59], v[176:179]
    ds_read_b64_tr_b16 v[132:133], v2 offset:15424
    v_mfma_f32_16x16x32_bf16 v[180:183], v[136:139], v[60:63], v[180:183]
    ds_read_b64_tr_b16 v[134:135], v2 offset:16192
    v_mfma_f32_16x16x32_bf16 v[192:195], v[140:143], v[56:59], v[192:195]
    ds_read_b64_tr_b16 v[136:137], v24 offset:53760
    v_mfma_f32_16x16x32_bf16 v[196:199], v[140:143], v[60:63], v[196:199]
    ds_read_b64_tr_b16 v[138:139], v24 offset:54784
    s_waitcnt lgkmcnt(6)
    v_mfma_f32_16x16x32_bf16 v[208:211], v[112:115], v[56:59], v[208:211]
    ds_read_b64_tr_b16 v[140:141], v25 offset:53760
    v_mfma_f32_16x16x32_bf16 v[212:215], v[112:115], v[60:63], v[212:215]
    ds_read_b64_tr_b16 v[142:143], v25 offset:54784
    v_mfma_f32_16x16x32_bf16 v[224:227], v[116:119], v[56:59], v[224:227]
    ds_read_b64_tr_b16 v[112:113], v26 offset:53760
    ds_read_b128 v[20:23], v15
    v_mfma_f32_16x16x32_bf16 v[228:231], v[116:119], v[60:63], v[228:231]
    ds_read_b64_tr_b16 v[114:115], v26 offset:54784
    v_mfma_f32_16x16x32_bf16 v[240:243], v[120:123], v[56:59], v[240:243]
    ds_read_b64_tr_b16 v[116:117], v27 offset:53760
    v_mfma_f32_16x16x32_bf16 v[244:247], v[120:123], v[60:63], v[244:247]
    ds_read_b64_tr_b16 v[118:119], v27 offset:54784
    v_mfma_f32_16x16x32_bf16 v[152:155], v[124:127], v[56:59], v[152:155]
    ds_read_b64_tr_b16 v[120:121], v2 offset:18432
    v_mfma_f32_16x16x32_bf16 v[156:159], v[124:127], v[60:63], v[156:159]
    ds_read_b64_tr_b16 v[122:123], v2 offset:19200
    s_waitcnt lgkmcnt(7)
    v_mfma_f32_16x16x32_bf16 v[168:171], v[128:131], v[56:59], v[168:171]
    buffer_load_dwordx4 v[96:99], v4, s[16:19], s70 offen offset:384 sc1
    buffer_load_dwordx4 v[100:103], v4, s[16:19], s70 offen offset:2432 sc1
    ds_read_b64_tr_b16 v[124:125], v2 offset:18464
    v_mfma_f32_16x16x32_bf16 v[172:175], v[128:131], v[60:63], v[172:175]
    ds_read_b64_tr_b16 v[126:127], v2 offset:19232
    v_mfma_f32_16x16x32_bf16 v[184:187], v[132:135], v[56:59], v[184:187]
    ds_read_b64_tr_b16 v[128:129], v2 offset:18496
    v_mfma_f32_16x16x32_bf16 v[188:191], v[132:135], v[60:63], v[188:191]
    ds_read_b64_tr_b16 v[130:131], v2 offset:19264
    s_waitcnt lgkmcnt(9)
    v_min3_u32 v20, v20, v21, v22
    v_min_u32 v20, v20, v23
    v_cmp_gt_u32 vcc, 5, v20
    v_mfma_f32_16x16x32_bf16 v[200:203], v[136:139], v[56:59], v[200:203]
    s_cbranch_vccnz L_ld5_ss
L_ld5_sr:
    ds_read_b64_tr_b16 v[132:133], v24 offset:0
    v_mfma_f32_16x16x32_bf16 v[204:207], v[136:139], v[60:63], v[204:207]
    ds_read_b64_tr_b16 v[134:135], v24 offset:1024
    v_mfma_f32_16x16x32_bf16 v[216:219], v[140:143], v[56:59], v[216:219]
    ds_read_b64_tr_b16 v[136:137], v25 offset:0
    v_mfma_f32_16x16x32_bf16 v[220:223], v[140:143], v[60:63], v[220:223]
    ds_read_b64_tr_b16 v[138:139], v25 offset:1024
    s_waitcnt lgkmcnt(6)
    v_mfma_f32_16x16x32_bf16 v[232:235], v[112:115], v[56:59], v[232:235]
    ds_read_b64_tr_b16 v[140:141], v26 offset:0
    v_mfma_f32_16x16x32_bf16 v[236:239], v[112:115], v[60:63], v[236:239]
    ds_read_b64_tr_b16 v[142:143], v26 offset:1024
    v_mfma_f32_16x16x32_bf16 v[248:251], v[116:119], v[56:59], v[248:251]
    ds_read_b64_tr_b16 v[112:113], v27 offset:0
    v_mov_b32 v16, 4
    v_mfma_f32_16x16x32_bf16 v[252:255], v[116:119], v[60:63], v[252:255]
    ds_read_b64_tr_b16 v[114:115], v27 offset:1024
    ds_write_b32 v14, v16
    v_mfma_f32_16x16x32_bf16 v[144:147], v[120:123], v[64:67], v[144:147]
    ds_read_b64_tr_b16 v[116:117], v2 offset:21504
    v_mfma_f32_16x16x32_bf16 v[148:151], v[120:123], v[68:71], v[148:151]
    ds_read_b64_tr_b16 v[118:119], v2 offset:22272
    v_mfma_f32_16x16x32_bf16 v[160:163], v[124:127], v[64:67], v[160:163]
    buffer_load_dwordx4 v[104:107], v4, s[16:19], s68 offen offset:512 sc1
    buffer_load_dwordx4 v[108:111], v4, s[16:19], s68 offen offset:2560 sc1
    ds_read_b64_tr_b16 v[120:121], v2 offset:21536
    v_mfma_f32_16x16x32_bf16 v[164:167], v[124:127], v[68:71], v[164:167]
    ds_read_b64_tr_b16 v[122:123], v2 offset:22304
    s_waitcnt lgkmcnt(7)
    v_mfma_f32_16x16x32_bf16 v[176:179], v[128:131], v[64:67], v[176:179]
    ds_read_b64_tr_b16 v[124:125], v2 offset:21568
    v_mfma_f32_16x16x32_bf16 v[180:183], v[128:131], v[68:71], v[180:183]
    ds_read_b64_tr_b16 v[126:127], v2 offset:22336
    v_mfma_f32_16x16x32_bf16 v[192:195], v[132:135], v[64:67], v[192:195]
    ds_read_b64_tr_b16 v[128:129], v24 offset:4096
    v_mfma_f32_16x16x32_bf16 v[196:199], v[132:135], v[68:71], v[196:199]
    ds_read_b64_tr_b16 v[130:131], v24 offset:5120
    v_mfma_f32_16x16x32_bf16 v[208:211], v[136:139], v[64:67], v[208:211]
    ds_read_b64_tr_b16 v[132:133], v25 offset:4096
    v_mfma_f32_16x16x32_bf16 v[212:215], v[136:139], v[68:71], v[212:215]
    ds_read_b64_tr_b16 v[134:135], v25 offset:5120
    v_mfma_f32_16x16x32_bf16 v[224:227], v[140:143], v[64:67], v[224:227]
    ds_read_b64_tr_b16 v[136:137], v26 offset:4096
    v_mfma_f32_16x16x32_bf16 v[228:231], v[140:143], v[68:71], v[228:231]
    ds_read_b64_tr_b16 v[138:139], v26 offset:5120
    s_waitcnt lgkmcnt(6)
    v_mfma_f32_16x16x32_bf16 v[240:243], v[112:115], v[64:67], v[240:243]
    ds_read_b64_tr_b16 v[140:141], v27 offset:4096
    v_mfma_f32_16x16x32_bf16 v[244:247], v[112:115], v[68:71], v[244:247]
    ds_read_b64_tr_b16 v[142:143], v27 offset:5120
    v_mfma_f32_16x16x32_bf16 v[152:155], v[116:119], v[64:67], v[152:155]
    ds_read_b64_tr_b16 v[112:113], v2 offset:24576
    v_mfma_f32_16x16x32_bf16 v[156:159], v[116:119], v[68:71], v[156:159]
    ds_read_b64_tr_b16 v[114:115], v2 offset:25344
    v_mfma_f32_16x16x32_bf16 v[168:171], v[120:123], v[64:67], v[168:171]
    buffer_load_dwordx4 v[40:43], v4, s[16:19], s70 offen offset:512 sc1
    buffer_load_dwordx4 v[44:47], v4, s[16:19], s70 offen offset:2560 sc1
    ds_read_b64_tr_b16 v[116:117], v2 offset:24608
    v_mfma_f32_16x16x32_bf16 v[172:175], v[120:123], v[68:71], v[172:175]
    ds_read_b64_tr_b16 v[118:119], v2 offset:25376
    v_mfma_f32_16x16x32_bf16 v[184:187], v[124:127], v[64:67], v[184:187]
    ds_read_b64_tr_b16 v[120:121], v2 offset:24640
    v_mfma_f32_16x16x32_bf16 v[188:191], v[124:127], v[68:71], v[188:191]
    ds_read_b64_tr_b16 v[122:123], v2 offset:25408
    s_waitcnt lgkmcnt(6)
    v_mfma_f32_16x16x32_bf16 v[200:203], v[128:131], v[64:67], v[200:203]
    ds_read_b64_tr_b16 v[124:125], v24 offset:8192
    v_mfma_f32_16x16x32_bf16 v[204:207], v[128:131], v[68:71], v[204:207]
    ds_read_b64_tr_b16 v[126:127], v24 offset:9216
    v_mfma_f32_16x16x32_bf16 v[216:219], v[132:135], v[64:67], v[216:219]
    ds_read_b64_tr_b16 v[128:129], v25 offset:8192
    v_mfma_f32_16x16x32_bf16 v[220:223], v[132:135], v[68:71], v[220:223]
    ds_read_b64_tr_b16 v[130:131], v25 offset:9216
    s_waitcnt vmcnt(8)
    v_max3_u32 v13, v72, v76, v80
    v_max_u32 v13, v13, v84
    v_cmp_eq_u32 vcc, -1, v13
    s_cbranch_vccnz L_a8_ss
L_a8_sr:
    v_mfma_f32_16x16x32_bf16 v[232:235], v[136:139], v[64:67], v[232:235]
    ds_read_b64_tr_b16 v[132:133], v26 offset:8192
    v_mfma_f32_16x16x32_bf16 v[236:239], v[136:139], v[68:71], v[236:239]
    ds_read_b64_tr_b16 v[134:135], v26 offset:9216
    v_mfma_f32_16x16x32_bf16 v[248:251], v[140:143], v[64:67], v[248:251]
    ds_read_b64_tr_b16 v[136:137], v27 offset:8192
    v_mov_b32 v16, 5
    v_mfma_f32_16x16x32_bf16 v[252:255], v[140:143], v[68:71], v[252:255]
    ds_read_b64_tr_b16 v[138:139], v27 offset:9216
    ds_write_b32 v14, v16
    s_waitcnt lgkmcnt(7)
    v_mfma_f32_16x16x32_bf16 v[144:147], v[112:115], v[72:75], v[144:147]
    ds_read_b64_tr_b16 v[140:141], v2 offset:27648
    v_mfma_f32_16x16x32_bf16 v[148:151], v[112:115], v[76:79], v[148:151]
    ds_read_b64_tr_b16 v[142:143], v2 offset:28416
    v_mfma_f32_16x16x32_bf16 v[160:163], v[116:119], v[72:75], v[160:163]
    buffer_load_dwordx4 v[48:51], v4, s[16:19], s68 offen offset:640 sc1
    buffer_load_dwordx4 v[52:55], v4, s[16:19], s68 offen offset:2688 sc1
    ds_read_b64_tr_b16 v[112:113], v2 offset:27680
    v_mfma_f32_16x16x32_bf16 v[164:167], v[116:119], v[76:79], v[164:167]
    ds_read_b64_tr_b16 v[114:115], v2 offset:28448
    v_mfma_f32_16x16x32_bf16 v[176:179], v[120:123], v[72:75], v[176:179]
    ds_read_b64_tr_b16 v[116:117], v2 offset:27712
    v_mfma_f32_16x16x32_bf16 v[180:183], v[120:123], v[76:79], v[180:183]
    ds_read_b64_tr_b16 v[118:119], v2 offset:28480
    v_mfma_f32_16x16x32_bf16 v[192:195], v[124:127], v[72:75], v[192:195]
    ds_read_b64_tr_b16 v[120:121], v24 offset:12288
    v_mfma_f32_16x16x32_bf16 v[196:199], v[124:127], v[76:79], v[196:199]
    ds_read_b64_tr_b16 v[122:123], v24 offset:13312
    s_waitcnt lgkmcnt(6)
    v_mfma_f32_16x16x32_bf16 v[208:211], v[128:131], v[72:75], v[208:211]
    ds_read_b64_tr_b16 v[124:125], v25 offset:12288
    v_mfma_f32_16x16x32_bf16 v[212:215], v[128:131], v[76:79], v[212:215]
    ds_read_b64_tr_b16 v[126:127], v25 offset:13312
    v_mfma_f32_16x16x32_bf16 v[224:227], v[132:135], v[72:75], v[224:227]
    ds_read_b64_tr_b16 v[128:129], v26 offset:12288
    ds_read_b128 v[20:23], v15
    v_mfma_f32_16x16x32_bf16 v[228:231], v[132:135], v[76:79], v[228:231]
    ds_read_b64_tr_b16 v[130:131], v26 offset:13312
    v_mfma_f32_16x16x32_bf16 v[240:243], v[136:139], v[72:75], v[240:243]
    ds_read_b64_tr_b16 v[132:133], v27 offset:12288
    v_mfma_f32_16x16x32_bf16 v[244:247], v[136:139], v[76:79], v[244:247]
    ds_read_b64_tr_b16 v[134:135], v27 offset:13312
    v_mfma_f32_16x16x32_bf16 v[152:155], v[140:143], v[72:75], v[152:155]
    ds_read_b64_tr_b16 v[136:137], v2 offset:30720
    v_mfma_f32_16x16x32_bf16 v[156:159], v[140:143], v[76:79], v[156:159]
    ds_read_b64_tr_b16 v[138:139], v2 offset:31488
    s_waitcnt lgkmcnt(7)
    v_mfma_f32_16x16x32_bf16 v[168:171], v[112:115], v[72:75], v[168:171]
    buffer_load_dwordx4 v[56:59], v4, s[16:19], s70 offen offset:640 sc1
    buffer_load_dwordx4 v[60:63], v4, s[16:19], s70 offen offset:2688 sc1
    ds_read_b64_tr_b16 v[140:141], v2 offset:30752
    v_mfma_f32_16x16x32_bf16 v[172:175], v[112:115], v[76:79], v[172:175]
    ds_read_b64_tr_b16 v[142:143], v2 offset:31520
    v_mfma_f32_16x16x32_bf16 v[184:187], v[116:119], v[72:75], v[184:187]
    ds_read_b64_tr_b16 v[112:113], v2 offset:30784
    v_mfma_f32_16x16x32_bf16 v[188:191], v[116:119], v[76:79], v[188:191]
    ds_read_b64_tr_b16 v[114:115], v2 offset:31552
    s_waitcnt lgkmcnt(9)
    v_min3_u32 v20, v20, v21, v22
    v_min_u32 v20, v20, v23
    v_cmp_gt_u32 vcc, 7, v20
    v_mfma_f32_16x16x32_bf16 v[200:203], v[120:123], v[72:75], v[200:203]
    s_cbranch_vccnz L_ld7_ss
L_ld7_sr:
    ds_read_b64_tr_b16 v[116:117], v24 offset:16384
    v_mfma_f32_16x16x32_bf16 v[204:207], v[120:123], v[76:79], v[204:207]
    ds_read_b64_tr_b16 v[118:119], v24 offset:17408
    v_mfma_f32_16x16x32_bf16 v[216:219], v[124:127], v[72:75], v[216:219]
    ds_read_b64_tr_b16 v[120:121], v25 offset:16384
    v_mfma_f32_16x16x32_bf16 v[220:223], v[124:127], v[76:79], v[220:223]
    ds_read_b64_tr_b16 v[122:123], v25 offset:17408
    s_waitcnt lgkmcnt(6)
    v_mfma_f32_16x16x32_bf16 v[232:235], v[128:131], v[72:75], v[232:235]
    ds_read_b64_tr_b16 v[124:125], v26 offset:16384
    v_mfma_f32_16x16x32_bf16 v[236:239], v[128:131], v[76:79], v[236:239]
    ds_read_b64_tr_b16 v[126:127], v26 offset:17408
    v_mfma_f32_16x16x32_bf16 v[248:251], v[132:135], v[72:75], v[248:251]
    ds_read_b64_tr_b16 v[128:129], v27 offset:16384
    v_mov_b32 v16, 6
    v_mfma_f32_16x16x32_bf16 v[252:255], v[132:135], v[76:79], v[252:255]
    ds_read_b64_tr_b16 v[130:131], v27 offset:17408
    ds_write_b32 v14, v16
    v_mfma_f32_16x16x32_bf16 v[144:147], v[136:139], v[80:83], v[144:147]
    ds_read_b64_tr_b16 v[132:133], v2 offset:33792
    v_mfma_f32_16x16x32_bf16 v[148:151], v[136:139], v[84:87], v[148:151]
    ds_read_b64_tr_b16 v[134:135], v2 offset:34560
    v_mfma_f32_16x16x32_bf16 v[160:163], v[140:143], v[80:83], v[160:163]
    buffer_load_dwordx4 v[64:67], v4, s[16:19], s68 offen offset:768 sc1
    buffer_load_dwordx4 v[68:71], v4, s[16:19], s68 offen offset:2816 sc1
    ds_read_b64_tr_b16 v[136:137], v2 offset:33824
    v_mfma_f32_16x16x32_bf16 v[164:167], v[140:143], v[84:87], v[164:167]
    ds_read_b64_tr_b16 v[138:139], v2 offset:34592
    s_waitcnt lgkmcnt(7)
    v_mfma_f32_16x16x32_bf16 v[176:179], v[112:115], v[80:83], v[176:179]
    ds_read_b64_tr_b16 v[140:141], v2 offset:33856
    v_mfma_f32_16x16x32_bf16 v[180:183], v[112:115], v[84:87], v[180:183]
    ds_read_b64_tr_b16 v[142:143], v2 offset:34624
    v_mfma_f32_16x16x32_bf16 v[192:195], v[116:119], v[80:83], v[192:195]
    ds_read_b64_tr_b16 v[112:113], v24 offset:20480
    v_mfma_f32_16x16x32_bf16 v[196:199], v[116:119], v[84:87], v[196:199]
    ds_read_b64_tr_b16 v[114:115], v24 offset:21504
    v_mfma_f32_16x16x32_bf16 v[208:211], v[120:123], v[80:83], v[208:211]
    ds_read_b64_tr_b16 v[116:117], v25 offset:20480
    v_mfma_f32_16x16x32_bf16 v[212:215], v[120:123], v[84:87], v[212:215]
    ds_read_b64_tr_b16 v[118:119], v25 offset:21504
    v_mfma_f32_16x16x32_bf16 v[224:227], v[124:127], v[80:83], v[224:227]
    ds_read_b64_tr_b16 v[120:121], v26 offset:20480
    v_mfma_f32_16x16x32_bf16 v[228:231], v[124:127], v[84:87], v[228:231]
    ds_read_b64_tr_b16 v[122:123], v26 offset:21504
    s_waitcnt lgkmcnt(6)
    v_mfma_f32_16x16x32_bf16 v[240:243], v[128:131], v[80:83], v[240:243]
    ds_read_b64_tr_b16 v[124:125], v27 offset:20480
    v_mfma_f32_16x16x32_bf16 v[244:247], v[128:131], v[84:87], v[244:247]
    ds_read_b64_tr_b16 v[126:127], v27 offset:21504
    s_waitcnt vmcnt(10)
    v_max3_u32 v13, v88, v92, v96
    v_max_u32 v13, v13, v100
    v_cmp_eq_u32 vcc, -1, v13
    s_cbranch_vccnz L_a12_ss
L_a12_sr:
    v_mfma_f32_16x16x32_bf16 v[152:155], v[132:135], v[80:83], v[152:155]
    ds_read_b64_tr_b16 v[128:129], v2 offset:36864
    v_mfma_f32_16x16x32_bf16 v[156:159], v[132:135], v[84:87], v[156:159]
    ds_read_b64_tr_b16 v[130:131], v2 offset:37632
    v_mfma_f32_16x16x32_bf16 v[168:171], v[136:139], v[80:83], v[168:171]
    buffer_load_dwordx4 v[72:75], v4, s[16:19], s70 offen offset:768 sc1
    buffer_load_dwordx4 v[76:79], v4, s[16:19], s70 offen offset:2816 sc1
    ds_read_b64_tr_b16 v[132:133], v2 offset:36896
    v_mfma_f32_16x16x32_bf16 v[172:175], v[136:139], v[84:87], v[172:175]
    ds_read_b64_tr_b16 v[134:135], v2 offset:37664
    v_mfma_f32_16x16x32_bf16 v[184:187], v[140:143], v[80:83], v[184:187]
    ds_read_b64_tr_b16 v[136:137], v2 offset:36928
    v_mfma_f32_16x16x32_bf16 v[188:191], v[140:143], v[84:87], v[188:191]
    ds_read_b64_tr_b16 v[138:139], v2 offset:37696
    s_waitcnt lgkmcnt(6)
    v_mfma_f32_16x16x32_bf16 v[200:203], v[112:115], v[80:83], v[200:203]
    ds_read_b64_tr_b16 v[140:141], v24 offset:24576
    v_mfma_f32_16x16x32_bf16 v[204:207], v[112:115], v[84:87], v[204:207]
    ds_read_b64_tr_b16 v[142:143], v24 offset:25600
    v_mfma_f32_16x16x32_bf16 v[216:219], v[116:119], v[80:83], v[216:219]
    ds_read_b64_tr_b16 v[112:113], v25 offset:24576
    v_mfma_f32_16x16x32_bf16 v[220:223], v[116:119], v[84:87], v[220:223]
    ds_read_b64_tr_b16 v[114:115], v25 offset:25600
    v_mfma_f32_16x16x32_bf16 v[232:235], v[120:123], v[80:83], v[232:235]
    ds_read_b64_tr_b16 v[116:117], v26 offset:24576
    v_mfma_f32_16x16x32_bf16 v[236:239], v[120:123], v[84:87], v[236:239]
    ds_read_b64_tr_b16 v[118:119], v26 offset:25600
    v_mfma_f32_16x16x32_bf16 v[248:251], v[124:127], v[80:83], v[248:251]
    ds_read_b64_tr_b16 v[120:121], v27 offset:24576
    v_mov_b32 v16, 7
    v_mfma_f32_16x16x32_bf16 v[252:255], v[124:127], v[84:87], v[252:255]
    ds_read_b64_tr_b16 v[122:123], v27 offset:25600
    ds_write_b32 v14, v16
    s_waitcnt lgkmcnt(7)
    v_mfma_f32_16x16x32_bf16 v[144:147], v[128:131], v[88:91], v[144:147]
    ds_read_b64_tr_b16 v[124:125], v2 offset:39936
    v_mfma_f32_16x16x32_bf16 v[148:151], v[128:131], v[92:95], v[148:151]
    ds_read_b64_tr_b16 v[126:127], v2 offset:40704
    v_mfma_f32_16x16x32_bf16 v[160:163], v[132:135], v[88:91], v[160:163]
    buffer_load_dwordx4 v[80:83], v4, s[16:19], s68 offen offset:896 sc1
    buffer_load_dwordx4 v[84:87], v4, s[16:19], s68 offen offset:2944 sc1
    ds_read_b64_tr_b16 v[128:129], v2 offset:39968
    v_mfma_f32_16x16x32_bf16 v[164:167], v[132:135], v[92:95], v[164:167]
    ds_read_b64_tr_b16 v[130:131], v2 offset:40736
    v_mfma_f32_16x16x32_bf16 v[176:179], v[136:139], v[88:91], v[176:179]
    ds_read_b64_tr_b16 v[132:133], v2 offset:40000
    v_mfma_f32_16x16x32_bf16 v[180:183], v[136:139], v[92:95], v[180:183]
    ds_read_b64_tr_b16 v[134:135], v2 offset:40768
    v_mfma_f32_16x16x32_bf16 v[192:195], v[140:143], v[88:91], v[192:195]
    ds_read_b64_tr_b16 v[136:137], v24 offset:28672
    v_mfma_f32_16x16x32_bf16 v[196:199], v[140:143], v[92:95], v[196:199]
    ds_read_b64_tr_b16 v[138:139], v24 offset:29696
    s_waitcnt lgkmcnt(6)
    v_mfma_f32_16x16x32_bf16 v[208:211], v[112:115], v[88:91], v[208:211]
    buffer_load_dwordx4 v[28:31], v5, s[40:43], s25 offen offset:512 sc1
    buffer_load_dwordx4 v[32:35], v5, s[40:43], s25 offen offset:768 sc1
    ds_read_b64_tr_b16 v[140:141], v25 offset:28672
    v_mfma_f32_16x16x32_bf16 v[212:215], v[112:115], v[92:95], v[212:215]
    ds_read_b64_tr_b16 v[142:143], v25 offset:29696
    v_mfma_f32_16x16x32_bf16 v[224:227], v[116:119], v[88:91], v[224:227]
    ds_read_b64_tr_b16 v[112:113], v26 offset:28672
    ds_read_b128 v[20:23], v15
    v_mfma_f32_16x16x32_bf16 v[228:231], v[116:119], v[92:95], v[228:231]
    ds_read_b64_tr_b16 v[114:115], v26 offset:29696
    v_mfma_f32_16x16x32_bf16 v[240:243], v[120:123], v[88:91], v[240:243]
    ds_read_b64_tr_b16 v[116:117], v27 offset:28672
    v_mfma_f32_16x16x32_bf16 v[244:247], v[120:123], v[92:95], v[244:247]
    ds_read_b64_tr_b16 v[118:119], v27 offset:29696
    v_mfma_f32_16x16x32_bf16 v[152:155], v[124:127], v[88:91], v[152:155]
    ds_read_b64_tr_b16 v[120:121], v2 offset:43008
    v_mfma_f32_16x16x32_bf16 v[156:159], v[124:127], v[92:95], v[156:159]
    ds_read_b64_tr_b16 v[122:123], v2 offset:43776
    s_waitcnt lgkmcnt(7)
    v_mfma_f32_16x16x32_bf16 v[168:171], v[128:131], v[88:91], v[168:171]
    ds_read_b64_tr_b16 v[124:125], v2 offset:43040
    v_mfma_f32_16x16x32_bf16 v[172:175], v[128:131], v[92:95], v[172:175]
    ds_read_b64_tr_b16 v[126:127], v2 offset:43808
    v_mfma_f32_16x16x32_bf16 v[184:187], v[132:135], v[88:91], v[184:187]
    ds_read_b64_tr_b16 v[128:129], v2 offset:43072
    v_mfma_f32_16x16x32_bf16 v[188:191], v[132:135], v[92:95], v[188:191]
    ds_read_b64_tr_b16 v[130:131], v2 offset:43840
    s_waitcnt lgkmcnt(9)
    v_min3_u32 v20, v20, v21, v22
    v_min_u32 v20, v20, v23
    v_cmp_gt_u32 vcc, 9, v20
    v_mfma_f32_16x16x32_bf16 v[200:203], v[136:139], v[88:91], v[200:203]
    s_cbranch_vccnz L_ld9_ss
L_ld9_sr:
    ds_read_b64_tr_b16 v[132:133], v24 offset:33280
    v_mfma_f32_16x16x32_bf16 v[204:207], v[136:139], v[92:95], v[204:207]
    ds_read_b64_tr_b16 v[134:135], v24 offset:34304
    v_mfma_f32_16x16x32_bf16 v[216:219], v[140:143], v[88:91], v[216:219]
    ds_read_b64_tr_b16 v[136:137], v25 offset:33280
    v_mfma_f32_16x16x32_bf16 v[220:223], v[140:143], v[92:95], v[220:223]
    ds_read_b64_tr_b16 v[138:139], v25 offset:34304
    s_waitcnt lgkmcnt(6)
    v_mfma_f32_16x16x32_bf16 v[232:235], v[112:115], v[88:91], v[232:235]
    ds_read_b64_tr_b16 v[140:141], v26 offset:33280
    v_mfma_f32_16x16x32_bf16 v[236:239], v[112:115], v[92:95], v[236:239]
    ds_read_b64_tr_b16 v[142:143], v26 offset:34304
    s_waitcnt vmcnt(12)
    v_max3_u32 v13, v104, v108, v40
    v_max_u32 v13, v13, v44
    v_cmp_eq_u32 vcc, -1, v13
    s_cbranch_vccnz L_a16_ss
L_a16_sr:
    v_mfma_f32_16x16x32_bf16 v[248:251], v[116:119], v[88:91], v[248:251]
    ds_read_b64_tr_b16 v[112:113], v27 offset:33280
    v_mov_b32 v16, 8
    v_mfma_f32_16x16x32_bf16 v[252:255], v[116:119], v[92:95], v[252:255]
    ds_read_b64_tr_b16 v[114:115], v27 offset:34304
    ds_write_b32 v14, v16
    v_mfma_f32_16x16x32_bf16 v[144:147], v[120:123], v[96:99], v[144:147]
    ds_read_b64_tr_b16 v[116:117], v2 offset:46080
    v_mfma_f32_16x16x32_bf16 v[148:151], v[120:123], v[100:103], v[148:151]
    ds_read_b64_tr_b16 v[118:119], v2 offset:46848
    v_mfma_f32_16x16x32_bf16 v[160:163], v[124:127], v[96:99], v[160:163]
    buffer_load_dwordx4 v[88:91], v4, s[16:19], s70 offen offset:896 sc1
    buffer_load_dwordx4 v[92:95], v4, s[16:19], s70 offen offset:2944 sc1
    ds_read_b64_tr_b16 v[120:121], v2 offset:46112
    v_mfma_f32_16x16x32_bf16 v[164:167], v[124:127], v[100:103], v[164:167]
    ds_read_b64_tr_b16 v[122:123], v2 offset:46880
    s_waitcnt lgkmcnt(7)
    v_mfma_f32_16x16x32_bf16 v[176:179], v[128:131], v[96:99], v[176:179]
    ds_read_b64_tr_b16 v[124:125], v2 offset:46144
    v_mfma_f32_16x16x32_bf16 v[180:183], v[128:131], v[100:103], v[180:183]
    ds_read_b64_tr_b16 v[126:127], v2 offset:46912
    v_mfma_f32_16x16x32_bf16 v[192:195], v[132:135], v[96:99], v[192:195]
    ds_read_b64_tr_b16 v[128:129], v24 offset:37376
    v_mfma_f32_16x16x32_bf16 v[196:199], v[132:135], v[100:103], v[196:199]
    ds_read_b64_tr_b16 v[130:131], v24 offset:38400
    v_mfma_f32_16x16x32_bf16 v[208:211], v[136:139], v[96:99], v[208:211]
    ds_read_b64_tr_b16 v[132:133], v25 offset:37376
    v_mfma_f32_16x16x32_bf16 v[212:215], v[136:139], v[100:103], v[212:215]
    ds_read_b64_tr_b16 v[134:135], v25 offset:38400
    v_mfma_f32_16x16x32_bf16 v[224:227], v[140:143], v[96:99], v[224:227]
    ds_read_b64_tr_b16 v[136:137], v26 offset:37376
    v_mfma_f32_16x16x32_bf16 v[228:231], v[140:143], v[100:103], v[228:231]
    ds_read_b64_tr_b16 v[138:139], v26 offset:38400
    s_waitcnt vmcnt(10)
    v_max3_u32 v13, v48, v52, v56
    v_max_u32 v13, v13, v60
    v_cmp_eq_u32 vcc, -1, v13
    s_cbranch_vccnz L_a20_ss
L_a20_sr:
    s_waitcnt lgkmcnt(6)
    v_mfma_f32_16x16x32_bf16 v[240:243], v[112:115], v[96:99], v[240:243]
    ds_read_b64_tr_b16 v[140:141], v27 offset:37376
    v_mfma_f32_16x16x32_bf16 v[244:247], v[112:115], v[100:103], v[244:247]
    ds_read_b64_tr_b16 v[142:143], v27 offset:38400
    v_mfma_f32_16x16x32_bf16 v[152:155], v[116:119], v[96:99], v[152:155]
    ds_read_b64_tr_b16 v[112:113], v3 offset:0
    v_mfma_f32_16x16x32_bf16 v[156:159], v[116:119], v[100:103], v[156:159]
    ds_read_b64_tr_b16 v[114:115], v3 offset:768
    v_mfma_f32_16x16x32_bf16 v[168:171], v[120:123], v[96:99], v[168:171]
    ds_read_b64_tr_b16 v[116:117], v3 offset:32
    v_mfma_f32_16x16x32_bf16 v[172:175], v[120:123], v[100:103], v[172:175]
    ds_read_b64_tr_b16 v[118:119], v3 offset:800
    v_mfma_f32_16x16x32_bf16 v[184:187], v[124:127], v[96:99], v[184:187]
    ds_read_b64_tr_b16 v[120:121], v3 offset:64
    v_mfma_f32_16x16x32_bf16 v[188:191], v[124:127], v[100:103], v[188:191]
    ds_read_b64_tr_b16 v[122:123], v3 offset:832
    s_waitcnt lgkmcnt(6)
    v_mfma_f32_16x16x32_bf16 v[200:203], v[128:131], v[96:99], v[200:203]
    ds_read_b64_tr_b16 v[124:125], v24 offset:41472
    v_mfma_f32_16x16x32_bf16 v[204:207], v[128:131], v[100:103], v[204:207]
    ds_read_b64_tr_b16 v[126:127], v24 offset:42496
    v_mfma_f32_16x16x32_bf16 v[216:219], v[132:135], v[96:99], v[216:219]
    ds_read_b64_tr_b16 v[128:129], v25 offset:41472
    v_mfma_f32_16x16x32_bf16 v[220:223], v[132:135], v[100:103], v[220:223]
    ds_read_b64_tr_b16 v[130:131], v25 offset:42496
    v_mfma_f32_16x16x32_bf16 v[232:235], v[136:139], v[96:99], v[232:235]
    ds_read_b64_tr_b16 v[132:133], v26 offset:41472
    v_mfma_f32_16x16x32_bf16 v[236:239], v[136:139], v[100:103], v[236:239]
    ds_read_b64_tr_b16 v[134:135], v26 offset:42496
    s_waitcnt vmcnt(6)
    v_max3_u32 v13, v64, v68, v72
    v_max_u32 v13, v13, v76
    v_cmp_eq_u32 vcc, -1, v13
    s_cbranch_vccnz L_a24_ss
L_a24_sr:
    v_mfma_f32_16x16x32_bf16 v[248:251], v[140:143], v[96:99], v[248:251]
    ds_read_b64_tr_b16 v[136:137], v27 offset:41472
    v_mov_b32 v16, 9
    v_mfma_f32_16x16x32_bf16 v[252:255], v[140:143], v[100:103], v[252:255]
    ds_read_b64_tr_b16 v[138:139], v27 offset:42496
    ds_write_b32 v14, v16
    s_waitcnt lgkmcnt(7)
    v_mfma_f32_16x16x32_bf16 v[144:147], v[112:115], v[104:107], v[144:147]
    ds_read_b64_tr_b16 v[140:141], v3 offset:3072
    v_mfma_f32_16x16x32_bf16 v[148:151], v[112:115], v[108:111], v[148:151]
    ds_read_b64_tr_b16 v[142:143], v3 offset:3840
    s_waitcnt vmcnt(2)
    v_mfma_f32_16x16x32_bf16 v[160:163], v[116:119], v[104:107], v[160:163]
    ds_read_b64_tr_b16 v[112:113], v3 offset:3104
    v_max3_u32 v36, v28, v29, v30
    v_max3_u32 v36, v36, v31, v32
    v_max3_u32 v36, v36, v33, v34
    v_max_u32 v36, v36, v35
    v_cmp_eq_u32 vcc, -1, v36
    s_cbranch_vccnz L_st_ss
L_st_sr:
    v_mfma_f32_16x16x32_bf16 v[164:167], v[116:119], v[108:111], v[164:167]
    ds_read_b64_tr_b16 v[114:115], v3 offset:3872
    v_add_f32 v28, v28, v29
    v_mfma_f32_16x16x32_bf16 v[176:179], v[120:123], v[104:107], v[176:179]
    ds_read_b64_tr_b16 v[116:117], v3 offset:3136
    v_add_f32 v30, v30, v31
    v_mfma_f32_16x16x32_bf16 v[180:183], v[120:123], v[108:111], v[180:183]
    ds_read_b64_tr_b16 v[118:119], v3 offset:3904
    v_add_f32 v32, v32, v33
    v_mfma_f32_16x16x32_bf16 v[192:195], v[124:127], v[104:107], v[192:195]
    ds_read_b64_tr_b16 v[120:121], v24 offset:45568
    v_add_f32 v34, v34, v35
    v_mfma_f32_16x16x32_bf16 v[196:199], v[124:127], v[108:111], v[196:199]
    ds_read_b64_tr_b16 v[122:123], v24 offset:46592
    v_add_f32 v28, v28, v30
    s_waitcnt lgkmcnt(6)
    v_mfma_f32_16x16x32_bf16 v[208:211], v[128:131], v[104:107], v[208:211]
    ds_read_b64_tr_b16 v[124:125], v25 offset:45568
    v_add_f32 v32, v32, v34
    v_mfma_f32_16x16x32_bf16 v[212:215], v[128:131], v[108:111], v[212:215]
    ds_read_b64_tr_b16 v[126:127], v25 offset:46592
    v_permlane16_swap_b32 v28, v32
    v_mfma_f32_16x16x32_bf16 v[224:227], v[132:135], v[104:107], v[224:227]
    ds_read_b64_tr_b16 v[128:129], v26 offset:45568
    v_add_f32 v28, v28, v32
    v_mfma_f32_16x16x32_bf16 v[228:231], v[132:135], v[108:111], v[228:231]
    ds_read_b64_tr_b16 v[130:131], v26 offset:46592
    v_mov_b32 v32, v28
    v_mfma_f32_16x16x32_bf16 v[240:243], v[136:139], v[104:107], v[240:243]
    ds_read_b64_tr_b16 v[132:133], v27 offset:45568
    v_mov_b32 v30, 0x3727c5ac
    v_mfma_f32_16x16x32_bf16 v[244:247], v[136:139], v[108:111], v[244:247]
    ds_read_b64_tr_b16 v[134:135], v27 offset:46592
    v_permlane32_swap_b32 v28, v32
    v_mfma_f32_16x16x32_bf16 v[152:155], v[140:143], v[104:107], v[152:155]
    ds_read_b64_tr_b16 v[136:137], v3 offset:6144
    v_add_f32 v28, v28, v32
    v_mfma_f32_16x16x32_bf16 v[156:159], v[140:143], v[108:111], v[156:159]
    ds_read_b64_tr_b16 v[138:139], v3 offset:6912
    v_fmac_f32 v30, 0x3b000000, v28
    s_waitcnt lgkmcnt(6)
    v_mfma_f32_16x16x32_bf16 v[168:171], v[112:115], v[104:107], v[168:171]
    ds_read_b64_tr_b16 v[140:141], v3 offset:12288
    v_rsq_f32 v31, v30
    v_mfma_f32_16x16x32_bf16 v[172:175], v[112:115], v[108:111], v[172:175]
    ds_read_b64_tr_b16 v[142:143], v3 offset:13056
    v_sqrt_f32 v17, v30
    v_mfma_f32_16x16x32_bf16 v[184:187], v[116:119], v[104:107], v[184:187]
    ds_read_b64_tr_b16 v[112:113], v3 offset:18432
    v_sqrt_f32 v18, v30
    v_mfma_f32_16x16x32_bf16 v[188:191], v[116:119], v[108:111], v[188:191]
    ds_read_b64_tr_b16 v[114:115], v3 offset:19200
    v_mul_f32 v8, 0xbfb8aa3b, v31
    v_mfma_f32_16x16x32_bf16 v[200:203], v[120:123], v[104:107], v[200:203]
    ds_read_b64_tr_b16 v[116:117], v3 offset:24576
    v_mul_f32 v9, 0xbfb8aa3b, v31
    v_mfma_f32_16x16x32_bf16 v[204:207], v[120:123], v[108:111], v[204:207]
    ds_read_b64_tr_b16 v[118:119], v3 offset:25344
    v_permlane16_swap_b32 v17, v18
    v_mfma_f32_16x16x32_bf16 v[216:219], v[124:127], v[104:107], v[216:219]
    ds_read_b64_tr_b16 v[120:121], v3 offset:30720
    v_permlane16_swap_b32 v8, v9
    v_mfma_f32_16x16x32_bf16 v[220:223], v[124:127], v[108:111], v[220:223]
    ds_read_b64_tr_b16 v[122:123], v3 offset:31488
    s_waitcnt lgkmcnt(6)
    v_mfma_f32_16x16x32_bf16 v[232:235], v[128:131], v[104:107], v[232:235]
    ds_read_b64_tr_b16 v[124:125], v3 offset:36864
    v_mfma_f32_16x16x32_bf16 v[236:239], v[128:131], v[108:111], v[236:239]
    ds_read_b64_tr_b16 v[126:127], v3 offset:37632
    s_waitcnt vmcnt(0)
    v_max3_u32 v13, v80, v84, v88
    v_max_u32 v13, v13, v92
    v_cmp_eq_u32 vcc, -1, v13
    s_cbranch_vccnz L_a28_ss
L_a28_sr:
    v_mfma_f32_16x16x32_bf16 v[248:251], v[132:135], v[104:107], v[248:251]
    ds_read_b64_tr_b16 v[128:129], v3 offset:43008
    v_mfma_f32_16x16x32_bf16 v[252:255], v[132:135], v[108:111], v[252:255]
    ds_read_b64_tr_b16 v[130:131], v3 offset:43776
    v_mfma_f32_16x16x32_bf16 v[144:147], v[136:139], v[40:43], v[144:147]
    ds_read_b64_tr_b16 v[132:133], v3 offset:9216
    v_mfma_f32_16x16x32_bf16 v[148:151], v[136:139], v[44:47], v[148:151]
    ds_read_b64_tr_b16 v[134:135], v3 offset:9984
    v_mfma_f32_16x16x32_bf16 v[144:147], v[140:143], v[48:51], v[144:147]
    ds_read_b64_tr_b16 v[136:137], v3 offset:15360
    v_mfma_f32_16x16x32_bf16 v[148:151], v[140:143], v[52:55], v[148:151]
    ds_read_b64_tr_b16 v[138:139], v3 offset:16128
    s_waitcnt lgkmcnt(6)
    v_mfma_f32_16x16x32_bf16 v[144:147], v[112:115], v[56:59], v[144:147]
    ds_read_b64_tr_b16 v[140:141], v3 offset:21504
    v_mfma_f32_16x16x32_bf16 v[148:151], v[112:115], v[60:63], v[148:151]
    ds_read_b64_tr_b16 v[142:143], v3 offset:22272
    v_mfma_f32_16x16x32_bf16 v[144:147], v[116:119], v[64:67], v[144:147]
    ds_read_b64_tr_b16 v[112:113], v3 offset:27648
    v_mfma_f32_16x16x32_bf16 v[148:151], v[116:119], v[68:71], v[148:151]
    ds_read_b64_tr_b16 v[114:115], v3 offset:28416
    v_mfma_f32_16x16x32_bf16 v[144:147], v[120:123], v[72:75], v[144:147]
    ds_read_b64_tr_b16 v[116:117], v3 offset:33792
    v_mfma_f32_16x16x32_bf16 v[148:151], v[120:123], v[76:79], v[148:151]
    ds_read_b64_tr_b16 v[118:119], v3 offset:34560
    v_mfma_f32_16x16x32_bf16 v[144:147], v[124:127], v[80:83], v[144:147]
    ds_read_b64_tr_b16 v[120:121], v3 offset:39936
    v_mfma_f32_16x16x32_bf16 v[148:151], v[124:127], v[84:87], v[148:151]
    ds_read_b64_tr_b16 v[122:123], v3 offset:40704
    s_waitcnt lgkmcnt(6)
    v_mfma_f32_16x16x32_bf16 v[144:147], v[128:131], v[88:91], v[144:147]
    ds_read_b64_tr_b16 v[124:125], v3 offset:46080
    v_mfma_f32_16x16x32_bf16 v[148:151], v[128:131], v[92:95], v[148:151]
    ds_read_b64_tr_b16 v[126:127], v3 offset:46848
    v_mfma_f32_16x16x32_bf16 v[152:155], v[132:135], v[40:43], v[152:155]
    ds_read_b64_tr_b16 v[128:129], v3 offset:6176
    v_mfma_f32_16x16x32_bf16 v[156:159], v[132:135], v[44:47], v[156:159]
    ds_read_b64_tr_b16 v[130:131], v3 offset:6944
    v_mfma_f32_16x16x32_bf16 v[152:155], v[136:139], v[48:51], v[152:155]
    ds_read_b64_tr_b16 v[132:133], v3 offset:12320
    v_mfma_f32_16x16x32_bf16 v[156:159], v[136:139], v[52:55], v[156:159]
    ds_read_b64_tr_b16 v[134:135], v3 offset:13088
    v_mul_f32 v144, v8, v144
    v_mul_f32 v145, v8, v145
    v_mul_f32 v146, v8, v146
    v_mfma_f32_16x16x32_bf16 v[152:155], v[140:143], v[56:59], v[152:155]
    ds_read_b64_tr_b16 v[136:137], v3 offset:18464
    v_mul_f32 v147, v8, v147
    v_mul_f32 v148, v9, v148
    v_mfma_f32_16x16x32_bf16 v[156:159], v[140:143], v[60:63], v[156:159]
    ds_read_b64_tr_b16 v[138:139], v3 offset:19232
    v_mul_f32 v149, v9, v149
    v_mul_f32 v150, v9, v150
    v_mul_f32 v151, v9, v151
    s_waitcnt lgkmcnt(6)
    v_mfma_f32_16x16x32_bf16 v[152:155], v[112:115], v[64:67], v[152:155]
    ds_read_b64_tr_b16 v[140:141], v3 offset:24608
    v_exp_f32 v144, v144
    v_mfma_f32_16x16x32_bf16 v[156:159], v[112:115], v[68:71], v[156:159]
    ds_read_b64_tr_b16 v[142:143], v3 offset:25376
    v_exp_f32 v145, v145
    v_mfma_f32_16x16x32_bf16 v[152:155], v[116:119], v[72:75], v[152:155]
    ds_read_b64_tr_b16 v[112:113], v3 offset:30752
    v_exp_f32 v146, v146
    v_exp_f32 v147, v147
    v_mfma_f32_16x16x32_bf16 v[156:159], v[116:119], v[76:79], v[156:159]
    ds_read_b64_tr_b16 v[114:115], v3 offset:31520
    v_exp_f32 v148, v148
    v_mfma_f32_16x16x32_bf16 v[152:155], v[120:123], v[80:83], v[152:155]
    ds_read_b64_tr_b16 v[116:117], v3 offset:36896
    v_exp_f32 v149, v149
    v_mfma_f32_16x16x32_bf16 v[156:159], v[120:123], v[84:87], v[156:159]
    ds_read_b64_tr_b16 v[118:119], v3 offset:37664
    v_exp_f32 v150, v150
    v_mfma_f32_16x16x32_bf16 v[152:155], v[124:127], v[88:91], v[152:155]
    ds_read_b64_tr_b16 v[120:121], v3 offset:43040
    v_exp_f32 v151, v151
    v_mfma_f32_16x16x32_bf16 v[156:159], v[124:127], v[92:95], v[156:159]
    ds_read_b64_tr_b16 v[122:123], v3 offset:43808
    v_fma_f32 v144, v144, v17, v17
    v_fma_f32 v145, v145, v17, v17
    v_fma_f32 v146, v146, v17, v17
    s_waitcnt lgkmcnt(6)
    v_mfma_f32_16x16x32_bf16 v[160:163], v[128:131], v[40:43], v[160:163]
    ds_read_b64_tr_b16 v[124:125], v3 offset:9248
    v_fma_f32 v147, v147, v17, v17
    v_fma_f32 v148, v148, v18, v18
    v_mfma_f32_16x16x32_bf16 v[164:167], v[128:131], v[44:47], v[164:167]
    ds_read_b64_tr_b16 v[126:127], v3 offset:10016
    v_fma_f32 v149, v149, v18, v18
    v_fma_f32 v150, v150, v18, v18
    v_mfma_f32_16x16x32_bf16 v[160:163], v[132:135], v[48:51], v[160:163]
    ds_read_b64_tr_b16 v[128:129], v3 offset:15392
    v_fma_f32 v151, v151, v18, v18
    v_rcp_f32 v144, v144
    v_mfma_f32_16x16x32_bf16 v[164:167], v[132:135], v[52:55], v[164:167]
    ds_read_b64_tr_b16 v[130:131], v3 offset:16160
    v_rcp_f32 v145, v145
    v_mfma_f32_16x16x32_bf16 v[160:163], v[136:139], v[56:59], v[160:163]
    ds_read_b64_tr_b16 v[132:133], v3 offset:21536
    v_rcp_f32 v146, v146
    v_rcp_f32 v147, v147
    v_mfma_f32_16x16x32_bf16 v[164:167], v[136:139], v[60:63], v[164:167]
    ds_read_b64_tr_b16 v[134:135], v3 offset:22304
    v_rcp_f32 v148, v148
    v_mfma_f32_16x16x32_bf16 v[160:163], v[140:143], v[64:67], v[160:163]
    ds_read_b64_tr_b16 v[136:137], v3 offset:27680
    v_rcp_f32 v149, v149
    v_mfma_f32_16x16x32_bf16 v[164:167], v[140:143], v[68:71], v[164:167]
    ds_read_b64_tr_b16 v[138:139], v3 offset:28448
    v_rcp_f32 v150, v150
    s_waitcnt lgkmcnt(6)
    v_mfma_f32_16x16x32_bf16 v[160:163], v[112:115], v[72:75], v[160:163]
    ds_read_b64_tr_b16 v[140:141], v3 offset:33824
    v_rcp_f32 v151, v151
    v_mfma_f32_16x16x32_bf16 v[164:167], v[112:115], v[76:79], v[164:167]
    ds_read_b64_tr_b16 v[142:143], v3 offset:34592
    v_mul_f32 v144, v144, v152
    v_mul_f32 v145, v145, v153
    v_mul_f32 v146, v146, v154
    v_mfma_f32_16x16x32_bf16 v[160:163], v[116:119], v[80:83], v[160:163]
    ds_read_b64_tr_b16 v[112:113], v3 offset:39968
    v_mul_f32 v147, v147, v155
    v_mul_f32 v148, v148, v156
    v_mfma_f32_16x16x32_bf16 v[164:167], v[116:119], v[84:87], v[164:167]
    ds_read_b64_tr_b16 v[114:115], v3 offset:40736
    v_mul_f32 v149, v149, v157
    v_mul_f32 v150, v150, v158
    v_mfma_f32_16x16x32_bf16 v[160:163], v[120:123], v[88:91], v[160:163]
    ds_read_b64_tr_b16 v[116:117], v3 offset:46112
    v_mul_f32 v151, v151, v159
    v_cvt_pk_bf16_f32 v152, v144, v145
    v_cvt_pk_bf16_f32 v154, v148, v149
    v_mfma_f32_16x16x32_bf16 v[164:167], v[120:123], v[92:95], v[164:167]
    ds_read_b64_tr_b16 v[118:119], v3 offset:46880
    v_cvt_pk_bf16_f32 v153, v146, v147
    v_cvt_pk_bf16_f32 v155, v150, v151
    v_mfma_f32_16x16x32_bf16 v[168:171], v[124:127], v[40:43], v[168:171]
    ds_read_b64_tr_b16 v[120:121], v3 offset:6208
    v_permlane32_swap_b32 v152, v154
    s_nop 0
    v_permlane32_swap_b32 v153, v155
    v_mfma_f32_16x16x32_bf16 v[172:175], v[124:127], v[44:47], v[172:175]
    buffer_store_dwordx4 v[152:155], v6, s[40:43], s26 offen offset:0 sc1
    ds_read_b64_tr_b16 v[122:123], v3 offset:6976
    s_waitcnt lgkmcnt(6)
    v_mfma_f32_16x16x32_bf16 v[168:171], v[128:131], v[48:51], v[168:171]
    ds_read_b64_tr_b16 v[124:125], v3 offset:12352
    v_mfma_f32_16x16x32_bf16 v[172:175], v[128:131], v[52:55], v[172:175]
    ds_read_b64_tr_b16 v[126:127], v3 offset:13120
    v_mul_f32 v160, v8, v160
    v_mul_f32 v161, v8, v161
    v_mul_f32 v162, v8, v162
    v_mfma_f32_16x16x32_bf16 v[168:171], v[132:135], v[56:59], v[168:171]
    ds_read_b64_tr_b16 v[128:129], v3 offset:18496
    v_mul_f32 v163, v8, v163
    v_mul_f32 v164, v9, v164
    v_mfma_f32_16x16x32_bf16 v[172:175], v[132:135], v[60:63], v[172:175]
    ds_read_b64_tr_b16 v[130:131], v3 offset:19264
    v_mul_f32 v165, v9, v165
    v_mul_f32 v166, v9, v166
    v_mul_f32 v167, v9, v167
    v_mfma_f32_16x16x32_bf16 v[168:171], v[136:139], v[64:67], v[168:171]
    ds_read_b64_tr_b16 v[132:133], v3 offset:24640
    v_exp_f32 v160, v160
    v_mfma_f32_16x16x32_bf16 v[172:175], v[136:139], v[68:71], v[172:175]
    ds_read_b64_tr_b16 v[134:135], v3 offset:25408
    v_exp_f32 v161, v161
    v_mfma_f32_16x16x32_bf16 v[168:171], v[140:143], v[72:75], v[168:171]
    ds_read_b64_tr_b16 v[136:137], v3 offset:30784
    v_exp_f32 v162, v162
    v_exp_f32 v163, v163
    v_mfma_f32_16x16x32_bf16 v[172:175], v[140:143], v[76:79], v[172:175]
    ds_read_b64_tr_b16 v[138:139], v3 offset:31552
    v_exp_f32 v164, v164
    s_waitcnt lgkmcnt(6)
    v_mfma_f32_16x16x32_bf16 v[168:171], v[112:115], v[80:83], v[168:171]
    ds_read_b64_tr_b16 v[140:141], v3 offset:36928
    v_exp_f32 v165, v165
    v_mfma_f32_16x16x32_bf16 v[172:175], v[112:115], v[84:87], v[172:175]
    ds_read_b64_tr_b16 v[142:143], v3 offset:37696
    v_exp_f32 v166, v166
    v_mfma_f32_16x16x32_bf16 v[168:171], v[116:119], v[88:91], v[168:171]
    ds_read_b64_tr_b16 v[112:113], v3 offset:43072
    v_exp_f32 v167, v167
    v_mfma_f32_16x16x32_bf16 v[172:175], v[116:119], v[92:95], v[172:175]
    ds_read_b64_tr_b16 v[114:115], v3 offset:43840
    v_fma_f32 v160, v160, v17, v17
    v_fma_f32 v161, v161, v17, v17
    v_fma_f32 v162, v162, v17, v17
    v_mfma_f32_16x16x32_bf16 v[176:179], v[120:123], v[40:43], v[176:179]
    ds_read_b64_tr_b16 v[116:117], v3 offset:9280
    v_fma_f32 v163, v163, v17, v17
    v_fma_f32 v164, v164, v18, v18
    v_mfma_f32_16x16x32_bf16 v[180:183], v[120:123], v[44:47], v[180:183]
    ds_read_b64_tr_b16 v[118:119], v3 offset:10048
    v_fma_f32 v165, v165, v18, v18
    v_fma_f32 v166, v166, v18, v18
    v_mfma_f32_16x16x32_bf16 v[176:179], v[124:127], v[48:51], v[176:179]
    ds_read_b64_tr_b16 v[120:121], v3 offset:15424
    v_fma_f32 v167, v167, v18, v18
    v_rcp_f32 v160, v160
    v_mfma_f32_16x16x32_bf16 v[180:183], v[124:127], v[52:55], v[180:183]
    ds_read_b64_tr_b16 v[122:123], v3 offset:16192
    v_rcp_f32 v161, v161
    s_waitcnt lgkmcnt(6)
    v_mfma_f32_16x16x32_bf16 v[176:179], v[128:131], v[56:59], v[176:179]
    ds_read_b64_tr_b16 v[124:125], v3 offset:21568
    ds_read_b128 v[20:23], v15
    v_rcp_f32 v162, v162
    v_rcp_f32 v163, v163
    v_mfma_f32_16x16x32_bf16 v[180:183], v[128:131], v[60:63], v[180:183]
    ds_read_b64_tr_b16 v[126:127], v3 offset:22336
    v_rcp_f32 v164, v164
    v_mfma_f32_16x16x32_bf16 v[176:179], v[132:135], v[64:67], v[176:179]
    ds_read_b64_tr_b16 v[128:129], v3 offset:27712
    v_rcp_f32 v165, v165
    v_mfma_f32_16x16x32_bf16 v[180:183], v[132:135], v[68:71], v[180:183]
    ds_read_b64_tr_b16 v[130:131], v3 offset:28480
    v_rcp_f32 v166, v166
    v_mfma_f32_16x16x32_bf16 v[176:179], v[136:139], v[72:75], v[176:179]
    ds_read_b64_tr_b16 v[132:133], v3 offset:33856
    v_rcp_f32 v167, v167
    v_mfma_f32_16x16x32_bf16 v[180:183], v[136:139], v[76:79], v[180:183]
    ds_read_b64_tr_b16 v[134:135], v3 offset:34624
    v_mul_f32 v160, v160, v168
    v_mul_f32 v161, v161, v169
    v_mul_f32 v162, v162, v170
    v_mfma_f32_16x16x32_bf16 v[176:179], v[140:143], v[80:83], v[176:179]
    ds_read_b64_tr_b16 v[136:137], v3 offset:40000
    v_mul_f32 v163, v163, v171
    v_mul_f32 v164, v164, v172
    v_mfma_f32_16x16x32_bf16 v[180:183], v[140:143], v[84:87], v[180:183]
    ds_read_b64_tr_b16 v[138:139], v3 offset:40768
    v_mul_f32 v165, v165, v173
    v_mul_f32 v166, v166, v174
    s_waitcnt lgkmcnt(6)
    v_mfma_f32_16x16x32_bf16 v[176:179], v[112:115], v[88:91], v[176:179]
    ds_read_b64_tr_b16 v[140:141], v3 offset:46144
    v_mul_f32 v167, v167, v175
    v_cvt_pk_bf16_f32 v168, v160, v161
    v_cvt_pk_bf16_f32 v170, v164, v165
    v_mfma_f32_16x16x32_bf16 v[180:183], v[112:115], v[92:95], v[180:183]
    ds_read_b64_tr_b16 v[142:143], v3 offset:46912
    v_min3_u32 v20, v20, v21, v22
    v_min_u32 v20, v20, v23
    v_cmp_gt_u32 vcc, 16, v20
    v_cvt_pk_bf16_f32 v169, v162, v163
    v_cvt_pk_bf16_f32 v171, v166, v167
    v_mfma_f32_16x16x32_bf16 v[184:187], v[116:119], v[40:43], v[184:187]
    s_cbranch_vccnz L_ld16_ss
L_ld16_sr:
    ds_read_b64_tr_b16 v[112:113], v24 offset:57856
    v_permlane32_swap_b32 v168, v170
    s_nop 0
    v_permlane32_swap_b32 v169, v171
    v_mfma_f32_16x16x32_bf16 v[188:191], v[116:119], v[44:47], v[188:191]
    buffer_store_dwordx4 v[168:171], v6, s[40:43], s26 offen offset:1024 sc1
    ds_read_b64_tr_b16 v[114:115], v24 offset:58880
    v_mfma_f32_16x16x32_bf16 v[184:187], v[120:123], v[48:51], v[184:187]
    ds_read_b64_tr_b16 v[116:117], v24 offset:49664
    v_mfma_f32_16x16x32_bf16 v[188:191], v[120:123], v[52:55], v[188:191]
    ds_read_b64_tr_b16 v[118:119], v24 offset:50688
    v_mul_f32 v176, v8, v176
    v_mul_f32 v177, v8, v177
    v_mul_f32 v178, v8, v178
    v_mfma_f32_16x16x32_bf16 v[184:187], v[124:127], v[56:59], v[184:187]
    ds_read_b64_tr_b16 v[120:121], v24 offset:0
    v_mul_f32 v179, v8, v179
    v_mul_f32 v180, v9, v180
    v_mfma_f32_16x16x32_bf16 v[188:191], v[124:127], v[60:63], v[188:191]
    ds_read_b64_tr_b16 v[122:123], v24 offset:1024
    v_mul_f32 v181, v9, v181
    v_mul_f32 v182, v9, v182
    v_mul_f32 v183, v9, v183
    s_waitcnt lgkmcnt(6)
    v_mfma_f32_16x16x32_bf16 v[184:187], v[128:131], v[64:67], v[184:187]
    ds_read_b64_tr_b16 v[124:125], v24 offset:8192
    v_exp_f32 v176, v176
    v_mfma_f32_16x16x32_bf16 v[188:191], v[128:131], v[68:71], v[188:191]
    ds_read_b64_tr_b16 v[126:127], v24 offset:9216
    v_exp_f32 v177, v177
    v_mfma_f32_16x16x32_bf16 v[184:187], v[132:135], v[72:75], v[184:187]
    ds_read_b64_tr_b16 v[128:129], v24 offset:16384
    v_exp_f32 v178, v178
    v_exp_f32 v179, v179
    v_mfma_f32_16x16x32_bf16 v[188:191], v[132:135], v[76:79], v[188:191]
    ds_read_b64_tr_b16 v[130:131], v24 offset:17408
    v_exp_f32 v180, v180
    v_mfma_f32_16x16x32_bf16 v[184:187], v[136:139], v[80:83], v[184:187]
    ds_read_b64_tr_b16 v[132:133], v24 offset:24576
    v_exp_f32 v181, v181
    v_mfma_f32_16x16x32_bf16 v[188:191], v[136:139], v[84:87], v[188:191]
    ds_read_b64_tr_b16 v[134:135], v24 offset:25600
    v_exp_f32 v182, v182
    v_mfma_f32_16x16x32_bf16 v[184:187], v[140:143], v[88:91], v[184:187]
    ds_read_b64_tr_b16 v[136:137], v24 offset:33280
    v_mov_b32 v16, 20
    v_exp_f32 v183, v183
    v_mfma_f32_16x16x32_bf16 v[188:191], v[140:143], v[92:95], v[188:191]
    ds_read_b64_tr_b16 v[138:139], v24 offset:34304
    ds_write_b32 v14, v16
    v_fma_f32 v176, v176, v17, v17
    v_fma_f32 v177, v177, v17, v17
    v_fma_f32 v178, v178, v17, v17
    s_waitcnt lgkmcnt(7)
    v_mfma_f32_16x16x32_bf16 v[192:195], v[112:115], v[40:43], v[192:195]
    ds_read_b64_tr_b16 v[140:141], v24 offset:61952
    v_fma_f32 v179, v179, v17, v17
    v_fma_f32 v180, v180, v18, v18
    v_mfma_f32_16x16x32_bf16 v[196:199], v[112:115], v[44:47], v[196:199]
    ds_read_b64_tr_b16 v[142:143], v24 offset:62976
    v_fma_f32 v181, v181, v18, v18
    v_fma_f32 v182, v182, v18, v18
    v_mfma_f32_16x16x32_bf16 v[192:195], v[116:119], v[48:51], v[192:195]
    ds_read_b64_tr_b16 v[112:113], v24 offset:53760
    v_fma_f32 v183, v183, v18, v18
    v_rcp_f32 v176, v176
    v_mfma_f32_16x16x32_bf16 v[196:199], v[116:119], v[52:55], v[196:199]
    ds_read_b64_tr_b16 v[114:115], v24 offset:54784
    v_rcp_f32 v177, v177
    v_mfma_f32_16x16x32_bf16 v[192:195], v[120:123], v[56:59], v[192:195]
    ds_read_b64_tr_b16 v[116:117], v24 offset:4096
    v_rcp_f32 v178, v178
    v_rcp_f32 v179, v179
    v_mfma_f32_16x16x32_bf16 v[196:199], v[120:123], v[60:63], v[196:199]
    ds_read_b64_tr_b16 v[118:119], v24 offset:5120
    v_rcp_f32 v180, v180
    v_mfma_f32_16x16x32_bf16 v[192:195], v[124:127], v[64:67], v[192:195]
    ds_read_b64_tr_b16 v[120:121], v24 offset:12288
    v_rcp_f32 v181, v181
    v_mfma_f32_16x16x32_bf16 v[196:199], v[124:127], v[68:71], v[196:199]
    ds_read_b64_tr_b16 v[122:123], v24 offset:13312
    v_rcp_f32 v182, v182
    s_waitcnt lgkmcnt(6)
    v_mfma_f32_16x16x32_bf16 v[192:195], v[128:131], v[72:75], v[192:195]
    ds_read_b64_tr_b16 v[124:125], v24 offset:20480
    v_rcp_f32 v183, v183
    v_mfma_f32_16x16x32_bf16 v[196:199], v[128:131], v[76:79], v[196:199]
    ds_read_b64_tr_b16 v[126:127], v24 offset:21504
    v_mul_f32 v176, v176, v184
    v_mul_f32 v177, v177, v185
    v_mul_f32 v178, v178, v186
    v_mfma_f32_16x16x32_bf16 v[192:195], v[132:135], v[80:83], v[192:195]
    ds_read_b64_tr_b16 v[128:129], v24 offset:28672
    v_mul_f32 v179, v179, v187
    v_mul_f32 v180, v180, v188
    v_mfma_f32_16x16x32_bf16 v[196:199], v[132:135], v[84:87], v[196:199]
    ds_read_b64_tr_b16 v[130:131], v24 offset:29696
    v_mul_f32 v181, v181, v189
    v_mul_f32 v182, v182, v190
    v_mfma_f32_16x16x32_bf16 v[192:195], v[136:139], v[88:91], v[192:195]
    ds_read_b64_tr_b16 v[132:133], v24 offset:37376
    v_mul_f32 v183, v183, v191
    v_cvt_pk_bf16_f32 v184, v176, v177
    v_cvt_pk_bf16_f32 v186, v180, v181
    v_mfma_f32_16x16x32_bf16 v[196:199], v[136:139], v[92:95], v[196:199]
    ds_read_b64_tr_b16 v[134:135], v24 offset:38400
    v_cvt_pk_bf16_f32 v185, v178, v179
    v_cvt_pk_bf16_f32 v187, v182, v183
    v_mfma_f32_16x16x32_bf16 v[200:203], v[140:143], v[40:43], v[200:203]
    ds_read_b64_tr_b16 v[136:137], v25 offset:57856
    v_permlane32_swap_b32 v184, v186
    s_nop 0
    v_permlane32_swap_b32 v185, v187
    v_mfma_f32_16x16x32_bf16 v[204:207], v[140:143], v[44:47], v[204:207]
    buffer_store_dwordx4 v[184:187], v6, s[40:43], s26 offen offset:2048 sc1
    ds_read_b64_tr_b16 v[138:139], v25 offset:58880
    s_waitcnt lgkmcnt(6)
    v_mfma_f32_16x16x32_bf16 v[200:203], v[112:115], v[48:51], v[200:203]
    ds_read_b64_tr_b16 v[140:141], v25 offset:49664
    v_mfma_f32_16x16x32_bf16 v[204:207], v[112:115], v[52:55], v[204:207]
    ds_read_b64_tr_b16 v[142:143], v25 offset:50688
    v_mul_f32 v192, v8, v192
    v_mul_f32 v193, v8, v193
    v_mul_f32 v194, v8, v194
    v_mfma_f32_16x16x32_bf16 v[200:203], v[116:119], v[56:59], v[200:203]
    ds_read_b64_tr_b16 v[112:113], v25 offset:0
    v_mul_f32 v195, v8, v195
    v_mul_f32 v196, v9, v196
    v_mfma_f32_16x16x32_bf16 v[204:207], v[116:119], v[60:63], v[204:207]
    v_add_u32 v11, 1, v11
    s_waitcnt vmcnt(1)
    buffer_store_dword v11, v10, s[40:43], s24 offen sc1
    ds_read_b64_tr_b16 v[114:115], v25 offset:1024
    v_mul_f32 v197, v9, v197
    v_mul_f32 v198, v9, v198
    v_mul_f32 v199, v9, v199
    v_mfma_f32_16x16x32_bf16 v[200:203], v[120:123], v[64:67], v[200:203]
    ds_read_b64_tr_b16 v[116:117], v25 offset:8192
    v_exp_f32 v192, v192
    v_mfma_f32_16x16x32_bf16 v[204:207], v[120:123], v[68:71], v[204:207]
    ds_read_b64_tr_b16 v[118:119], v25 offset:9216
    v_exp_f32 v193, v193
    v_mfma_f32_16x16x32_bf16 v[200:203], v[124:127], v[72:75], v[200:203]
    ds_read_b64_tr_b16 v[120:121], v25 offset:16384
    v_exp_f32 v194, v194
    v_exp_f32 v195, v195
    v_mfma_f32_16x16x32_bf16 v[204:207], v[124:127], v[76:79], v[204:207]
    ds_read_b64_tr_b16 v[122:123], v25 offset:17408
    v_exp_f32 v196, v196
    s_waitcnt lgkmcnt(6)
    v_mfma_f32_16x16x32_bf16 v[200:203], v[128:131], v[80:83], v[200:203]
    ds_read_b64_tr_b16 v[124:125], v25 offset:24576
    v_exp_f32 v197, v197
    v_mfma_f32_16x16x32_bf16 v[204:207], v[128:131], v[84:87], v[204:207]
    ds_read_b64_tr_b16 v[126:127], v25 offset:25600
    v_exp_f32 v198, v198
    v_mfma_f32_16x16x32_bf16 v[200:203], v[132:135], v[88:91], v[200:203]
    ds_read_b64_tr_b16 v[128:129], v25 offset:33280
    v_exp_f32 v199, v199
    v_mfma_f32_16x16x32_bf16 v[204:207], v[132:135], v[92:95], v[204:207]
    ds_read_b64_tr_b16 v[130:131], v25 offset:34304
    v_fma_f32 v192, v192, v17, v17
    v_fma_f32 v193, v193, v17, v17
    v_fma_f32 v194, v194, v17, v17
    v_mfma_f32_16x16x32_bf16 v[208:211], v[136:139], v[40:43], v[208:211]
    ds_read_b64_tr_b16 v[132:133], v25 offset:61952
    v_fma_f32 v195, v195, v17, v17
    v_fma_f32 v196, v196, v18, v18
    v_mfma_f32_16x16x32_bf16 v[212:215], v[136:139], v[44:47], v[212:215]
    ds_read_b64_tr_b16 v[134:135], v25 offset:62976
    v_fma_f32 v197, v197, v18, v18
    v_fma_f32 v198, v198, v18, v18
    v_mfma_f32_16x16x32_bf16 v[208:211], v[140:143], v[48:51], v[208:211]
    ds_read_b64_tr_b16 v[136:137], v25 offset:53760
    v_fma_f32 v199, v199, v18, v18
    v_rcp_f32 v192, v192
    v_mfma_f32_16x16x32_bf16 v[212:215], v[140:143], v[52:55], v[212:215]
    ds_read_b64_tr_b16 v[138:139], v25 offset:54784
    v_rcp_f32 v193, v193
    s_waitcnt lgkmcnt(6)
    v_mfma_f32_16x16x32_bf16 v[208:211], v[112:115], v[56:59], v[208:211]
    ds_read_b64_tr_b16 v[140:141], v25 offset:4096
    v_rcp_f32 v194, v194
    v_rcp_f32 v195, v195
    v_mfma_f32_16x16x32_bf16 v[212:215], v[112:115], v[60:63], v[212:215]
    ds_read_b64_tr_b16 v[142:143], v25 offset:5120
    v_rcp_f32 v196, v196
    v_mfma_f32_16x16x32_bf16 v[208:211], v[116:119], v[64:67], v[208:211]
    ds_read_b64_tr_b16 v[112:113], v25 offset:12288
    v_rcp_f32 v197, v197
    v_mfma_f32_16x16x32_bf16 v[212:215], v[116:119], v[68:71], v[212:215]
    ds_read_b64_tr_b16 v[114:115], v25 offset:13312
    v_rcp_f32 v198, v198
    v_mfma_f32_16x16x32_bf16 v[208:211], v[120:123], v[72:75], v[208:211]
    ds_read_b64_tr_b16 v[116:117], v25 offset:20480
    v_rcp_f32 v199, v199
    v_mfma_f32_16x16x32_bf16 v[212:215], v[120:123], v[76:79], v[212:215]
    ds_read_b64_tr_b16 v[118:119], v25 offset:21504
    v_mul_f32 v192, v192, v200
    v_mul_f32 v193, v193, v201
    v_mul_f32 v194, v194, v202
    v_mfma_f32_16x16x32_bf16 v[208:211], v[124:127], v[80:83], v[208:211]
    ds_read_b64_tr_b16 v[120:121], v25 offset:28672
    v_mul_f32 v195, v195, v203
    v_mul_f32 v196, v196, v204
    v_mfma_f32_16x16x32_bf16 v[212:215], v[124:127], v[84:87], v[212:215]
    ds_read_b64_tr_b16 v[122:123], v25 offset:29696
    v_mul_f32 v197, v197, v205
    v_mul_f32 v198, v198, v206
    s_waitcnt lgkmcnt(6)
    v_mfma_f32_16x16x32_bf16 v[208:211], v[128:131], v[88:91], v[208:211]
    ds_read_b64_tr_b16 v[124:125], v25 offset:37376
    v_mul_f32 v199, v199, v207
    v_cvt_pk_bf16_f32 v200, v192, v193
    v_cvt_pk_bf16_f32 v202, v196, v197
    v_mfma_f32_16x16x32_bf16 v[212:215], v[128:131], v[92:95], v[212:215]
    ds_read_b64_tr_b16 v[126:127], v25 offset:38400
    v_cvt_pk_bf16_f32 v201, v194, v195
    v_cvt_pk_bf16_f32 v203, v198, v199
    v_mfma_f32_16x16x32_bf16 v[216:219], v[132:135], v[40:43], v[216:219]
    ds_read_b64_tr_b16 v[128:129], v26 offset:57856
    v_permlane32_swap_b32 v200, v202
    s_nop 0
    v_permlane32_swap_b32 v201, v203
    v_mfma_f32_16x16x32_bf16 v[220:223], v[132:135], v[44:47], v[220:223]
    buffer_store_dwordx4 v[200:203], v6, s[40:43], s26 offen offset:3072 sc1
    ds_read_b64_tr_b16 v[130:131], v26 offset:58880
    v_mfma_f32_16x16x32_bf16 v[216:219], v[136:139], v[48:51], v[216:219]
    ds_read_b64_tr_b16 v[132:133], v26 offset:49664
    v_mfma_f32_16x16x32_bf16 v[220:223], v[136:139], v[52:55], v[220:223]
    ds_read_b64_tr_b16 v[134:135], v26 offset:50688
    v_mul_f32 v208, v8, v208
    v_mul_f32 v209, v8, v209
    v_mul_f32 v210, v8, v210
    v_mfma_f32_16x16x32_bf16 v[216:219], v[140:143], v[56:59], v[216:219]
    ds_read_b64_tr_b16 v[136:137], v26 offset:0
    v_mul_f32 v211, v8, v211
    v_mul_f32 v212, v9, v212
    v_mfma_f32_16x16x32_bf16 v[220:223], v[140:143], v[60:63], v[220:223]
    ds_read_b64_tr_b16 v[138:139], v26 offset:1024
    v_mul_f32 v213, v9, v213
    v_mul_f32 v214, v9, v214
    v_mul_f32 v215, v9, v215
    s_waitcnt lgkmcnt(6)
    v_mfma_f32_16x16x32_bf16 v[216:219], v[112:115], v[64:67], v[216:219]
    ds_read_b64_tr_b16 v[140:141], v26 offset:8192
    v_exp_f32 v208, v208
    v_mfma_f32_16x16x32_bf16 v[220:223], v[112:115], v[68:71], v[220:223]
    ds_read_b64_tr_b16 v[142:143], v26 offset:9216
    v_exp_f32 v209, v209
    v_mfma_f32_16x16x32_bf16 v[216:219], v[116:119], v[72:75], v[216:219]
    ds_read_b64_tr_b16 v[112:113], v26 offset:16384
    v_exp_f32 v210, v210
    v_exp_f32 v211, v211
    v_mfma_f32_16x16x32_bf16 v[220:223], v[116:119], v[76:79], v[220:223]
    ds_read_b64_tr_b16 v[114:115], v26 offset:17408
    v_exp_f32 v212, v212
    v_mfma_f32_16x16x32_bf16 v[216:219], v[120:123], v[80:83], v[216:219]
    ds_read_b64_tr_b16 v[116:117], v26 offset:24576
    v_exp_f32 v213, v213
    v_mfma_f32_16x16x32_bf16 v[220:223], v[120:123], v[84:87], v[220:223]
    ds_read_b64_tr_b16 v[118:119], v26 offset:25600
    v_exp_f32 v214, v214
    v_mfma_f32_16x16x32_bf16 v[216:219], v[124:127], v[88:91], v[216:219]
    ds_read_b64_tr_b16 v[120:121], v26 offset:33280
    v_exp_f32 v215, v215
    v_mfma_f32_16x16x32_bf16 v[220:223], v[124:127], v[92:95], v[220:223]
    ds_read_b64_tr_b16 v[122:123], v26 offset:34304
    v_fma_f32 v208, v208, v17, v17
    v_fma_f32 v209, v209, v17, v17
    v_fma_f32 v210, v210, v17, v17
    s_waitcnt lgkmcnt(6)
    v_mfma_f32_16x16x32_bf16 v[224:227], v[128:131], v[40:43], v[224:227]
    ds_read_b64_tr_b16 v[124:125], v26 offset:61952
    v_fma_f32 v211, v211, v17, v17
    v_fma_f32 v212, v212, v18, v18
    v_mfma_f32_16x16x32_bf16 v[228:231], v[128:131], v[44:47], v[228:231]
    ds_read_b64_tr_b16 v[126:127], v26 offset:62976
    v_fma_f32 v213, v213, v18, v18
    v_fma_f32 v214, v214, v18, v18
    v_mfma_f32_16x16x32_bf16 v[224:227], v[132:135], v[48:51], v[224:227]
    ds_read_b64_tr_b16 v[128:129], v26 offset:53760
    v_fma_f32 v215, v215, v18, v18
    v_rcp_f32 v208, v208
    v_mfma_f32_16x16x32_bf16 v[228:231], v[132:135], v[52:55], v[228:231]
    ds_read_b64_tr_b16 v[130:131], v26 offset:54784
    v_rcp_f32 v209, v209
    v_mfma_f32_16x16x32_bf16 v[224:227], v[136:139], v[56:59], v[224:227]
    ds_read_b64_tr_b16 v[132:133], v26 offset:4096
    v_rcp_f32 v210, v210
    v_rcp_f32 v211, v211
    v_mfma_f32_16x16x32_bf16 v[228:231], v[136:139], v[60:63], v[228:231]
    ds_read_b64_tr_b16 v[134:135], v26 offset:5120
    v_rcp_f32 v212, v212
    v_mfma_f32_16x16x32_bf16 v[224:227], v[140:143], v[64:67], v[224:227]
    ds_read_b64_tr_b16 v[136:137], v26 offset:12288
    v_rcp_f32 v213, v213
    v_mfma_f32_16x16x32_bf16 v[228:231], v[140:143], v[68:71], v[228:231]
    ds_read_b64_tr_b16 v[138:139], v26 offset:13312
    v_rcp_f32 v214, v214
    s_waitcnt lgkmcnt(6)
    v_mfma_f32_16x16x32_bf16 v[224:227], v[112:115], v[72:75], v[224:227]
    ds_read_b64_tr_b16 v[140:141], v26 offset:20480
    v_rcp_f32 v215, v215
    v_mfma_f32_16x16x32_bf16 v[228:231], v[112:115], v[76:79], v[228:231]
    ds_read_b64_tr_b16 v[142:143], v26 offset:21504
    v_mul_f32 v208, v208, v216
    v_mul_f32 v209, v209, v217
    v_mul_f32 v210, v210, v218
    v_mfma_f32_16x16x32_bf16 v[224:227], v[116:119], v[80:83], v[224:227]
    ds_read_b64_tr_b16 v[112:113], v26 offset:28672
    v_mul_f32 v211, v211, v219
    v_mul_f32 v212, v212, v220
    v_mfma_f32_16x16x32_bf16 v[228:231], v[116:119], v[84:87], v[228:231]
    ds_read_b64_tr_b16 v[114:115], v26 offset:29696
    v_mul_f32 v213, v213, v221
    v_mul_f32 v214, v214, v222
    v_mfma_f32_16x16x32_bf16 v[224:227], v[120:123], v[88:91], v[224:227]
    ds_read_b64_tr_b16 v[116:117], v26 offset:37376
    v_mul_f32 v215, v215, v223
    v_cvt_pk_bf16_f32 v216, v208, v209
    v_cvt_pk_bf16_f32 v218, v212, v213
    v_mfma_f32_16x16x32_bf16 v[228:231], v[120:123], v[92:95], v[228:231]
    ds_read_b64_tr_b16 v[118:119], v26 offset:38400
    v_cvt_pk_bf16_f32 v217, v210, v211
    v_cvt_pk_bf16_f32 v219, v214, v215
    v_mfma_f32_16x16x32_bf16 v[232:235], v[124:127], v[40:43], v[232:235]
    ds_read_b64_tr_b16 v[120:121], v27 offset:57856
    v_permlane32_swap_b32 v216, v218
    s_nop 0
    v_permlane32_swap_b32 v217, v219
    v_mfma_f32_16x16x32_bf16 v[236:239], v[124:127], v[44:47], v[236:239]
    buffer_store_dwordx4 v[216:219], v6, s[40:43], s27 offen offset:0 sc1
    ds_read_b64_tr_b16 v[122:123], v27 offset:58880
    s_waitcnt lgkmcnt(6)
    v_mfma_f32_16x16x32_bf16 v[232:235], v[128:131], v[48:51], v[232:235]
    ds_read_b64_tr_b16 v[124:125], v27 offset:49664
    v_mfma_f32_16x16x32_bf16 v[236:239], v[128:131], v[52:55], v[236:239]
    ds_read_b64_tr_b16 v[126:127], v27 offset:50688
    v_mul_f32 v224, v8, v224
    v_mul_f32 v225, v8, v225
    v_mul_f32 v226, v8, v226
    v_mfma_f32_16x16x32_bf16 v[232:235], v[132:135], v[56:59], v[232:235]
    ds_read_b64_tr_b16 v[128:129], v27 offset:0
    v_mul_f32 v227, v8, v227
    v_mul_f32 v228, v9, v228
    v_mfma_f32_16x16x32_bf16 v[236:239], v[132:135], v[60:63], v[236:239]
    v_add_u32 v11, 2, v11
    s_waitcnt vmcnt(1)
    buffer_store_dword v11, v10, s[40:43], s24 offen sc1
    ds_read_b64_tr_b16 v[130:131], v27 offset:1024
    v_mul_f32 v229, v9, v229
    v_mul_f32 v230, v9, v230
    v_mul_f32 v231, v9, v231
    v_mfma_f32_16x16x32_bf16 v[232:235], v[136:139], v[64:67], v[232:235]
    ds_read_b64_tr_b16 v[132:133], v27 offset:8192
    v_exp_f32 v224, v224
    v_mfma_f32_16x16x32_bf16 v[236:239], v[136:139], v[68:71], v[236:239]
    ds_read_b64_tr_b16 v[134:135], v27 offset:9216
    v_exp_f32 v225, v225
    v_mfma_f32_16x16x32_bf16 v[232:235], v[140:143], v[72:75], v[232:235]
    ds_read_b64_tr_b16 v[136:137], v27 offset:16384
    v_exp_f32 v226, v226
    v_exp_f32 v227, v227
    v_mfma_f32_16x16x32_bf16 v[236:239], v[140:143], v[76:79], v[236:239]
    ds_read_b64_tr_b16 v[138:139], v27 offset:17408
    v_exp_f32 v228, v228
    s_waitcnt lgkmcnt(6)
    v_mfma_f32_16x16x32_bf16 v[232:235], v[112:115], v[80:83], v[232:235]
    ds_read_b64_tr_b16 v[140:141], v27 offset:24576
    v_exp_f32 v229, v229
    v_mfma_f32_16x16x32_bf16 v[236:239], v[112:115], v[84:87], v[236:239]
    ds_read_b64_tr_b16 v[142:143], v27 offset:25600
    v_exp_f32 v230, v230
    v_mfma_f32_16x16x32_bf16 v[232:235], v[116:119], v[88:91], v[232:235]
    ds_read_b64_tr_b16 v[112:113], v27 offset:33280
    v_exp_f32 v231, v231
    v_mfma_f32_16x16x32_bf16 v[236:239], v[116:119], v[92:95], v[236:239]
    ds_read_b64_tr_b16 v[114:115], v27 offset:34304
    v_fma_f32 v224, v224, v17, v17
    v_fma_f32 v225, v225, v17, v17
    v_fma_f32 v226, v226, v17, v17
    v_mfma_f32_16x16x32_bf16 v[240:243], v[120:123], v[40:43], v[240:243]
    ds_read_b64_tr_b16 v[116:117], v27 offset:61952
    v_fma_f32 v227, v227, v17, v17
    v_fma_f32 v228, v228, v18, v18
    v_mfma_f32_16x16x32_bf16 v[244:247], v[120:123], v[44:47], v[244:247]
    ds_read_b64_tr_b16 v[118:119], v27 offset:62976
    v_fma_f32 v229, v229, v18, v18
    v_fma_f32 v230, v230, v18, v18
    v_mfma_f32_16x16x32_bf16 v[240:243], v[124:127], v[48:51], v[240:243]
    ds_read_b64_tr_b16 v[120:121], v27 offset:53760
    v_fma_f32 v231, v231, v18, v18
    v_rcp_f32 v224, v224
    v_mfma_f32_16x16x32_bf16 v[244:247], v[124:127], v[52:55], v[244:247]
    ds_read_b64_tr_b16 v[122:123], v27 offset:54784
    v_rcp_f32 v225, v225
    s_waitcnt lgkmcnt(6)
    v_mfma_f32_16x16x32_bf16 v[240:243], v[128:131], v[56:59], v[240:243]
    ds_read_b64_tr_b16 v[124:125], v27 offset:4096
    v_rcp_f32 v226, v226
    v_rcp_f32 v227, v227
    v_mfma_f32_16x16x32_bf16 v[244:247], v[128:131], v[60:63], v[244:247]
    ds_read_b64_tr_b16 v[126:127], v27 offset:5120
    v_rcp_f32 v228, v228
    v_mfma_f32_16x16x32_bf16 v[240:243], v[132:135], v[64:67], v[240:243]
    ds_read_b64_tr_b16 v[128:129], v27 offset:12288
    v_rcp_f32 v229, v229
    v_mfma_f32_16x16x32_bf16 v[244:247], v[132:135], v[68:71], v[244:247]
    ds_read_b64_tr_b16 v[130:131], v27 offset:13312
    v_rcp_f32 v230, v230
    v_mfma_f32_16x16x32_bf16 v[240:243], v[136:139], v[72:75], v[240:243]
    ds_read_b64_tr_b16 v[132:133], v27 offset:20480
    v_rcp_f32 v231, v231
    v_mfma_f32_16x16x32_bf16 v[244:247], v[136:139], v[76:79], v[244:247]
    ds_read_b64_tr_b16 v[134:135], v27 offset:21504
    v_mul_f32 v224, v224, v232
    v_mul_f32 v225, v225, v233
    v_mul_f32 v226, v226, v234
    v_mfma_f32_16x16x32_bf16 v[240:243], v[140:143], v[80:83], v[240:243]
    ds_read_b64_tr_b16 v[136:137], v27 offset:28672
    v_mul_f32 v227, v227, v235
    v_mul_f32 v228, v228, v236
    v_mfma_f32_16x16x32_bf16 v[244:247], v[140:143], v[84:87], v[244:247]
    ds_read_b64_tr_b16 v[138:139], v27 offset:29696
    v_mul_f32 v229, v229, v237
    v_mul_f32 v230, v230, v238
    s_waitcnt lgkmcnt(6)
    v_mfma_f32_16x16x32_bf16 v[240:243], v[112:115], v[88:91], v[240:243]
    ds_read_b64_tr_b16 v[140:141], v27 offset:37376
    v_mul_f32 v231, v231, v239
    v_cvt_pk_bf16_f32 v232, v224, v225
    v_cvt_pk_bf16_f32 v234, v228, v229
    v_mfma_f32_16x16x32_bf16 v[244:247], v[112:115], v[92:95], v[244:247]
    ds_read_b64_tr_b16 v[142:143], v27 offset:38400
    v_cvt_pk_bf16_f32 v233, v226, v227
    v_cvt_pk_bf16_f32 v235, v230, v231
    v_mfma_f32_16x16x32_bf16 v[248:251], v[116:119], v[40:43], v[248:251]
    v_permlane32_swap_b32 v232, v234
    s_nop 0
    v_permlane32_swap_b32 v233, v235
    v_mfma_f32_16x16x32_bf16 v[252:255], v[116:119], v[44:47], v[252:255]
    buffer_store_dwordx4 v[232:235], v6, s[40:43], s27 offen offset:1024 sc1
    v_mfma_f32_16x16x32_bf16 v[248:251], v[120:123], v[48:51], v[248:251]
    v_mfma_f32_16x16x32_bf16 v[252:255], v[120:123], v[52:55], v[252:255]
    v_mul_f32 v240, v8, v240
    v_mul_f32 v241, v8, v241
    v_mul_f32 v242, v8, v242
    v_mfma_f32_16x16x32_bf16 v[248:251], v[124:127], v[56:59], v[248:251]
    v_mul_f32 v243, v8, v243
    v_mul_f32 v244, v9, v244
    v_mfma_f32_16x16x32_bf16 v[252:255], v[124:127], v[60:63], v[252:255]
    v_mul_f32 v245, v9, v245
    v_mul_f32 v246, v9, v246
    v_mul_f32 v247, v9, v247
    s_waitcnt lgkmcnt(0)
    v_mfma_f32_16x16x32_bf16 v[248:251], v[128:131], v[64:67], v[248:251]
    v_exp_f32 v240, v240
    v_mfma_f32_16x16x32_bf16 v[252:255], v[128:131], v[68:71], v[252:255]
    v_exp_f32 v241, v241
    v_mfma_f32_16x16x32_bf16 v[248:251], v[132:135], v[72:75], v[248:251]
    v_exp_f32 v242, v242
    v_exp_f32 v243, v243
    v_mfma_f32_16x16x32_bf16 v[252:255], v[132:135], v[76:79], v[252:255]
    v_exp_f32 v244, v244
    v_mfma_f32_16x16x32_bf16 v[248:251], v[136:139], v[80:83], v[248:251]
    v_exp_f32 v245, v245
    v_mfma_f32_16x16x32_bf16 v[252:255], v[136:139], v[84:87], v[252:255]
    v_exp_f32 v246, v246
    v_mfma_f32_16x16x32_bf16 v[248:251], v[140:143], v[88:91], v[248:251]
    v_mov_b32 v16, 30
    v_exp_f32 v247, v247
    v_mfma_f32_16x16x32_bf16 v[252:255], v[140:143], v[92:95], v[252:255]
    ds_write_b32 v14, v16
    v_fma_f32 v240, v240, v17, v17
    v_fma_f32 v241, v241, v17, v17
    v_fma_f32 v242, v242, v17, v17
    v_fma_f32 v243, v243, v17, v17
    v_fma_f32 v244, v244, v18, v18
    v_fma_f32 v245, v245, v18, v18
    v_fma_f32 v246, v246, v18, v18
    v_fma_f32 v247, v247, v18, v18
    v_rcp_f32 v240, v240
    v_rcp_f32 v241, v241
    v_rcp_f32 v242, v242
    v_rcp_f32 v243, v243
    v_rcp_f32 v244, v244
    v_rcp_f32 v245, v245
    v_rcp_f32 v246, v246
    v_rcp_f32 v247, v247
    v_mul_f32 v240, v240, v248
    v_mul_f32 v241, v241, v249
    v_mul_f32 v242, v242, v250
    v_mul_f32 v243, v243, v251
    v_mul_f32 v244, v244, v252
    v_mul_f32 v245, v245, v253
    v_mul_f32 v246, v246, v254
    v_mul_f32 v247, v247, v255
    v_cvt_pk_bf16_f32 v248, v240, v241
    v_cvt_pk_bf16_f32 v250, v244, v245
    v_cvt_pk_bf16_f32 v249, v242, v243
    v_cvt_pk_bf16_f32 v251, v246, v247
    v_permlane32_swap_b32 v248, v250
    s_nop 0
    v_permlane32_swap_b32 v249, v251
    buffer_store_dwordx4 v[248:251], v6, s[40:43], s27 offen offset:2048 sc1
    v_add_u32 v11, 3, v11
    s_waitcnt vmcnt(0)
    buffer_store_dword v11, v10, s[40:43], s24 offen sc1
    s_endpgm
.section .rodata,"a"
.p2align 6
.amdhsa_kernel sequential_preLN__grouped_kv_mqa__glu_gated_glu__prompt_kernel
  .amdhsa_next_free_vgpr 256
  .amdhsa_next_free_sgpr 102
  .amdhsa_accum_offset 256
  .amdhsa_group_segment_fixed_size 0
  .amdhsa_kernarg_size 96
  .amdhsa_user_sgpr_count 2
  .amdhsa_user_sgpr_kernarg_segment_ptr 1
  .amdhsa_system_sgpr_workgroup_id_x 1
.end_amdhsa_kernel
```
